```python
import torch

def _softmax(x, axis=-1):
    return torch.softmax(x, dim=axis)
def _gelu(x):
    return torch.nn.functional.gelu(x, approximate="tanh")
def _silu(x):
    return torch.nn.functional.silu(x)
def _sigmoid(x):
    return torch.sigmoid(x)
def _layernorm(x, axis=-1, eps=1e-5):
    m = x.mean(dim=axis, keepdim=True)
    v = x.var(dim=axis, keepdim=True, unbiased=False)
    return (x - m) / torch.sqrt(v + eps)
def _scatter_add(tgt, idx, src, axis=0):
    return tgt.clone().index_add_(axis, idx, src)
def _segment_sum(src, seg, n):
    out = torch.zeros((n,) + src.shape[1:], dtype=src.dtype)
    return out.index_add_(0, seg, src)
def _pad(x, pw):
    flat = tuple(v for pair in reversed(pw) for v in pair)
    return torch.nn.functional.pad(x, flat)

kernel_name = 'parallel_sum__linear_attn_block__dense_activation_relu__prompt'

def setup_inputs():

    _w = (lambda a: (lambda t: t.to(torch.bfloat16) if t.is_floating_point() else t)(torch.as_tensor(a)))
    def _A_setup():
        B, S, D = 1, 2048, 640
        return {
            "x": _w((lambda *s: torch.randn(*s, dtype=torch.bfloat16) * 0.05)(B, S, D)),
            "wqkv": _w((lambda *s: torch.randn(*s, dtype=torch.bfloat16) * 0.2)(D, 3 * D)),
            "wo": _w((lambda *s: torch.randn(*s, dtype=torch.bfloat16) * 0.2)(D, D)),
        }
    _A_in = _A_setup()

    def _B_setup():
        B, S, D, Dff = 1, 2048, 640, 1728
        return {
            "x": _w((lambda *s: torch.randn(*s, dtype=torch.bfloat16) * 0.05)(B, S, D)),
            "w1": _w((lambda *s: torch.randn(*s, dtype=torch.bfloat16) * 0.05)(D, Dff)),
            "w2": _w((lambda *s: torch.randn(*s, dtype=torch.bfloat16) * 0.05)(Dff, D)),
        }
    _B_in = _B_setup()

    return {
        "A_x": _A_in["x"],
        "A_wqkv": _A_in["wqkv"],
        "A_wo": _A_in["wo"],
        "B_x": _B_in["x"],
        "B_w1": _B_in["w1"],
        "B_w2": _B_in["w2"],
    }

def reference(A_x, A_wqkv, A_wo, B_x, B_w1, B_w2):
    def _A_ref(x, wqkv, wo):
        B, S, D = x.shape
        H = 32; Dh = D // H
        qkv = (lambda x, *d: x.permute(*d))((x @ wqkv).reshape(B, S, 3, H, Dh), 2, 0, 3, 1, 4)
        q, k, v = qkv[0], qkv[1], qkv[2]
        phi = lambda t: torch.where(t > 0, t + 1, torch.exp(t)) + 1e-6
        pq, pk = phi(q), phi(k)
        kv = torch.einsum("bhsd,bhse->bhde", pk, v)
        z = torch.einsum("bhsd->bhd", pk)
        num = torch.einsum("bhqd,bhde->bhqe", pq, kv)
        den = torch.einsum("bhqd,bhd->bhq", pq, z)[..., None] + 1e-6
        o = num / den
        return (lambda x, *d: x.permute(*d))(o, 0, 2, 1, 3).reshape(B, S, D) @ wo

    def _B_ref(x, w1, w2):
        h = torch.einsum("bsd,df->bsf", x, w1)
        zero = torch.zeros_like(h)
        h = torch.maximum(h, zero)
        return torch.einsum("bsf,fd->bsd", h, w2)

    x = A_x
    xn = _layernorm(x, axis=-1)
    return x + _A_ref(xn, A_wqkv, A_wo) + _B_ref(xn, B_w1, B_w2)
```

```asm
; @launch grid=(256,1,1) block=(256,1,1) lds=163840
.amdgcn_target "amdgcn-amd-amdhsa--gfx950"
.text
.globl parallel_sum__linear_attn_block__dense_activation_relu__prompt_kernel
.p2align 8
.type parallel_sum__linear_attn_block__dense_activation_relu__prompt_kernel,@function
parallel_sum__linear_attn_block__dense_activation_relu__prompt_kernel:
    s_cmp_ge_u32 s2, 256
    s_cbranch_scc1 parallel_sum__linear_attn_block__dense_activation_relu__prompt_kernel_exit
    s_mov_b32 s3, 0
    s_load_dwordx16 s[64:79], s[0:1], 0
    s_load_dwordx2 s[12:13], s[0:1], 64
    v_lshrrev_b32 v1, 6, v0
    v_and_b32 v2, 63, v0
    v_readfirstlane_b32 s14, v1
    s_getpc_b64 s[96:97]
parallel_sum__linear_attn_block__dense_activation_relu__prompt_kernel_pc:
    s_lshr_b32 s40, s2, 3
    s_lshl_b32 s40, s40, 2
    s_nop 0
    s_add_u32 s40, s40, s14
    s_and_b32 s40, s40, 127
    s_mul_i32 s41, s40, 1821
    s_lshr_b32 s41, s41, 16
    s_mul_i32 s41, s41, 36
    s_sub_u32 s40, s40, s41
    s_lshl_b32 s40, s40, 11
    v_lshrrev_b32 v3, 2, v2
    v_lshlrev_b32 v3, 7, v3
    v_add_u32 v3, s40, v3
    v_min_u32 v3, parallel_sum__linear_attn_block__dense_activation_relu__prompt_kernel_exit - parallel_sum__linear_attn_block__dense_activation_relu__prompt_kernel_pc, v3
    global_load_dword v79, v3, s[96:97]
    s_and_b32 s40, s2, 7
    s_lshr_b32 s41, s2, 3
    s_lshr_b32 s42, s40, 1
    s_lshl_b32 s42, s42, 2
    s_and_b32 s43, s41, 3
    s_add_u32 s16, s42, s43
    s_and_b32 s42, s40, 1
    s_lshl_b32 s42, s42, 2
    s_bfe_u32 s43, s41, 0x20002
    s_add_u32 s15, s42, s43
    s_lshl_b32 s42, s16, 2
    s_add_u32 s42, s42, s14
    s_mul_i32 s17, s42, 40960
    s_mul_i32 s38, s42, 151552
    s_add_u32 s38, s38, 2621440
    s_lshl_b32 s39, s14, 12
    s_mul_i32 s18, s14, 5120
    s_mul_i32 s19, s14, 3072
    s_lshl_b32 s58, s15, 13
    s_add_u32 s58, s58, 15368192
    v_lshrrev_b32 v40, 3, v2
    v_lshrrev_b32 v41, 4, v2
    v_and_b32 v42, 7, v2
    v_xor_b32 v42, v42, v41
    v_mul_u32_u24 v40, 1280, v40
    v_lshl_add_u32 v44, v42, 4, v40
    v_xor_b32 v42, 4, v42
    v_lshl_add_u32 v45, v42, 4, v40
    v_lshlrev_b32 v62, 4, v0
    s_waitcnt lgkmcnt(0)
    s_mov_b32 s4, s64
    s_mov_b32 s5, s65
    s_mov_b32 s6, 2621440
    s_mov_b32 s7, 0x20000
    s_add_u32 m0, s39, 20480
    s_add_u32 s41, s17, 0
    buffer_load_dwordx4 v44, s[4:7], s41 offen lds
    s_add_u32 m0, s39, 21504
    s_add_u32 s41, s17, 10240
    buffer_load_dwordx4 v45, s[4:7], s41 offen lds
    s_add_u32 m0, s39, 22528
    s_add_u32 s41, s17, 20480
    buffer_load_dwordx4 v44, s[4:7], s41 offen lds
    s_add_u32 m0, s39, 23552
    s_add_u32 s41, s17, 30720
    buffer_load_dwordx4 v45, s[4:7], s41 offen lds
    s_and_b32 s40, s15, 3
    s_lshr_b32 s42, s2, 7
    s_lshl_b32 s42, s42, 2
    s_add_u32 s40, s40, s42
    s_mul_i32 s40, s40, 20480
    s_mul_i32 s42, s16, 163840
    s_add_u32 s40, s40, s42
    buffer_load_dwordx4 v[64:67], v62, s[4:7], s40 offen
    s_add_u32 s40, s40, 4096
    buffer_load_dwordx4 v[64:67], v62, s[4:7], s40 offen
    s_add_u32 s40, s40, 4096
    buffer_load_dwordx4 v[64:67], v62, s[4:7], s40 offen
    s_add_u32 s40, s40, 4096
    buffer_load_dwordx4 v[64:67], v62, s[4:7], s40 offen
    s_add_u32 s40, s40, 4096
    buffer_load_dwordx4 v[64:67], v62, s[4:7], s40 offen
    s_add_u32 m0, s39, 36864
    s_add_u32 s41, s17, 128
    buffer_load_dwordx4 v44, s[4:7], s41 offen lds
    s_add_u32 m0, s39, 37888
    s_add_u32 s41, s17, 10368
    buffer_load_dwordx4 v45, s[4:7], s41 offen lds
    s_add_u32 m0, s39, 38912
    s_add_u32 s41, s17, 20608
    buffer_load_dwordx4 v44, s[4:7], s41 offen lds
    s_add_u32 m0, s39, 39936
    s_add_u32 s41, s17, 30848
    buffer_load_dwordx4 v45, s[4:7], s41 offen lds
    s_mov_b32 s20, s12
    s_mov_b32 s21, s13
    s_mov_b32 s22, 15597568
    s_mov_b32 s23, 0x20000
    s_cmp_ge_u32 s2, 128
    s_cbranch_scc1 parallel_sum__linear_attn_block__dense_activation_relu__prompt_kernel_B
    s_cmp_lg_u32 s16, 0
    s_cbranch_scc1 parallel_sum__linear_attn_block__dense_activation_relu__prompt_kernel_a_nozero
    v_mov_b32 v16, 0
    v_mov_b32 v17, 0
    v_mov_b32 v18, 0
    v_mov_b32 v19, 0
    v_lshlrev_b32 v20, 4, v0
    s_add_u32 s40, s58, 4096
    s_lshl_b32 s41, s15, 12
    s_add_u32 s41, s41, 15564800
    buffer_store_dwordx4 v[16:19], v20, s[20:23], s58 offen sc0 sc1
    buffer_store_dwordx4 v[16:19], v20, s[20:23], s40 offen sc0 sc1
    buffer_store_dwordx4 v[16:19], v20, s[20:23], s41 offen sc0 sc1
    s_nop 1
parallel_sum__linear_attn_block__dense_activation_relu__prompt_kernel_a_nozero:
    s_mov_b32 s32, s78
    s_mov_b32 s33, s79
    s_mov_b32 s34, 256
    s_mov_b32 s35, 0x20000
    s_mov_b32 s56, 0x358637bd
    s_mov_b32 s57, 0x3fb8aa3b
    s_mov_b32 s60, 0
    s_mov_b32 s61, -1
    s_mov_b32 s62, 0x0000ffff
    s_mov_b32 s63, 0x0000ffff
    v_lshrrev_b32 v16, 5, v2
    v_lshlrev_b32 v16, 3, v16
    v_bfe_u32 v17, v2, 2, 2
    v_add_u32 v16, v16, v17
    v_bfe_u32 v17, v2, 4, 1
    v_lshlrev_b32 v17, 5, v17
    v_and_b32 v18, 3, v2
    v_lshl_add_u32 v17, v18, 3, v17
    v_mul_u32_u24 v18, 320, v16
    v_add_u32 v14, v18, v17
    v_add_u32 v15, 61440, v14
    v_mul_u32_u24 v18, 192, v16
    v_add_u32 v88, v18, v17
    v_add_u32 v89, 61440, v88
    v_bfe_u32 v16, v2, 4, 1
    v_mul_u32_u24 v16, 75776, v16
    v_and_b32 v17, 15, v2
    v_lshl_add_u32 v16, v17, 4, v16
    v_lshrrev_b32 v17, 5, v2
    v_lshl_add_u32 v11, v17, 8, v16
    s_mov_b32 s24, s66
    s_mov_b32 s25, s67
    s_mov_b32 s26, 2457600
    s_mov_b32 s27, 0x20000
    s_mov_b32 s28, s72
    s_mov_b32 s29, s73
    s_mov_b32 s30, 2211840
    s_mov_b32 s31, 0x20000
    s_mul_i32 s36, s14, 61440
    s_mul_i32 s37, s14, 55296
    s_mul_i32 s40, s15, 160
    s_add_u32 s40, s40, 1280
    s_lshl_b32 s41, s15, 7
    v_add_u32 v16, 0, v2
    v_mul_u32_u24 v17, 3277, v16
    v_lshrrev_b32 v17, 16, v17
    v_mul_u32_u24 v18, 20, v17
    v_sub_u32 v18, v16, v18
    v_mul_u32_u24 v17, 3840, v17
    v_lshl_add_u32 v17, v18, 4, v17
    v_cmp_le_u32 vcc, 10, v18
    v_add_u32 v19, 1120, v17
    s_nop 0
    v_cndmask_b32 v17, v17, v19, vcc
    v_add_u32 v3, s40, v17
    v_add_u32 v16, 64, v2
    v_mul_u32_u24 v17, 3277, v16
    v_lshrrev_b32 v17, 16, v17
    v_mul_u32_u24 v18, 20, v17
    v_sub_u32 v18, v16, v18
    v_mul_u32_u24 v17, 3840, v17
    v_lshl_add_u32 v17, v18, 4, v17
    v_cmp_le_u32 vcc, 10, v18
    v_add_u32 v19, 1120, v17
    s_nop 0
    v_cndmask_b32 v17, v17, v19, vcc
    v_add_u32 v4, s40, v17
    v_add_u32 v16, 128, v2
    v_mul_u32_u24 v17, 3277, v16
    v_lshrrev_b32 v17, 16, v17
    v_mul_u32_u24 v18, 20, v17
    v_sub_u32 v18, v16, v18
    v_mul_u32_u24 v17, 3840, v17
    v_lshl_add_u32 v17, v18, 4, v17
    v_cmp_le_u32 vcc, 10, v18
    v_add_u32 v19, 1120, v17
    s_nop 0
    v_cndmask_b32 v17, v17, v19, vcc
    v_add_u32 v5, s40, v17
    v_add_u32 v16, 192, v2
    v_mul_u32_u24 v17, 3277, v16
    v_lshrrev_b32 v17, 16, v17
    v_mul_u32_u24 v18, 20, v17
    v_sub_u32 v18, v16, v18
    v_mul_u32_u24 v17, 3840, v17
    v_lshl_add_u32 v17, v18, 4, v17
    v_cmp_le_u32 vcc, 10, v18
    v_add_u32 v19, 1120, v17
    s_nop 0
    v_cndmask_b32 v17, v17, v19, vcc
    v_add_u32 v6, s40, v17
    v_add_u32 v16, 256, v2
    v_mul_u32_u24 v17, 3277, v16
    v_lshrrev_b32 v17, 16, v17
    v_mul_u32_u24 v18, 20, v17
    v_sub_u32 v18, v16, v18
    v_mul_u32_u24 v17, 3840, v17
    v_lshl_add_u32 v17, v18, 4, v17
    v_cmp_le_u32 vcc, 10, v18
    v_add_u32 v19, 1120, v17
    s_nop 0
    v_cndmask_b32 v17, v17, v19, vcc
    v_add_u32 v7, s40, v17
    v_add_u32 v16, 0, v2
    v_mul_u32_u24 v17, 5462, v16
    v_lshrrev_b32 v17, 16, v17
    v_mul_u32_u24 v18, 12, v17
    v_sub_u32 v18, v16, v18
    v_and_b32 v18, 7, v18
    v_mul_u32_u24 v17, 3456, v17
    v_lshl_add_u32 v17, v18, 4, v17
    v_add_u32 v8, s41, v17
    v_add_u32 v16, 64, v2
    v_mul_u32_u24 v17, 5462, v16
    v_lshrrev_b32 v17, 16, v17
    v_mul_u32_u24 v18, 12, v17
    v_sub_u32 v18, v16, v18
    v_and_b32 v18, 7, v18
    v_mul_u32_u24 v17, 3456, v17
    v_lshl_add_u32 v17, v18, 4, v17
    v_add_u32 v9, s41, v17
    v_add_u32 v16, 128, v2
    v_mul_u32_u24 v17, 5462, v16
    v_lshrrev_b32 v17, 16, v17
    v_mul_u32_u24 v18, 12, v17
    v_sub_u32 v18, v16, v18
    v_and_b32 v18, 7, v18
    v_mul_u32_u24 v17, 3456, v17
    v_lshl_add_u32 v17, v18, 4, v17
    v_add_u32 v10, s41, v17
    s_mul_i32 s40, s14, 7168
    s_add_u32 s40, s40, 122880
    v_and_b32 v24, 31, v2
    v_lshrrev_b32 v25, 5, v2
    v_lshlrev_b32 v25, 4, v25
    v_add_u32 v91, s40, v25
    v_mul_u32_u24 v24, 80, v24
    v_add_u32 v24, v24, v91
    v_subrev_u32 v90, 1280, v24
    s_lshl_b32 s48, s15, 11
    s_add_u32 s48, s48, s38
    v_and_b32 v40, 31, v2
    v_bfe_u32 v41, v2, 1, 3
    v_lshrrev_b32 v42, 5, v2
    v_lshlrev_b32 v40, 7, v40
    v_add_u32 v40, s39, v40
    v_add_u32 v43, 0, v42
    v_xor_b32 v43, v43, v41
    v_lshl_add_u32 v46, v43, 4, v40
    v_add_u32 v50, 20480, v46
    v_add_u32 v43, 2, v42
    v_xor_b32 v43, v43, v41
    v_lshl_add_u32 v47, v43, 4, v40
    v_add_u32 v51, 20480, v47
    v_add_u32 v43, 4, v42
    v_xor_b32 v43, v43, v41
    v_lshl_add_u32 v48, v43, 4, v40
    v_add_u32 v52, 20480, v48
    v_add_u32 v43, 6, v42
    v_xor_b32 v43, v43, v41
    v_lshl_add_u32 v49, v43, 4, v40
    v_add_u32 v53, 20480, v49
    v_add_u32 v46, 86016, v46
    v_add_u32 v47, 86016, v47
    v_add_u32 v48, 86016, v48
    v_add_u32 v49, 86016, v49
    v_mov_b32 v54, 0
    v_mov_b32 v58, 0
    v_mov_b32 v55, 0
    v_mov_b32 v59, 0
    v_mov_b32 v56, 0
    v_mov_b32 v60, 0
    v_mov_b32 v57, 0
    v_mov_b32 v61, 0
    s_add_u32 m0, s39, 53248
    s_add_u32 s41, s17, 256
    buffer_load_dwordx4 v44, s[4:7], s41 offen lds
    s_add_u32 m0, s39, 54272
    s_add_u32 s41, s17, 10496
    buffer_load_dwordx4 v45, s[4:7], s41 offen lds
    s_add_u32 m0, s39, 55296
    s_add_u32 s41, s17, 20736
    buffer_load_dwordx4 v44, s[4:7], s41 offen lds
    s_add_u32 m0, s39, 56320
    s_add_u32 s41, s17, 30976
    buffer_load_dwordx4 v45, s[4:7], s41 offen lds
    s_add_u32 m0, s39, 69632
    s_add_u32 s41, s17, 384
    buffer_load_dwordx4 v44, s[4:7], s41 offen lds
    s_add_u32 m0, s39, 70656
    s_add_u32 s41, s17, 10624
    buffer_load_dwordx4 v45, s[4:7], s41 offen lds
    s_add_u32 m0, s39, 71680
    s_add_u32 s41, s17, 20864
    buffer_load_dwordx4 v44, s[4:7], s41 offen lds
    s_add_u32 m0, s39, 72704
    s_add_u32 s41, s17, 31104
    buffer_load_dwordx4 v45, s[4:7], s41 offen lds
    s_add_u32 m0, s39, 86016
    s_add_u32 s41, s17, 512
    buffer_load_dwordx4 v44, s[4:7], s41 offen lds
    s_add_u32 m0, s39, 87040
    s_add_u32 s41, s17, 10752
    buffer_load_dwordx4 v45, s[4:7], s41 offen lds
    s_add_u32 m0, s39, 88064
    s_add_u32 s41, s17, 20992
    buffer_load_dwordx4 v44, s[4:7], s41 offen lds
    s_add_u32 m0, s39, 89088
    s_add_u32 s41, s17, 31232
    buffer_load_dwordx4 v45, s[4:7], s41 offen lds
    s_waitcnt vmcnt(21)
    ds_read_b128 v[96:99], v50 offset:0
    ds_read_b128 v[100:103], v51 offset:0
    ds_read_b128 v[104:107], v52 offset:0
    ds_read_b128 v[108:111], v53 offset:0
    s_waitcnt vmcnt(12)
    ds_read_b128 v[112:115], v50 offset:16384
    ds_read_b128 v[116:119], v51 offset:16384
    ds_read_b128 v[120:123], v52 offset:16384
    ds_read_b128 v[124:127], v53 offset:16384
    s_waitcnt lgkmcnt(4)
    s_add_u32 m0, s39, 102400
    s_add_u32 s41, s17, 640
    buffer_load_dwordx4 v44, s[4:7], s41 offen lds
    v_dot2c_f32_bf16 v54, 0x3f803f80, v96
    v_dot2c_f32_bf16 v58, v96, v96
    v_dot2c_f32_bf16 v55, 0x3f803f80, v97
    v_dot2c_f32_bf16 v59, v97, v97
    s_add_u32 m0, s39, 103424
    s_add_u32 s41, s17, 10880
    buffer_load_dwordx4 v45, s[4:7], s41 offen lds
    v_dot2c_f32_bf16 v56, 0x3f803f80, v98
    v_dot2c_f32_bf16 v60, v98, v98
    v_dot2c_f32_bf16 v57, 0x3f803f80, v99
    v_dot2c_f32_bf16 v61, v99, v99
    s_add_u32 m0, s39, 104448
    s_add_u32 s41, s17, 21120
    buffer_load_dwordx4 v44, s[4:7], s41 offen lds
    v_dot2c_f32_bf16 v54, 0x3f803f80, v100
    v_dot2c_f32_bf16 v58, v100, v100
    v_dot2c_f32_bf16 v55, 0x3f803f80, v101
    v_dot2c_f32_bf16 v59, v101, v101
    s_add_u32 m0, s39, 105472
    s_add_u32 s41, s17, 31360
    buffer_load_dwordx4 v45, s[4:7], s41 offen lds
    v_dot2c_f32_bf16 v56, 0x3f803f80, v102
    v_dot2c_f32_bf16 v60, v102, v102
    v_dot2c_f32_bf16 v57, 0x3f803f80, v103
    v_dot2c_f32_bf16 v61, v103, v103
    v_dot2c_f32_bf16 v54, 0x3f803f80, v104
    v_dot2c_f32_bf16 v58, v104, v104
    v_dot2c_f32_bf16 v55, 0x3f803f80, v105
    v_dot2c_f32_bf16 v59, v105, v105
    v_dot2c_f32_bf16 v56, 0x3f803f80, v106
    v_dot2c_f32_bf16 v60, v106, v106
    v_dot2c_f32_bf16 v57, 0x3f803f80, v107
    v_dot2c_f32_bf16 v61, v107, v107
    v_dot2c_f32_bf16 v54, 0x3f803f80, v108
    v_dot2c_f32_bf16 v58, v108, v108
    v_dot2c_f32_bf16 v55, 0x3f803f80, v109
    v_dot2c_f32_bf16 v59, v109, v109
    v_dot2c_f32_bf16 v56, 0x3f803f80, v110
    v_dot2c_f32_bf16 v60, v110, v110
    v_dot2c_f32_bf16 v57, 0x3f803f80, v111
    v_dot2c_f32_bf16 v61, v111, v111
    s_waitcnt vmcnt(12)
    ds_read_b128 v[128:131], v50 offset:32768
    ds_read_b128 v[132:135], v51 offset:32768
    ds_read_b128 v[136:139], v52 offset:32768
    ds_read_b128 v[140:143], v53 offset:32768
    s_waitcnt lgkmcnt(4)
    s_add_u32 m0, s39, 118784
    s_add_u32 s41, s17, 768
    buffer_load_dwordx4 v44, s[4:7], s41 offen lds
    v_dot2c_f32_bf16 v54, 0x3f803f80, v112
    v_dot2c_f32_bf16 v58, v112, v112
    v_dot2c_f32_bf16 v55, 0x3f803f80, v113
    v_dot2c_f32_bf16 v59, v113, v113
    s_add_u32 m0, s39, 119808
    s_add_u32 s41, s17, 11008
    buffer_load_dwordx4 v45, s[4:7], s41 offen lds
    v_dot2c_f32_bf16 v56, 0x3f803f80, v114
    v_dot2c_f32_bf16 v60, v114, v114
    v_dot2c_f32_bf16 v57, 0x3f803f80, v115
    v_dot2c_f32_bf16 v61, v115, v115
    s_add_u32 m0, s39, 120832
    s_add_u32 s41, s17, 21248
    buffer_load_dwordx4 v44, s[4:7], s41 offen lds
    v_dot2c_f32_bf16 v54, 0x3f803f80, v116
    v_dot2c_f32_bf16 v58, v116, v116
    v_dot2c_f32_bf16 v55, 0x3f803f80, v117
    v_dot2c_f32_bf16 v59, v117, v117
    s_add_u32 m0, s39, 121856
    s_add_u32 s41, s17, 31488
    buffer_load_dwordx4 v45, s[4:7], s41 offen lds
    v_dot2c_f32_bf16 v56, 0x3f803f80, v118
    v_dot2c_f32_bf16 v60, v118, v118
    v_dot2c_f32_bf16 v57, 0x3f803f80, v119
    v_dot2c_f32_bf16 v61, v119, v119
    v_dot2c_f32_bf16 v54, 0x3f803f80, v120
    v_dot2c_f32_bf16 v58, v120, v120
    v_dot2c_f32_bf16 v55, 0x3f803f80, v121
    v_dot2c_f32_bf16 v59, v121, v121
    v_dot2c_f32_bf16 v56, 0x3f803f80, v122
    v_dot2c_f32_bf16 v60, v122, v122
    v_dot2c_f32_bf16 v57, 0x3f803f80, v123
    v_dot2c_f32_bf16 v61, v123, v123
    v_dot2c_f32_bf16 v54, 0x3f803f80, v124
    v_dot2c_f32_bf16 v58, v124, v124
    v_dot2c_f32_bf16 v55, 0x3f803f80, v125
    v_dot2c_f32_bf16 v59, v125, v125
    v_dot2c_f32_bf16 v56, 0x3f803f80, v126
    v_dot2c_f32_bf16 v60, v126, v126
    v_dot2c_f32_bf16 v57, 0x3f803f80, v127
    v_dot2c_f32_bf16 v61, v127, v127
    s_waitcnt vmcnt(12)
    ds_read_b128 v[144:147], v50 offset:49152
    ds_read_b128 v[148:151], v51 offset:49152
    ds_read_b128 v[152:155], v52 offset:49152
    ds_read_b128 v[156:159], v53 offset:49152
    s_waitcnt lgkmcnt(4)
    s_add_u32 m0, s39, 135168
    s_add_u32 s41, s17, 896
    buffer_load_dwordx4 v44, s[4:7], s41 offen lds
    v_dot2c_f32_bf16 v54, 0x3f803f80, v128
    v_dot2c_f32_bf16 v58, v128, v128
    v_dot2c_f32_bf16 v55, 0x3f803f80, v129
    v_dot2c_f32_bf16 v59, v129, v129
    s_add_u32 m0, s39, 136192
    s_add_u32 s41, s17, 11136
    buffer_load_dwordx4 v45, s[4:7], s41 offen lds
    v_dot2c_f32_bf16 v56, 0x3f803f80, v130
    v_dot2c_f32_bf16 v60, v130, v130
    v_dot2c_f32_bf16 v57, 0x3f803f80, v131
    v_dot2c_f32_bf16 v61, v131, v131
    s_add_u32 m0, s39, 137216
    s_add_u32 s41, s17, 21376
    buffer_load_dwordx4 v44, s[4:7], s41 offen lds
    v_dot2c_f32_bf16 v54, 0x3f803f80, v132
    v_dot2c_f32_bf16 v58, v132, v132
    v_dot2c_f32_bf16 v55, 0x3f803f80, v133
    v_dot2c_f32_bf16 v59, v133, v133
    s_add_u32 m0, s39, 138240
    s_add_u32 s41, s17, 31616
    buffer_load_dwordx4 v45, s[4:7], s41 offen lds
    v_dot2c_f32_bf16 v56, 0x3f803f80, v134
    v_dot2c_f32_bf16 v60, v134, v134
    v_dot2c_f32_bf16 v57, 0x3f803f80, v135
    v_dot2c_f32_bf16 v61, v135, v135
    v_dot2c_f32_bf16 v54, 0x3f803f80, v136
    v_dot2c_f32_bf16 v58, v136, v136
    v_dot2c_f32_bf16 v55, 0x3f803f80, v137
    v_dot2c_f32_bf16 v59, v137, v137
    v_dot2c_f32_bf16 v56, 0x3f803f80, v138
    v_dot2c_f32_bf16 v60, v138, v138
    v_dot2c_f32_bf16 v57, 0x3f803f80, v139
    v_dot2c_f32_bf16 v61, v139, v139
    v_dot2c_f32_bf16 v54, 0x3f803f80, v140
    v_dot2c_f32_bf16 v58, v140, v140
    v_dot2c_f32_bf16 v55, 0x3f803f80, v141
    v_dot2c_f32_bf16 v59, v141, v141
    v_dot2c_f32_bf16 v56, 0x3f803f80, v142
    v_dot2c_f32_bf16 v60, v142, v142
    v_dot2c_f32_bf16 v57, 0x3f803f80, v143
    v_dot2c_f32_bf16 v61, v143, v143
    s_waitcnt vmcnt(12)
    ds_read_b128 v[160:163], v46 offset:0
    ds_read_b128 v[164:167], v47 offset:0
    ds_read_b128 v[168:171], v48 offset:0
    ds_read_b128 v[172:175], v49 offset:0
    s_waitcnt lgkmcnt(4)
    s_add_u32 m0, s39, 69632
    s_add_u32 s41, s17, 1024
    buffer_load_dwordx4 v44, s[4:7], s41 offen lds
    v_dot2c_f32_bf16 v54, 0x3f803f80, v144
    v_dot2c_f32_bf16 v58, v144, v144
    v_dot2c_f32_bf16 v55, 0x3f803f80, v145
    v_dot2c_f32_bf16 v59, v145, v145
    s_add_u32 m0, s39, 70656
    s_add_u32 s41, s17, 11264
    buffer_load_dwordx4 v45, s[4:7], s41 offen lds
    v_dot2c_f32_bf16 v56, 0x3f803f80, v146
    v_dot2c_f32_bf16 v60, v146, v146
    v_dot2c_f32_bf16 v57, 0x3f803f80, v147
    v_dot2c_f32_bf16 v61, v147, v147
    s_add_u32 m0, s39, 71680
    s_add_u32 s41, s17, 21504
    buffer_load_dwordx4 v44, s[4:7], s41 offen lds
    v_dot2c_f32_bf16 v54, 0x3f803f80, v148
    v_dot2c_f32_bf16 v58, v148, v148
    v_dot2c_f32_bf16 v55, 0x3f803f80, v149
    v_dot2c_f32_bf16 v59, v149, v149
    s_add_u32 m0, s39, 72704
    s_add_u32 s41, s17, 31744
    buffer_load_dwordx4 v45, s[4:7], s41 offen lds
    v_dot2c_f32_bf16 v56, 0x3f803f80, v150
    v_dot2c_f32_bf16 v60, v150, v150
    v_dot2c_f32_bf16 v57, 0x3f803f80, v151
    v_dot2c_f32_bf16 v61, v151, v151
    v_dot2c_f32_bf16 v54, 0x3f803f80, v152
    v_dot2c_f32_bf16 v58, v152, v152
    v_dot2c_f32_bf16 v55, 0x3f803f80, v153
    v_dot2c_f32_bf16 v59, v153, v153
    v_dot2c_f32_bf16 v56, 0x3f803f80, v154
    v_dot2c_f32_bf16 v60, v154, v154
    v_dot2c_f32_bf16 v57, 0x3f803f80, v155
    v_dot2c_f32_bf16 v61, v155, v155
    v_dot2c_f32_bf16 v54, 0x3f803f80, v156
    v_dot2c_f32_bf16 v58, v156, v156
    v_dot2c_f32_bf16 v55, 0x3f803f80, v157
    v_dot2c_f32_bf16 v59, v157, v157
    v_dot2c_f32_bf16 v56, 0x3f803f80, v158
    v_dot2c_f32_bf16 v60, v158, v158
    v_dot2c_f32_bf16 v57, 0x3f803f80, v159
    v_dot2c_f32_bf16 v61, v159, v159
    s_waitcnt vmcnt(12)
    ds_read_b128 v[176:179], v46 offset:16384
    ds_read_b128 v[180:183], v47 offset:16384
    ds_read_b128 v[184:187], v48 offset:16384
    ds_read_b128 v[188:191], v49 offset:16384
    s_waitcnt lgkmcnt(4)
    s_add_u32 m0, s39, 86016
    s_add_u32 s41, s17, 1152
    buffer_load_dwordx4 v44, s[4:7], s41 offen lds
    v_dot2c_f32_bf16 v54, 0x3f803f80, v160
    v_dot2c_f32_bf16 v58, v160, v160
    v_dot2c_f32_bf16 v55, 0x3f803f80, v161
    v_dot2c_f32_bf16 v59, v161, v161
    s_add_u32 m0, s39, 87040
    s_add_u32 s41, s17, 11392
    buffer_load_dwordx4 v45, s[4:7], s41 offen lds
    v_dot2c_f32_bf16 v56, 0x3f803f80, v162
    v_dot2c_f32_bf16 v60, v162, v162
    v_dot2c_f32_bf16 v57, 0x3f803f80, v163
    v_dot2c_f32_bf16 v61, v163, v163
    s_add_u32 m0, s39, 88064
    s_add_u32 s41, s17, 21632
    buffer_load_dwordx4 v44, s[4:7], s41 offen lds
    v_dot2c_f32_bf16 v54, 0x3f803f80, v164
    v_dot2c_f32_bf16 v58, v164, v164
    v_dot2c_f32_bf16 v55, 0x3f803f80, v165
    v_dot2c_f32_bf16 v59, v165, v165
    s_add_u32 m0, s39, 89088
    s_add_u32 s41, s17, 31872
    buffer_load_dwordx4 v45, s[4:7], s41 offen lds
    v_dot2c_f32_bf16 v56, 0x3f803f80, v166
    v_dot2c_f32_bf16 v60, v166, v166
    v_dot2c_f32_bf16 v57, 0x3f803f80, v167
    v_dot2c_f32_bf16 v61, v167, v167
    v_lshlrev_b32 v62, 4, v0
    s_mul_i32 s42, s2, 9600
    s_mul_i32 s43, s2, 8640
    buffer_load_dwordx4 v[64:67], v62, s[24:27], s42 offen
    v_dot2c_f32_bf16 v54, 0x3f803f80, v168
    v_dot2c_f32_bf16 v58, v168, v168
    v_dot2c_f32_bf16 v55, 0x3f803f80, v169
    v_dot2c_f32_bf16 v59, v169, v169
    s_add_u32 s42, s42, 3200
    buffer_load_dwordx4 v[68:71], v62, s[28:31], s43 offen
    v_dot2c_f32_bf16 v56, 0x3f803f80, v170
    v_dot2c_f32_bf16 v60, v170, v170
    v_dot2c_f32_bf16 v57, 0x3f803f80, v171
    v_dot2c_f32_bf16 v61, v171, v171
    v_dot2c_f32_bf16 v54, 0x3f803f80, v172
    v_dot2c_f32_bf16 v58, v172, v172
    v_dot2c_f32_bf16 v55, 0x3f803f80, v173
    v_dot2c_f32_bf16 v59, v173, v173
    v_dot2c_f32_bf16 v56, 0x3f803f80, v174
    v_dot2c_f32_bf16 v60, v174, v174
    v_dot2c_f32_bf16 v57, 0x3f803f80, v175
    v_dot2c_f32_bf16 v61, v175, v175
    s_waitcnt vmcnt(14)
    ds_read_b128 v[192:195], v46 offset:32768
    ds_read_b128 v[196:199], v47 offset:32768
    ds_read_b128 v[200:203], v48 offset:32768
    ds_read_b128 v[204:207], v49 offset:32768
    s_waitcnt lgkmcnt(4)
    s_barrier
    s_add_u32 s43, s43, 2880
    buffer_load_dwordx4 v[64:67], v62, s[24:27], s42 offen
    v_dot2c_f32_bf16 v54, 0x3f803f80, v176
    v_dot2c_f32_bf16 v58, v176, v176
    v_dot2c_f32_bf16 v55, 0x3f803f80, v177
    v_dot2c_f32_bf16 v59, v177, v177
    s_add_u32 s42, s42, 3200
    buffer_load_dwordx4 v[68:71], v62, s[28:31], s43 offen
    v_dot2c_f32_bf16 v56, 0x3f803f80, v178
    v_dot2c_f32_bf16 v60, v178, v178
    v_dot2c_f32_bf16 v57, 0x3f803f80, v179
    v_dot2c_f32_bf16 v61, v179, v179
    s_add_u32 s55, s36, 0
    s_add_u32 m0, s18, 0
    s_nop 0
    buffer_load_dwordx4 v3, s[24:27], s55 offen lds
    v_dot2c_f32_bf16 v54, 0x3f803f80, v180
    v_dot2c_f32_bf16 v58, v180, v180
    v_dot2c_f32_bf16 v55, 0x3f803f80, v181
    v_dot2c_f32_bf16 v59, v181, v181
    s_add_u32 m0, s18, 1024
    s_nop 0
    buffer_load_dwordx4 v4, s[24:27], s55 offen lds
    v_dot2c_f32_bf16 v56, 0x3f803f80, v182
    v_dot2c_f32_bf16 v60, v182, v182
    v_dot2c_f32_bf16 v57, 0x3f803f80, v183
    v_dot2c_f32_bf16 v61, v183, v183
    s_add_u32 m0, s18, 2048
    s_nop 0
    buffer_load_dwordx4 v5, s[24:27], s55 offen lds
    v_dot2c_f32_bf16 v54, 0x3f803f80, v184
    v_dot2c_f32_bf16 v58, v184, v184
    v_dot2c_f32_bf16 v55, 0x3f803f80, v185
    v_dot2c_f32_bf16 v59, v185, v185
    s_add_u32 m0, s18, 3072
    s_nop 0
    buffer_load_dwordx4 v6, s[24:27], s55 offen lds
    v_dot2c_f32_bf16 v56, 0x3f803f80, v186
    v_dot2c_f32_bf16 v60, v186, v186
    v_dot2c_f32_bf16 v57, 0x3f803f80, v187
    v_dot2c_f32_bf16 v61, v187, v187
    s_add_u32 m0, s18, 4096
    s_nop 0
    buffer_load_dwordx4 v7, s[24:27], s55 offen lds
    v_dot2c_f32_bf16 v54, 0x3f803f80, v188
    v_dot2c_f32_bf16 v58, v188, v188
    v_dot2c_f32_bf16 v55, 0x3f803f80, v189
    v_dot2c_f32_bf16 v59, v189, v189
    v_dot2c_f32_bf16 v56, 0x3f803f80, v190
    v_dot2c_f32_bf16 v60, v190, v190
    v_dot2c_f32_bf16 v57, 0x3f803f80, v191
    v_dot2c_f32_bf16 v61, v191, v191
    s_waitcnt vmcnt(17)
    ds_read_b128 v[208:211], v46 offset:49152
    ds_read_b128 v[212:215], v47 offset:49152
    ds_read_b128 v[216:219], v48 offset:49152
    ds_read_b128 v[220:223], v49 offset:49152
    s_waitcnt lgkmcnt(4)
    s_add_u32 s43, s43, 2880
    buffer_load_dwordx4 v[64:67], v62, s[24:27], s42 offen
    v_dot2c_f32_bf16 v54, 0x3f803f80, v192
    v_dot2c_f32_bf16 v58, v192, v192
    v_dot2c_f32_bf16 v55, 0x3f803f80, v193
    v_dot2c_f32_bf16 v59, v193, v193
    s_add_u32 s42, s42, 3200
    buffer_load_dwordx4 v[68:71], v62, s[28:31], s43 offen
    v_dot2c_f32_bf16 v56, 0x3f803f80, v194
    v_dot2c_f32_bf16 v60, v194, v194
    v_dot2c_f32_bf16 v57, 0x3f803f80, v195
    v_dot2c_f32_bf16 v61, v195, v195
    v_dot2c_f32_bf16 v54, 0x3f803f80, v196
    v_dot2c_f32_bf16 v58, v196, v196
    v_dot2c_f32_bf16 v55, 0x3f803f80, v197
    v_dot2c_f32_bf16 v59, v197, v197
    v_dot2c_f32_bf16 v56, 0x3f803f80, v198
    v_dot2c_f32_bf16 v60, v198, v198
    v_dot2c_f32_bf16 v57, 0x3f803f80, v199
    v_dot2c_f32_bf16 v61, v199, v199
    v_dot2c_f32_bf16 v54, 0x3f803f80, v200
    v_dot2c_f32_bf16 v58, v200, v200
    v_dot2c_f32_bf16 v55, 0x3f803f80, v201
    v_dot2c_f32_bf16 v59, v201, v201
    v_dot2c_f32_bf16 v56, 0x3f803f80, v202
    v_dot2c_f32_bf16 v60, v202, v202
    v_dot2c_f32_bf16 v57, 0x3f803f80, v203
    v_dot2c_f32_bf16 v61, v203, v203
    v_dot2c_f32_bf16 v54, 0x3f803f80, v204
    v_dot2c_f32_bf16 v58, v204, v204
    v_dot2c_f32_bf16 v55, 0x3f803f80, v205
    v_dot2c_f32_bf16 v59, v205, v205
    v_dot2c_f32_bf16 v56, 0x3f803f80, v206
    v_dot2c_f32_bf16 v60, v206, v206
    v_dot2c_f32_bf16 v57, 0x3f803f80, v207
    v_dot2c_f32_bf16 v61, v207, v207
    s_waitcnt vmcnt(15)
    ds_read_b128 v[224:227], v50 offset:49152
    ds_read_b128 v[228:231], v51 offset:49152
    ds_read_b128 v[232:235], v52 offset:49152
    ds_read_b128 v[236:239], v53 offset:49152
    s_waitcnt lgkmcnt(4)
    v_dot2c_f32_bf16 v54, 0x3f803f80, v208
    v_dot2c_f32_bf16 v58, v208, v208
    v_dot2c_f32_bf16 v55, 0x3f803f80, v209
    v_dot2c_f32_bf16 v59, v209, v209
    v_dot2c_f32_bf16 v56, 0x3f803f80, v210
    v_dot2c_f32_bf16 v60, v210, v210
    v_dot2c_f32_bf16 v57, 0x3f803f80, v211
    v_dot2c_f32_bf16 v61, v211, v211
    v_dot2c_f32_bf16 v54, 0x3f803f80, v212
    v_dot2c_f32_bf16 v58, v212, v212
    v_dot2c_f32_bf16 v55, 0x3f803f80, v213
    v_dot2c_f32_bf16 v59, v213, v213
    v_dot2c_f32_bf16 v56, 0x3f803f80, v214
    v_dot2c_f32_bf16 v60, v214, v214
    v_dot2c_f32_bf16 v57, 0x3f803f80, v215
    v_dot2c_f32_bf16 v61, v215, v215
    v_dot2c_f32_bf16 v54, 0x3f803f80, v216
    v_dot2c_f32_bf16 v58, v216, v216
    v_dot2c_f32_bf16 v55, 0x3f803f80, v217
    v_dot2c_f32_bf16 v59, v217, v217
    v_dot2c_f32_bf16 v56, 0x3f803f80, v218
    v_dot2c_f32_bf16 v60, v218, v218
    v_dot2c_f32_bf16 v57, 0x3f803f80, v219
    v_dot2c_f32_bf16 v61, v219, v219
    v_dot2c_f32_bf16 v54, 0x3f803f80, v220
    v_dot2c_f32_bf16 v58, v220, v220
    v_dot2c_f32_bf16 v55, 0x3f803f80, v221
    v_dot2c_f32_bf16 v59, v221, v221
    v_dot2c_f32_bf16 v56, 0x3f803f80, v222
    v_dot2c_f32_bf16 v60, v222, v222
    v_dot2c_f32_bf16 v57, 0x3f803f80, v223
    v_dot2c_f32_bf16 v61, v223, v223
    s_waitcnt vmcnt(11)
    ds_read_b128 v[240:243], v46 offset:0
    ds_read_b128 v[244:247], v47 offset:0
    ds_read_b128 v[248:251], v48 offset:0
    ds_read_b128 v[252:255], v49 offset:0
    s_waitcnt lgkmcnt(4)
    v_dot2c_f32_bf16 v54, 0x3f803f80, v224
    v_dot2c_f32_bf16 v58, v224, v224
    v_dot2c_f32_bf16 v55, 0x3f803f80, v225
    v_dot2c_f32_bf16 v59, v225, v225
    v_dot2c_f32_bf16 v56, 0x3f803f80, v226
    v_dot2c_f32_bf16 v60, v226, v226
    v_dot2c_f32_bf16 v57, 0x3f803f80, v227
    v_dot2c_f32_bf16 v61, v227, v227
    v_dot2c_f32_bf16 v54, 0x3f803f80, v228
    v_dot2c_f32_bf16 v58, v228, v228
    v_dot2c_f32_bf16 v55, 0x3f803f80, v229
    v_dot2c_f32_bf16 v59, v229, v229
    v_dot2c_f32_bf16 v56, 0x3f803f80, v230
    v_dot2c_f32_bf16 v60, v230, v230
    v_dot2c_f32_bf16 v57, 0x3f803f80, v231
    v_dot2c_f32_bf16 v61, v231, v231
    v_dot2c_f32_bf16 v54, 0x3f803f80, v232
    v_dot2c_f32_bf16 v58, v232, v232
    v_dot2c_f32_bf16 v55, 0x3f803f80, v233
    v_dot2c_f32_bf16 v59, v233, v233
    v_dot2c_f32_bf16 v56, 0x3f803f80, v234
    v_dot2c_f32_bf16 v60, v234, v234
    v_dot2c_f32_bf16 v57, 0x3f803f80, v235
    v_dot2c_f32_bf16 v61, v235, v235
    v_dot2c_f32_bf16 v54, 0x3f803f80, v236
    v_dot2c_f32_bf16 v58, v236, v236
    v_dot2c_f32_bf16 v55, 0x3f803f80, v237
    v_dot2c_f32_bf16 v59, v237, v237
    v_dot2c_f32_bf16 v56, 0x3f803f80, v238
    v_dot2c_f32_bf16 v60, v238, v238
    v_dot2c_f32_bf16 v57, 0x3f803f80, v239
    v_dot2c_f32_bf16 v61, v239, v239
    s_waitcnt lgkmcnt(0)
    s_add_u32 s55, s36, 245760
    s_add_u32 m0, s18, 20480
    s_nop 0
    buffer_load_dwordx4 v3, s[24:27], s55 offen lds
    v_dot2c_f32_bf16 v54, 0x3f803f80, v240
    v_dot2c_f32_bf16 v58, v240, v240
    v_dot2c_f32_bf16 v55, 0x3f803f80, v241
    v_dot2c_f32_bf16 v59, v241, v241
    s_add_u32 m0, s18, 21504
    s_nop 0
    buffer_load_dwordx4 v4, s[24:27], s55 offen lds
    v_dot2c_f32_bf16 v56, 0x3f803f80, v242
    v_dot2c_f32_bf16 v60, v242, v242
    v_dot2c_f32_bf16 v57, 0x3f803f80, v243
    v_dot2c_f32_bf16 v61, v243, v243
    s_add_u32 m0, s18, 22528
    s_nop 0
    buffer_load_dwordx4 v5, s[24:27], s55 offen lds
    v_dot2c_f32_bf16 v54, 0x3f803f80, v244
    v_dot2c_f32_bf16 v58, v244, v244
    v_dot2c_f32_bf16 v55, 0x3f803f80, v245
    v_dot2c_f32_bf16 v59, v245, v245
    s_add_u32 m0, s18, 23552
    s_nop 0
    buffer_load_dwordx4 v6, s[24:27], s55 offen lds
    v_dot2c_f32_bf16 v56, 0x3f803f80, v246
    v_dot2c_f32_bf16 v60, v246, v246
    v_dot2c_f32_bf16 v57, 0x3f803f80, v247
    v_dot2c_f32_bf16 v61, v247, v247
    s_add_u32 m0, s18, 24576
    s_nop 0
    buffer_load_dwordx4 v7, s[24:27], s55 offen lds
    v_dot2c_f32_bf16 v54, 0x3f803f80, v248
    v_dot2c_f32_bf16 v58, v248, v248
    v_dot2c_f32_bf16 v55, 0x3f803f80, v249
    v_dot2c_f32_bf16 v59, v249, v249
    v_dot2c_f32_bf16 v56, 0x3f803f80, v250
    v_dot2c_f32_bf16 v60, v250, v250
    v_dot2c_f32_bf16 v57, 0x3f803f80, v251
    v_dot2c_f32_bf16 v61, v251, v251
    v_dot2c_f32_bf16 v54, 0x3f803f80, v252
    v_dot2c_f32_bf16 v58, v252, v252
    v_dot2c_f32_bf16 v55, 0x3f803f80, v253
    v_dot2c_f32_bf16 v59, v253, v253
    v_dot2c_f32_bf16 v56, 0x3f803f80, v254
    v_dot2c_f32_bf16 v60, v254, v254
    v_dot2c_f32_bf16 v57, 0x3f803f80, v255
    v_dot2c_f32_bf16 v61, v255, v255
    v_add_f32 v54, v54, v55
    s_nop 0
    v_add_f32 v56, v56, v57
    v_add_f32 v58, v58, v59
    v_add_f32 v60, v60, v61
    v_add_f32 v54, v54, v56
    v_add_f32 v58, v58, v60
    v_mov_b32 v55, v54
    v_mov_b32 v59, v58
    s_nop 0
    v_permlane32_swap_b32 v54, v55
    v_permlane32_swap_b32 v58, v59
    v_add_f32 v54, v54, v55
    v_add_f32 v58, v58, v59
    v_mul_f32 v54, 0x3acccccd, v54
    v_mul_f32 v58, 0x3acccccd, v58
    v_fma_f32 v58, -v54, v54, v58
    v_max_f32 v58, 0, v58
    v_cvt_pk_bf16_f32 v54, v54, v58
    v_and_b32 v58, 0xffff0000, v54
    v_lshlrev_b32 v54, 16, v54
    v_add_f32 v58, 0x3727c5ac, v58
    v_cvt_pk_bf16_f32 v58, v58, v58
    v_lshlrev_b32 v58, 16, v58
    v_sqrt_f32 v58, v58
    s_nop 0
    v_cvt_pk_bf16_f32 v58, v58, v58
    v_lshlrev_b32 v58, 16, v58
    v_rcp_f32 v12, v58
    s_nop 0
    v_mul_f32 v13, v54, v12
    v_sub_f32 v13, 0, v13
    v_lshlrev_b32 v40, 16, v96
    v_and_b32 v41, 0xffff0000, v96
    v_lshlrev_b32 v42, 16, v97
    v_and_b32 v43, 0xffff0000, v97
    v_fma_f32 v40, v40, v12, v13
    v_fma_f32 v41, v41, v12, v13
    v_fma_f32 v42, v42, v12, v13
    v_fma_f32 v43, v43, v12, v13
    v_cvt_pk_bf16_f32 v96, v40, v41
    v_cvt_pk_bf16_f32 v97, v42, v43
    v_lshlrev_b32 v40, 16, v98
    v_and_b32 v41, 0xffff0000, v98
    v_lshlrev_b32 v42, 16, v99
    v_and_b32 v43, 0xffff0000, v99
    v_fma_f32 v40, v40, v12, v13
    v_fma_f32 v41, v41, v12, v13
    v_fma_f32 v42, v42, v12, v13
    v_fma_f32 v43, v43, v12, v13
    v_cvt_pk_bf16_f32 v98, v40, v41
    v_cvt_pk_bf16_f32 v99, v42, v43
    v_lshlrev_b32 v40, 16, v100
    v_and_b32 v41, 0xffff0000, v100
    v_lshlrev_b32 v42, 16, v101
    v_and_b32 v43, 0xffff0000, v101
    v_fma_f32 v40, v40, v12, v13
    v_fma_f32 v41, v41, v12, v13
    v_fma_f32 v42, v42, v12, v13
    v_fma_f32 v43, v43, v12, v13
    v_cvt_pk_bf16_f32 v100, v40, v41
    v_cvt_pk_bf16_f32 v101, v42, v43
    v_lshlrev_b32 v40, 16, v102
    v_and_b32 v41, 0xffff0000, v102
    v_lshlrev_b32 v42, 16, v103
    v_and_b32 v43, 0xffff0000, v103
    v_fma_f32 v40, v40, v12, v13
    v_fma_f32 v41, v41, v12, v13
    v_fma_f32 v42, v42, v12, v13
    v_fma_f32 v43, v43, v12, v13
    v_cvt_pk_bf16_f32 v102, v40, v41
    v_cvt_pk_bf16_f32 v103, v42, v43
    s_waitcnt vmcnt(7)
    s_barrier
    s_cmp_lg_u32 s16, 0
    s_cbranch_scc1 parallel_sum__linear_attn_block__dense_activation_relu__prompt_kernel_a_nozsig
    s_cmp_lg_u32 s14, 0
    s_cbranch_scc1 parallel_sum__linear_attn_block__dense_activation_relu__prompt_kernel_a_z_sig
    v_mov_b32 v44, 1
    s_mov_b32 s40, 0
    v_mul_u32_u24 v45, 64, v2
    v_add_u32 v45, s40, v45
    s_mov_b64 exec, 15
    buffer_atomic_add v44, v45, s[32:35], 0 offen
    s_mov_b64 exec, -1
parallel_sum__linear_attn_block__dense_activation_relu__prompt_kernel_a_z_sig:
parallel_sum__linear_attn_block__dense_activation_relu__prompt_kernel_a_nozsig:
    ds_read_b64_tr_b16 v[16:17], v14 offset:0
    ds_read_b64_tr_b16 v[18:19], v14 offset:1280
    ds_read_b64_tr_b16 v[20:21], v14 offset:64
    ds_read_b64_tr_b16 v[22:23], v14 offset:1344
    ds_read_b64_tr_b16 v[24:25], v14 offset:128
    ds_read_b64_tr_b16 v[26:27], v14 offset:1408
    ds_read_b64_tr_b16 v[28:29], v14 offset:192
    ds_read_b64_tr_b16 v[30:31], v14 offset:1472
    s_add_u32 s55, s36, 491520
    s_add_u32 m0, s18, 40960
    s_waitcnt lgkmcnt(6)
    v_mfma_f32_32x32x16_bf16 a[0:15], v[96:99], v[16:19], 0
    buffer_load_dwordx4 v3, s[24:27], s55 offen lds
    ds_read_b64_tr_b16 v[32:33], v14 offset:256
    ds_read_b64_tr_b16 v[34:35], v14 offset:1536
    v_lshlrev_b32 v40, 16, v104
    v_and_b32 v41, 0xffff0000, v104
    v_lshlrev_b32 v42, 16, v105
    v_and_b32 v43, 0xffff0000, v105
    s_waitcnt lgkmcnt(6)
    v_mfma_f32_32x32x16_bf16 a[16:31], v[96:99], v[20:23], 0
    ds_read_b64_tr_b16 v[36:37], v14 offset:5120
    ds_read_b64_tr_b16 v[38:39], v14 offset:6400
    v_fma_f32 v40, v40, v12, v13
    v_fma_f32 v41, v41, v12, v13
    v_fma_f32 v42, v42, v12, v13
    v_fma_f32 v43, v43, v12, v13
    s_add_u32 m0, s18, 41984
    s_waitcnt lgkmcnt(6)
    v_mfma_f32_32x32x16_bf16 a[32:47], v[96:99], v[24:27], 0
    buffer_load_dwordx4 v4, s[24:27], s55 offen lds
    ds_read_b64_tr_b16 v[16:17], v14 offset:5184
    ds_read_b64_tr_b16 v[18:19], v14 offset:6464
    v_cvt_pk_bf16_f32 v104, v40, v41
    v_cvt_pk_bf16_f32 v105, v42, v43
    v_lshlrev_b32 v40, 16, v106
    v_and_b32 v41, 0xffff0000, v106
    s_waitcnt lgkmcnt(6)
    v_mfma_f32_32x32x16_bf16 a[48:63], v[96:99], v[28:31], 0
    ds_read_b64_tr_b16 v[20:21], v14 offset:5248
    ds_read_b64_tr_b16 v[22:23], v14 offset:6528
    v_lshlrev_b32 v42, 16, v107
    v_and_b32 v43, 0xffff0000, v107
    v_fma_f32 v40, v40, v12, v13
    v_fma_f32 v41, v41, v12, v13
    s_add_u32 m0, s18, 43008
    s_waitcnt lgkmcnt(6)
    v_mfma_f32_32x32x16_bf16 a[64:79], v[96:99], v[32:35], 0
    buffer_load_dwordx4 v5, s[24:27], s55 offen lds
    ds_read_b64_tr_b16 v[24:25], v14 offset:5312
    ds_read_b64_tr_b16 v[26:27], v14 offset:6592
    v_fma_f32 v42, v42, v12, v13
    v_fma_f32 v43, v43, v12, v13
    v_cvt_pk_bf16_f32 v106, v40, v41
    v_cvt_pk_bf16_f32 v107, v42, v43
    s_waitcnt lgkmcnt(6)
    v_mfma_f32_32x32x16_bf16 a[0:15], v[100:103], v[36:39], a[0:15]
    ds_read_b64_tr_b16 v[28:29], v14 offset:5376
    ds_read_b64_tr_b16 v[30:31], v14 offset:6656
    v_lshlrev_b32 v40, 16, v108
    v_and_b32 v41, 0xffff0000, v108
    v_lshlrev_b32 v42, 16, v109
    v_and_b32 v43, 0xffff0000, v109
    s_add_u32 m0, s18, 44032
    s_waitcnt lgkmcnt(6)
    v_mfma_f32_32x32x16_bf16 a[16:31], v[100:103], v[16:19], a[16:31]
    buffer_load_dwordx4 v6, s[24:27], s55 offen lds
    ds_read_b64_tr_b16 v[32:33], v14 offset:10240
    ds_read_b64_tr_b16 v[34:35], v14 offset:11520
    v_fma_f32 v40, v40, v12, v13
    v_fma_f32 v41, v41, v12, v13
    v_fma_f32 v42, v42, v12, v13
    v_fma_f32 v43, v43, v12, v13
    s_waitcnt lgkmcnt(6)
    v_mfma_f32_32x32x16_bf16 a[32:47], v[100:103], v[20:23], a[32:47]
    ds_read_b64_tr_b16 v[36:37], v14 offset:10304
    ds_read_b64_tr_b16 v[38:39], v14 offset:11584
    v_cvt_pk_bf16_f32 v108, v40, v41
    v_cvt_pk_bf16_f32 v109, v42, v43
    v_lshlrev_b32 v40, 16, v110
    v_and_b32 v41, 0xffff0000, v110
    s_add_u32 m0, s18, 45056
    s_waitcnt lgkmcnt(6)
    v_mfma_f32_32x32x16_bf16 a[48:63], v[100:103], v[24:27], a[48:63]
    buffer_load_dwordx4 v7, s[24:27], s55 offen lds
    ds_read_b64_tr_b16 v[16:17], v14 offset:10368
    ds_read_b64_tr_b16 v[18:19], v14 offset:11648
    v_lshlrev_b32 v42, 16, v111
    v_and_b32 v43, 0xffff0000, v111
    v_fma_f32 v40, v40, v12, v13
    v_fma_f32 v41, v41, v12, v13
    s_waitcnt lgkmcnt(6)
    v_mfma_f32_32x32x16_bf16 a[64:79], v[100:103], v[28:31], a[64:79]
    ds_read_b64_tr_b16 v[20:21], v14 offset:10432
    ds_read_b64_tr_b16 v[22:23], v14 offset:11712
    v_fma_f32 v42, v42, v12, v13
    v_fma_f32 v43, v43, v12, v13
    v_cvt_pk_bf16_f32 v110, v40, v41
    v_cvt_pk_bf16_f32 v111, v42, v43
    s_add_u32 s55, s36, 737280
    s_add_u32 m0, s18, 61440
    s_waitcnt lgkmcnt(6)
    v_mfma_f32_32x32x16_bf16 a[0:15], v[104:107], v[32:35], a[0:15]
    buffer_load_dwordx4 v3, s[24:27], s55 offen lds
    ds_read_b64_tr_b16 v[24:25], v14 offset:10496
    ds_read_b64_tr_b16 v[26:27], v14 offset:11776
    v_lshlrev_b32 v40, 16, v112
    v_and_b32 v41, 0xffff0000, v112
    v_lshlrev_b32 v42, 16, v113
    v_and_b32 v43, 0xffff0000, v113
    s_waitcnt lgkmcnt(6)
    v_mfma_f32_32x32x16_bf16 a[16:31], v[104:107], v[36:39], a[16:31]
    ds_read_b64_tr_b16 v[28:29], v14 offset:15360
    ds_read_b64_tr_b16 v[30:31], v14 offset:16640
    v_fma_f32 v40, v40, v12, v13
    v_fma_f32 v41, v41, v12, v13
    v_fma_f32 v42, v42, v12, v13
    v_fma_f32 v43, v43, v12, v13
    s_add_u32 m0, s18, 62464
    s_waitcnt lgkmcnt(6)
    v_mfma_f32_32x32x16_bf16 a[32:47], v[104:107], v[16:19], a[32:47]
    buffer_load_dwordx4 v4, s[24:27], s55 offen lds
    ds_read_b64_tr_b16 v[32:33], v14 offset:15424
    ds_read_b64_tr_b16 v[34:35], v14 offset:16704
    v_cvt_pk_bf16_f32 v112, v40, v41
    v_cvt_pk_bf16_f32 v113, v42, v43
    v_lshlrev_b32 v40, 16, v114
    v_and_b32 v41, 0xffff0000, v114
    s_waitcnt lgkmcnt(6)
    v_mfma_f32_32x32x16_bf16 a[48:63], v[104:107], v[20:23], a[48:63]
    ds_read_b64_tr_b16 v[36:37], v14 offset:15488
    ds_read_b64_tr_b16 v[38:39], v14 offset:16768
    v_lshlrev_b32 v42, 16, v115
    v_and_b32 v43, 0xffff0000, v115
    v_fma_f32 v40, v40, v12, v13
    v_fma_f32 v41, v41, v12, v13
    s_add_u32 m0, s18, 63488
    s_waitcnt lgkmcnt(6)
    v_mfma_f32_32x32x16_bf16 a[64:79], v[104:107], v[24:27], a[64:79]
    buffer_load_dwordx4 v5, s[24:27], s55 offen lds
    ds_read_b64_tr_b16 v[16:17], v14 offset:15552
    ds_read_b64_tr_b16 v[18:19], v14 offset:16832
    v_fma_f32 v42, v42, v12, v13
    v_fma_f32 v43, v43, v12, v13
    v_cvt_pk_bf16_f32 v114, v40, v41
    v_cvt_pk_bf16_f32 v115, v42, v43
    s_waitcnt lgkmcnt(6)
    v_mfma_f32_32x32x16_bf16 a[0:15], v[108:111], v[28:31], a[0:15]
    ds_read_b64_tr_b16 v[20:21], v14 offset:15616
    ds_read_b64_tr_b16 v[22:23], v14 offset:16896
    v_lshlrev_b32 v40, 16, v116
    v_and_b32 v41, 0xffff0000, v116
    v_lshlrev_b32 v42, 16, v117
    v_and_b32 v43, 0xffff0000, v117
    s_add_u32 m0, s18, 64512
    s_waitcnt lgkmcnt(6)
    v_mfma_f32_32x32x16_bf16 a[16:31], v[108:111], v[32:35], a[16:31]
    buffer_load_dwordx4 v6, s[24:27], s55 offen lds
    s_waitcnt vmcnt(9)
    s_barrier
    ds_read_b64_tr_b16 v[24:25], v14 offset:20480
    ds_read_b64_tr_b16 v[26:27], v14 offset:21760
    v_fma_f32 v40, v40, v12, v13
    v_fma_f32 v41, v41, v12, v13
    v_fma_f32 v42, v42, v12, v13
    v_fma_f32 v43, v43, v12, v13
    s_waitcnt lgkmcnt(6)
    v_mfma_f32_32x32x16_bf16 a[32:47], v[108:111], v[36:39], a[32:47]
    ds_read_b64_tr_b16 v[28:29], v14 offset:20544
    ds_read_b64_tr_b16 v[30:31], v14 offset:21824
    v_cvt_pk_bf16_f32 v116, v40, v41
    v_cvt_pk_bf16_f32 v117, v42, v43
    v_lshlrev_b32 v40, 16, v118
    v_and_b32 v41, 0xffff0000, v118
    s_add_u32 m0, s18, 65536
    s_waitcnt lgkmcnt(6)
    v_mfma_f32_32x32x16_bf16 a[48:63], v[108:111], v[16:19], a[48:63]
    buffer_load_dwordx4 v7, s[24:27], s55 offen lds
    ds_read_b64_tr_b16 v[32:33], v14 offset:20608
    ds_read_b64_tr_b16 v[34:35], v14 offset:21888
    v_lshlrev_b32 v42, 16, v119
    v_and_b32 v43, 0xffff0000, v119
    v_fma_f32 v40, v40, v12, v13
    v_fma_f32 v41, v41, v12, v13
    s_waitcnt lgkmcnt(6)
    v_mfma_f32_32x32x16_bf16 a[64:79], v[108:111], v[20:23], a[64:79]
    ds_read_b64_tr_b16 v[36:37], v14 offset:20672
    ds_read_b64_tr_b16 v[38:39], v14 offset:21952
    v_fma_f32 v42, v42, v12, v13
    v_fma_f32 v43, v43, v12, v13
    v_cvt_pk_bf16_f32 v118, v40, v41
    v_cvt_pk_bf16_f32 v119, v42, v43
    s_add_u32 s55, s36, 983040
    s_add_u32 m0, s18, 81920
    s_waitcnt lgkmcnt(6)
    v_mfma_f32_32x32x16_bf16 a[0:15], v[112:115], v[24:27], a[0:15]
    buffer_load_dwordx4 v3, s[24:27], s55 offen lds
    ds_read_b64_tr_b16 v[16:17], v14 offset:20736
    ds_read_b64_tr_b16 v[18:19], v14 offset:22016
    v_lshlrev_b32 v40, 16, v120
    v_and_b32 v41, 0xffff0000, v120
    v_lshlrev_b32 v42, 16, v121
    v_and_b32 v43, 0xffff0000, v121
    s_waitcnt lgkmcnt(6)
    v_mfma_f32_32x32x16_bf16 a[16:31], v[112:115], v[28:31], a[16:31]
    ds_read_b64_tr_b16 v[20:21], v14 offset:25600
    ds_read_b64_tr_b16 v[22:23], v14 offset:26880
    v_fma_f32 v40, v40, v12, v13
    v_fma_f32 v41, v41, v12, v13
    v_fma_f32 v42, v42, v12, v13
    v_fma_f32 v43, v43, v12, v13
    s_add_u32 m0, s18, 82944
    s_waitcnt lgkmcnt(6)
    v_mfma_f32_32x32x16_bf16 a[32:47], v[112:115], v[32:35], a[32:47]
    buffer_load_dwordx4 v4, s[24:27], s55 offen lds
    ds_read_b64_tr_b16 v[24:25], v14 offset:25664
    ds_read_b64_tr_b16 v[26:27], v14 offset:26944
    v_cvt_pk_bf16_f32 v120, v40, v41
    v_cvt_pk_bf16_f32 v121, v42, v43
    v_lshlrev_b32 v40, 16, v122
    v_and_b32 v41, 0xffff0000, v122
    s_waitcnt lgkmcnt(6)
    v_mfma_f32_32x32x16_bf16 a[48:63], v[112:115], v[36:39], a[48:63]
    ds_read_b64_tr_b16 v[28:29], v14 offset:25728
    ds_read_b64_tr_b16 v[30:31], v14 offset:27008
    v_lshlrev_b32 v42, 16, v123
    v_and_b32 v43, 0xffff0000, v123
    v_fma_f32 v40, v40, v12, v13
    v_fma_f32 v41, v41, v12, v13
    s_add_u32 m0, s18, 83968
    s_waitcnt lgkmcnt(6)
    v_mfma_f32_32x32x16_bf16 a[64:79], v[112:115], v[16:19], a[64:79]
    buffer_load_dwordx4 v5, s[24:27], s55 offen lds
    ds_read_b64_tr_b16 v[32:33], v14 offset:25792
    ds_read_b64_tr_b16 v[34:35], v14 offset:27072
    v_fma_f32 v42, v42, v12, v13
    v_fma_f32 v43, v43, v12, v13
    v_cvt_pk_bf16_f32 v122, v40, v41
    v_cvt_pk_bf16_f32 v123, v42, v43
    s_waitcnt lgkmcnt(6)
    v_mfma_f32_32x32x16_bf16 a[0:15], v[116:119], v[20:23], a[0:15]
    ds_read_b64_tr_b16 v[36:37], v14 offset:25856
    ds_read_b64_tr_b16 v[38:39], v14 offset:27136
    v_lshlrev_b32 v40, 16, v124
    v_and_b32 v41, 0xffff0000, v124
    v_lshlrev_b32 v42, 16, v125
    v_and_b32 v43, 0xffff0000, v125
    s_add_u32 m0, s18, 84992
    s_waitcnt lgkmcnt(6)
    v_mfma_f32_32x32x16_bf16 a[16:31], v[116:119], v[24:27], a[16:31]
    buffer_load_dwordx4 v6, s[24:27], s55 offen lds
    ds_read_b64_tr_b16 v[16:17], v14 offset:30720
    ds_read_b64_tr_b16 v[18:19], v14 offset:32000
    v_fma_f32 v40, v40, v12, v13
    v_fma_f32 v41, v41, v12, v13
    v_fma_f32 v42, v42, v12, v13
    v_fma_f32 v43, v43, v12, v13
    s_waitcnt lgkmcnt(6)
    v_mfma_f32_32x32x16_bf16 a[32:47], v[116:119], v[28:31], a[32:47]
    ds_read_b64_tr_b16 v[20:21], v14 offset:30784
    ds_read_b64_tr_b16 v[22:23], v14 offset:32064
    v_cvt_pk_bf16_f32 v124, v40, v41
    v_cvt_pk_bf16_f32 v125, v42, v43
    v_lshlrev_b32 v40, 16, v126
    v_and_b32 v41, 0xffff0000, v126
    s_add_u32 m0, s18, 86016
    s_waitcnt lgkmcnt(6)
    v_mfma_f32_32x32x16_bf16 a[48:63], v[116:119], v[32:35], a[48:63]
    buffer_load_dwordx4 v7, s[24:27], s55 offen lds
    ds_read_b64_tr_b16 v[24:25], v14 offset:30848
    ds_read_b64_tr_b16 v[26:27], v14 offset:32128
    v_lshlrev_b32 v42, 16, v127
    v_and_b32 v43, 0xffff0000, v127
    v_fma_f32 v40, v40, v12, v13
    v_fma_f32 v41, v41, v12, v13
    s_waitcnt lgkmcnt(6)
    v_mfma_f32_32x32x16_bf16 a[64:79], v[116:119], v[36:39], a[64:79]
    ds_read_b64_tr_b16 v[28:29], v14 offset:30912
    ds_read_b64_tr_b16 v[30:31], v14 offset:32192
    v_fma_f32 v42, v42, v12, v13
    v_fma_f32 v43, v43, v12, v13
    v_cvt_pk_bf16_f32 v126, v40, v41
    v_cvt_pk_bf16_f32 v127, v42, v43
    s_add_u32 s55, s36, 1228800
    s_add_u32 m0, s18, 102400
    s_waitcnt lgkmcnt(6)
    v_mfma_f32_32x32x16_bf16 a[0:15], v[120:123], v[16:19], a[0:15]
    buffer_load_dwordx4 v3, s[24:27], s55 offen lds
    ds_read_b64_tr_b16 v[32:33], v14 offset:30976
    ds_read_b64_tr_b16 v[34:35], v14 offset:32256
    v_lshlrev_b32 v40, 16, v128
    v_and_b32 v41, 0xffff0000, v128
    v_lshlrev_b32 v42, 16, v129
    v_and_b32 v43, 0xffff0000, v129
    s_waitcnt lgkmcnt(6)
    v_mfma_f32_32x32x16_bf16 a[16:31], v[120:123], v[20:23], a[16:31]
    ds_read_b64_tr_b16 v[36:37], v14 offset:35840
    ds_read_b64_tr_b16 v[38:39], v14 offset:37120
    v_fma_f32 v40, v40, v12, v13
    v_fma_f32 v41, v41, v12, v13
    v_fma_f32 v42, v42, v12, v13
    v_fma_f32 v43, v43, v12, v13
    s_add_u32 m0, s18, 103424
    s_waitcnt lgkmcnt(6)
    v_mfma_f32_32x32x16_bf16 a[32:47], v[120:123], v[24:27], a[32:47]
    buffer_load_dwordx4 v4, s[24:27], s55 offen lds
    ds_read_b64_tr_b16 v[16:17], v14 offset:35904
    ds_read_b64_tr_b16 v[18:19], v14 offset:37184
    v_cvt_pk_bf16_f32 v128, v40, v41
    v_cvt_pk_bf16_f32 v129, v42, v43
    v_lshlrev_b32 v40, 16, v130
    v_and_b32 v41, 0xffff0000, v130
    s_waitcnt lgkmcnt(6)
    v_mfma_f32_32x32x16_bf16 a[48:63], v[120:123], v[28:31], a[48:63]
    ds_read_b64_tr_b16 v[20:21], v14 offset:35968
    ds_read_b64_tr_b16 v[22:23], v14 offset:37248
    v_lshlrev_b32 v42, 16, v131
    v_and_b32 v43, 0xffff0000, v131
    v_fma_f32 v40, v40, v12, v13
    v_fma_f32 v41, v41, v12, v13
    s_add_u32 m0, s18, 104448
    s_waitcnt lgkmcnt(6)
    v_mfma_f32_32x32x16_bf16 a[64:79], v[120:123], v[32:35], a[64:79]
    buffer_load_dwordx4 v5, s[24:27], s55 offen lds
    ds_read_b64_tr_b16 v[24:25], v14 offset:36032
    ds_read_b64_tr_b16 v[26:27], v14 offset:37312
    v_fma_f32 v42, v42, v12, v13
    v_fma_f32 v43, v43, v12, v13
    v_cvt_pk_bf16_f32 v130, v40, v41
    v_cvt_pk_bf16_f32 v131, v42, v43
    s_waitcnt lgkmcnt(6)
    v_mfma_f32_32x32x16_bf16 a[0:15], v[124:127], v[36:39], a[0:15]
    ds_read_b64_tr_b16 v[28:29], v14 offset:36096
    ds_read_b64_tr_b16 v[30:31], v14 offset:37376
    v_lshlrev_b32 v40, 16, v132
    v_and_b32 v41, 0xffff0000, v132
    v_lshlrev_b32 v42, 16, v133
    v_and_b32 v43, 0xffff0000, v133
    s_add_u32 m0, s18, 105472
    s_waitcnt lgkmcnt(6)
    v_mfma_f32_32x32x16_bf16 a[16:31], v[124:127], v[16:19], a[16:31]
    buffer_load_dwordx4 v6, s[24:27], s55 offen lds
    s_waitcnt vmcnt(14)
    s_barrier
    ds_read_b64_tr_b16 v[32:33], v14 offset:40960
    ds_read_b64_tr_b16 v[34:35], v14 offset:42240
    v_fma_f32 v40, v40, v12, v13
    v_fma_f32 v41, v41, v12, v13
    v_fma_f32 v42, v42, v12, v13
    v_fma_f32 v43, v43, v12, v13
    s_waitcnt lgkmcnt(6)
    v_mfma_f32_32x32x16_bf16 a[32:47], v[124:127], v[20:23], a[32:47]
    ds_read_b64_tr_b16 v[36:37], v14 offset:41024
    ds_read_b64_tr_b16 v[38:39], v14 offset:42304
    v_cvt_pk_bf16_f32 v132, v40, v41
    v_cvt_pk_bf16_f32 v133, v42, v43
    v_lshlrev_b32 v40, 16, v134
    v_and_b32 v41, 0xffff0000, v134
    s_add_u32 m0, s18, 106496
    s_waitcnt lgkmcnt(6)
    v_mfma_f32_32x32x16_bf16 a[48:63], v[124:127], v[24:27], a[48:63]
    buffer_load_dwordx4 v7, s[24:27], s55 offen lds
    ds_read_b64_tr_b16 v[16:17], v14 offset:41088
    ds_read_b64_tr_b16 v[18:19], v14 offset:42368
    v_lshlrev_b32 v42, 16, v135
    v_and_b32 v43, 0xffff0000, v135
    v_fma_f32 v40, v40, v12, v13
    v_fma_f32 v41, v41, v12, v13
    s_waitcnt lgkmcnt(6)
    v_mfma_f32_32x32x16_bf16 a[64:79], v[124:127], v[28:31], a[64:79]
    ds_read_b64_tr_b16 v[20:21], v14 offset:41152
    ds_read_b64_tr_b16 v[22:23], v14 offset:42432
    v_fma_f32 v42, v42, v12, v13
    v_fma_f32 v43, v43, v12, v13
    v_cvt_pk_bf16_f32 v134, v40, v41
    v_cvt_pk_bf16_f32 v135, v42, v43
    s_waitcnt lgkmcnt(6)
    v_mfma_f32_32x32x16_bf16 a[0:15], v[128:131], v[32:35], a[0:15]
    ds_read_b64_tr_b16 v[24:25], v14 offset:41216
    ds_read_b64_tr_b16 v[26:27], v14 offset:42496
    v_lshlrev_b32 v40, 16, v136
    v_and_b32 v41, 0xffff0000, v136
    v_lshlrev_b32 v42, 16, v137
    v_and_b32 v43, 0xffff0000, v137
    s_waitcnt lgkmcnt(6)
    v_mfma_f32_32x32x16_bf16 a[16:31], v[128:131], v[36:39], a[16:31]
    ds_read_b64_tr_b16 v[28:29], v14 offset:46080
    ds_read_b64_tr_b16 v[30:31], v14 offset:47360
    v_fma_f32 v40, v40, v12, v13
    v_fma_f32 v41, v41, v12, v13
    v_fma_f32 v42, v42, v12, v13
    v_fma_f32 v43, v43, v12, v13
    s_add_u32 s55, s36, 1474560
    s_add_u32 m0, s18, 0
    s_waitcnt lgkmcnt(6)
    v_mfma_f32_32x32x16_bf16 a[32:47], v[128:131], v[16:19], a[32:47]
    buffer_load_dwordx4 v3, s[24:27], s55 offen lds
    ds_read_b64_tr_b16 v[32:33], v14 offset:46144
    ds_read_b64_tr_b16 v[34:35], v14 offset:47424
    v_cvt_pk_bf16_f32 v136, v40, v41
    v_cvt_pk_bf16_f32 v137, v42, v43
    v_lshlrev_b32 v40, 16, v138
    v_and_b32 v41, 0xffff0000, v138
    s_waitcnt lgkmcnt(6)
    v_mfma_f32_32x32x16_bf16 a[48:63], v[128:131], v[20:23], a[48:63]
    ds_read_b64_tr_b16 v[36:37], v14 offset:46208
    ds_read_b64_tr_b16 v[38:39], v14 offset:47488
    v_lshlrev_b32 v42, 16, v139
    v_and_b32 v43, 0xffff0000, v139
    v_fma_f32 v40, v40, v12, v13
    v_fma_f32 v41, v41, v12, v13
    s_waitcnt lgkmcnt(6)
    v_mfma_f32_32x32x16_bf16 a[64:79], v[128:131], v[24:27], a[64:79]
    ds_read_b64_tr_b16 v[16:17], v14 offset:46272
    ds_read_b64_tr_b16 v[18:19], v14 offset:47552
    v_fma_f32 v42, v42, v12, v13
    v_fma_f32 v43, v43, v12, v13
    v_cvt_pk_bf16_f32 v138, v40, v41
    v_cvt_pk_bf16_f32 v139, v42, v43
    s_waitcnt lgkmcnt(6)
    v_mfma_f32_32x32x16_bf16 a[0:15], v[132:135], v[28:31], a[0:15]
    ds_read_b64_tr_b16 v[20:21], v14 offset:46336
    ds_read_b64_tr_b16 v[22:23], v14 offset:47616
    v_lshlrev_b32 v40, 16, v140
    v_and_b32 v41, 0xffff0000, v140
    v_lshlrev_b32 v42, 16, v141
    v_and_b32 v43, 0xffff0000, v141
    s_add_u32 m0, s18, 1024
    s_waitcnt lgkmcnt(6)
    v_mfma_f32_32x32x16_bf16 a[16:31], v[132:135], v[32:35], a[16:31]
    buffer_load_dwordx4 v4, s[24:27], s55 offen lds
    ds_read_b64_tr_b16 v[24:25], v14 offset:51200
    ds_read_b64_tr_b16 v[26:27], v14 offset:52480
    v_fma_f32 v40, v40, v12, v13
    v_fma_f32 v41, v41, v12, v13
    v_fma_f32 v42, v42, v12, v13
    v_fma_f32 v43, v43, v12, v13
    s_waitcnt lgkmcnt(6)
    v_mfma_f32_32x32x16_bf16 a[32:47], v[132:135], v[36:39], a[32:47]
    ds_read_b64_tr_b16 v[28:29], v14 offset:51264
    ds_read_b64_tr_b16 v[30:31], v14 offset:52544
    v_cvt_pk_bf16_f32 v140, v40, v41
    v_cvt_pk_bf16_f32 v141, v42, v43
    v_lshlrev_b32 v40, 16, v142
    v_and_b32 v41, 0xffff0000, v142
    s_waitcnt lgkmcnt(6)
    v_mfma_f32_32x32x16_bf16 a[48:63], v[132:135], v[16:19], a[48:63]
    ds_read_b64_tr_b16 v[32:33], v14 offset:51328
    ds_read_b64_tr_b16 v[34:35], v14 offset:52608
    v_lshlrev_b32 v42, 16, v143
    v_and_b32 v43, 0xffff0000, v143
    v_fma_f32 v40, v40, v12, v13
    v_fma_f32 v41, v41, v12, v13
    s_waitcnt lgkmcnt(6)
    v_mfma_f32_32x32x16_bf16 a[64:79], v[132:135], v[20:23], a[64:79]
    ds_read_b64_tr_b16 v[36:37], v14 offset:51392
    ds_read_b64_tr_b16 v[38:39], v14 offset:52672
    v_fma_f32 v42, v42, v12, v13
    v_fma_f32 v43, v43, v12, v13
    v_cvt_pk_bf16_f32 v142, v40, v41
    v_cvt_pk_bf16_f32 v143, v42, v43
    s_add_u32 m0, s18, 2048
    s_waitcnt lgkmcnt(6)
    v_mfma_f32_32x32x16_bf16 a[0:15], v[136:139], v[24:27], a[0:15]
    buffer_load_dwordx4 v5, s[24:27], s55 offen lds
    ds_read_b64_tr_b16 v[16:17], v14 offset:51456
    ds_read_b64_tr_b16 v[18:19], v14 offset:52736
    v_lshlrev_b32 v40, 16, v144
    v_and_b32 v41, 0xffff0000, v144
    v_lshlrev_b32 v42, 16, v145
    v_and_b32 v43, 0xffff0000, v145
    s_waitcnt lgkmcnt(6)
    v_mfma_f32_32x32x16_bf16 a[16:31], v[136:139], v[28:31], a[16:31]
    ds_read_b64_tr_b16 v[20:21], v14 offset:56320
    ds_read_b64_tr_b16 v[22:23], v14 offset:57600
    v_fma_f32 v40, v40, v12, v13
    v_fma_f32 v41, v41, v12, v13
    v_fma_f32 v42, v42, v12, v13
    v_fma_f32 v43, v43, v12, v13
    s_waitcnt lgkmcnt(6)
    v_mfma_f32_32x32x16_bf16 a[32:47], v[136:139], v[32:35], a[32:47]
    ds_read_b64_tr_b16 v[24:25], v14 offset:56384
    ds_read_b64_tr_b16 v[26:27], v14 offset:57664
    v_cvt_pk_bf16_f32 v144, v40, v41
    v_cvt_pk_bf16_f32 v145, v42, v43
    v_lshlrev_b32 v40, 16, v146
    v_and_b32 v41, 0xffff0000, v146
    s_waitcnt lgkmcnt(6)
    v_mfma_f32_32x32x16_bf16 a[48:63], v[136:139], v[36:39], a[48:63]
    ds_read_b64_tr_b16 v[28:29], v14 offset:56448
    ds_read_b64_tr_b16 v[30:31], v14 offset:57728
    v_lshlrev_b32 v42, 16, v147
    v_and_b32 v43, 0xffff0000, v147
    v_fma_f32 v40, v40, v12, v13
    v_fma_f32 v41, v41, v12, v13
    s_add_u32 m0, s18, 3072
    s_waitcnt lgkmcnt(6)
    v_mfma_f32_32x32x16_bf16 a[64:79], v[136:139], v[16:19], a[64:79]
    buffer_load_dwordx4 v6, s[24:27], s55 offen lds
    ds_read_b64_tr_b16 v[32:33], v14 offset:56512
    ds_read_b64_tr_b16 v[34:35], v14 offset:57792
    v_fma_f32 v42, v42, v12, v13
    v_fma_f32 v43, v43, v12, v13
    v_cvt_pk_bf16_f32 v146, v40, v41
    v_cvt_pk_bf16_f32 v147, v42, v43
    s_waitcnt lgkmcnt(6)
    v_mfma_f32_32x32x16_bf16 a[0:15], v[140:143], v[20:23], a[0:15]
    ds_read_b64_tr_b16 v[36:37], v14 offset:56576
    ds_read_b64_tr_b16 v[38:39], v14 offset:57856
    v_lshlrev_b32 v40, 16, v148
    v_and_b32 v41, 0xffff0000, v148
    v_lshlrev_b32 v42, 16, v149
    v_and_b32 v43, 0xffff0000, v149
    s_waitcnt lgkmcnt(6)
    v_mfma_f32_32x32x16_bf16 a[16:31], v[140:143], v[24:27], a[16:31]
    s_waitcnt vmcnt(14)
    s_barrier
    ds_read_b64_tr_b16 v[16:17], v15 offset:0
    ds_read_b64_tr_b16 v[18:19], v15 offset:1280
    v_fma_f32 v40, v40, v12, v13
    v_fma_f32 v41, v41, v12, v13
    v_fma_f32 v42, v42, v12, v13
    v_fma_f32 v43, v43, v12, v13
    s_waitcnt lgkmcnt(6)
    v_mfma_f32_32x32x16_bf16 a[32:47], v[140:143], v[28:31], a[32:47]
    ds_read_b64_tr_b16 v[20:21], v15 offset:64
    ds_read_b64_tr_b16 v[22:23], v15 offset:1344
    v_cvt_pk_bf16_f32 v148, v40, v41
    v_cvt_pk_bf16_f32 v149, v42, v43
    v_lshlrev_b32 v40, 16, v150
    v_and_b32 v41, 0xffff0000, v150
    s_add_u32 m0, s18, 4096
    s_waitcnt lgkmcnt(6)
    v_mfma_f32_32x32x16_bf16 a[48:63], v[140:143], v[32:35], a[48:63]
    buffer_load_dwordx4 v7, s[24:27], s55 offen lds
    ds_read_b64_tr_b16 v[24:25], v15 offset:128
    ds_read_b64_tr_b16 v[26:27], v15 offset:1408
    v_lshlrev_b32 v42, 16, v151
    v_and_b32 v43, 0xffff0000, v151
    v_fma_f32 v40, v40, v12, v13
    v_fma_f32 v41, v41, v12, v13
    s_waitcnt lgkmcnt(6)
    v_mfma_f32_32x32x16_bf16 a[64:79], v[140:143], v[36:39], a[64:79]
    ds_read_b64_tr_b16 v[28:29], v15 offset:192
    ds_read_b64_tr_b16 v[30:31], v15 offset:1472
    v_fma_f32 v42, v42, v12, v13
    v_fma_f32 v43, v43, v12, v13
    v_cvt_pk_bf16_f32 v150, v40, v41
    v_cvt_pk_bf16_f32 v151, v42, v43
    s_waitcnt lgkmcnt(6)
    v_mfma_f32_32x32x16_bf16 a[0:15], v[144:147], v[16:19], a[0:15]
    ds_read_b64_tr_b16 v[32:33], v15 offset:256
    ds_read_b64_tr_b16 v[34:35], v15 offset:1536
    v_lshlrev_b32 v40, 16, v152
    v_and_b32 v41, 0xffff0000, v152
    v_lshlrev_b32 v42, 16, v153
    v_and_b32 v43, 0xffff0000, v153
    s_waitcnt lgkmcnt(6)
    v_mfma_f32_32x32x16_bf16 a[16:31], v[144:147], v[20:23], a[16:31]
    ds_read_b64_tr_b16 v[36:37], v15 offset:5120
    ds_read_b64_tr_b16 v[38:39], v15 offset:6400
    v_fma_f32 v40, v40, v12, v13
    v_fma_f32 v41, v41, v12, v13
    v_fma_f32 v42, v42, v12, v13
    v_fma_f32 v43, v43, v12, v13
    s_add_u32 s55, s36, 1720320
    s_add_u32 m0, s18, 20480
    s_waitcnt lgkmcnt(6)
    v_mfma_f32_32x32x16_bf16 a[32:47], v[144:147], v[24:27], a[32:47]
    buffer_load_dwordx4 v3, s[24:27], s55 offen lds
    ds_read_b64_tr_b16 v[16:17], v15 offset:5184
    ds_read_b64_tr_b16 v[18:19], v15 offset:6464
    v_cvt_pk_bf16_f32 v152, v40, v41
    v_cvt_pk_bf16_f32 v153, v42, v43
    v_lshlrev_b32 v40, 16, v154
    v_and_b32 v41, 0xffff0000, v154
    s_waitcnt lgkmcnt(6)
    v_mfma_f32_32x32x16_bf16 a[48:63], v[144:147], v[28:31], a[48:63]
    ds_read_b64_tr_b16 v[20:21], v15 offset:5248
    ds_read_b64_tr_b16 v[22:23], v15 offset:6528
    v_lshlrev_b32 v42, 16, v155
    v_and_b32 v43, 0xffff0000, v155
    v_fma_f32 v40, v40, v12, v13
    v_fma_f32 v41, v41, v12, v13
    s_waitcnt lgkmcnt(6)
    v_mfma_f32_32x32x16_bf16 a[64:79], v[144:147], v[32:35], a[64:79]
    ds_read_b64_tr_b16 v[24:25], v15 offset:5312
    ds_read_b64_tr_b16 v[26:27], v15 offset:6592
    v_fma_f32 v42, v42, v12, v13
    v_fma_f32 v43, v43, v12, v13
    v_cvt_pk_bf16_f32 v154, v40, v41
    v_cvt_pk_bf16_f32 v155, v42, v43
    s_waitcnt lgkmcnt(6)
    v_mfma_f32_32x32x16_bf16 a[0:15], v[148:151], v[36:39], a[0:15]
    ds_read_b64_tr_b16 v[28:29], v15 offset:5376
    ds_read_b64_tr_b16 v[30:31], v15 offset:6656
    v_lshlrev_b32 v40, 16, v156
    v_and_b32 v41, 0xffff0000, v156
    v_lshlrev_b32 v42, 16, v157
    v_and_b32 v43, 0xffff0000, v157
    s_add_u32 m0, s18, 21504
    s_waitcnt lgkmcnt(6)
    v_mfma_f32_32x32x16_bf16 a[16:31], v[148:151], v[16:19], a[16:31]
    buffer_load_dwordx4 v4, s[24:27], s55 offen lds
    ds_read_b64_tr_b16 v[32:33], v15 offset:10240
    ds_read_b64_tr_b16 v[34:35], v15 offset:11520
    v_fma_f32 v40, v40, v12, v13
    v_fma_f32 v41, v41, v12, v13
    v_fma_f32 v42, v42, v12, v13
    v_fma_f32 v43, v43, v12, v13
    s_waitcnt lgkmcnt(6)
    v_mfma_f32_32x32x16_bf16 a[32:47], v[148:151], v[20:23], a[32:47]
    ds_read_b64_tr_b16 v[36:37], v15 offset:10304
    ds_read_b64_tr_b16 v[38:39], v15 offset:11584
    v_cvt_pk_bf16_f32 v156, v40, v41
    v_cvt_pk_bf16_f32 v157, v42, v43
    v_lshlrev_b32 v40, 16, v158
    v_and_b32 v41, 0xffff0000, v158
    s_waitcnt lgkmcnt(6)
    v_mfma_f32_32x32x16_bf16 a[48:63], v[148:151], v[24:27], a[48:63]
    ds_read_b64_tr_b16 v[16:17], v15 offset:10368
    ds_read_b64_tr_b16 v[18:19], v15 offset:11648
    v_lshlrev_b32 v42, 16, v159
    v_and_b32 v43, 0xffff0000, v159
    v_fma_f32 v40, v40, v12, v13
    v_fma_f32 v41, v41, v12, v13
    s_waitcnt lgkmcnt(6)
    v_mfma_f32_32x32x16_bf16 a[64:79], v[148:151], v[28:31], a[64:79]
    ds_read_b64_tr_b16 v[20:21], v15 offset:10432
    ds_read_b64_tr_b16 v[22:23], v15 offset:11712
    v_fma_f32 v42, v42, v12, v13
    v_fma_f32 v43, v43, v12, v13
    v_cvt_pk_bf16_f32 v158, v40, v41
    v_cvt_pk_bf16_f32 v159, v42, v43
    s_add_u32 m0, s18, 22528
    s_waitcnt lgkmcnt(6)
    v_mfma_f32_32x32x16_bf16 a[0:15], v[152:155], v[32:35], a[0:15]
    buffer_load_dwordx4 v5, s[24:27], s55 offen lds
    ds_read_b64_tr_b16 v[24:25], v15 offset:10496
    ds_read_b64_tr_b16 v[26:27], v15 offset:11776
    v_lshlrev_b32 v40, 16, v160
    v_and_b32 v41, 0xffff0000, v160
    v_lshlrev_b32 v42, 16, v161
    v_and_b32 v43, 0xffff0000, v161
    s_waitcnt lgkmcnt(6)
    v_mfma_f32_32x32x16_bf16 a[16:31], v[152:155], v[36:39], a[16:31]
    ds_read_b64_tr_b16 v[28:29], v15 offset:15360
    ds_read_b64_tr_b16 v[30:31], v15 offset:16640
    v_fma_f32 v40, v40, v12, v13
    v_fma_f32 v41, v41, v12, v13
    v_fma_f32 v42, v42, v12, v13
    v_fma_f32 v43, v43, v12, v13
    s_waitcnt lgkmcnt(6)
    v_mfma_f32_32x32x16_bf16 a[32:47], v[152:155], v[16:19], a[32:47]
    ds_read_b64_tr_b16 v[32:33], v15 offset:15424
    ds_read_b64_tr_b16 v[34:35], v15 offset:16704
    v_cvt_pk_bf16_f32 v160, v40, v41
    v_cvt_pk_bf16_f32 v161, v42, v43
    v_lshlrev_b32 v40, 16, v162
    v_and_b32 v41, 0xffff0000, v162
    s_waitcnt lgkmcnt(6)
    v_mfma_f32_32x32x16_bf16 a[48:63], v[152:155], v[20:23], a[48:63]
    ds_read_b64_tr_b16 v[36:37], v15 offset:15488
    ds_read_b64_tr_b16 v[38:39], v15 offset:16768
    v_lshlrev_b32 v42, 16, v163
    v_and_b32 v43, 0xffff0000, v163
    v_fma_f32 v40, v40, v12, v13
    v_fma_f32 v41, v41, v12, v13
    s_add_u32 m0, s18, 23552
    s_waitcnt lgkmcnt(6)
    v_mfma_f32_32x32x16_bf16 a[64:79], v[152:155], v[24:27], a[64:79]
    buffer_load_dwordx4 v6, s[24:27], s55 offen lds
    ds_read_b64_tr_b16 v[16:17], v15 offset:15552
    ds_read_b64_tr_b16 v[18:19], v15 offset:16832
    v_fma_f32 v42, v42, v12, v13
    v_fma_f32 v43, v43, v12, v13
    v_cvt_pk_bf16_f32 v162, v40, v41
    v_cvt_pk_bf16_f32 v163, v42, v43
    s_waitcnt lgkmcnt(6)
    v_mfma_f32_32x32x16_bf16 a[0:15], v[156:159], v[28:31], a[0:15]
    ds_read_b64_tr_b16 v[20:21], v15 offset:15616
    ds_read_b64_tr_b16 v[22:23], v15 offset:16896
    v_lshlrev_b32 v40, 16, v164
    v_and_b32 v41, 0xffff0000, v164
    v_lshlrev_b32 v42, 16, v165
    v_and_b32 v43, 0xffff0000, v165
    s_waitcnt lgkmcnt(6)
    v_mfma_f32_32x32x16_bf16 a[16:31], v[156:159], v[32:35], a[16:31]
    s_waitcnt vmcnt(14)
    s_barrier
    s_cmp_lg_u32 s14, 0
    s_cbranch_scc1 parallel_sum__linear_attn_block__dense_activation_relu__prompt_kernel_a_initp_pre
    s_and_b32 s40, s2, 3
    s_lshl_b32 s40, s40, 6
    v_mov_b32 v1, s40
    s_mov_b64 exec, 1
    buffer_load_dword v95, v1, s[32:35], 0 offen sc0 sc1
    s_mov_b64 exec, -1
parallel_sum__linear_attn_block__dense_activation_relu__prompt_kernel_a_initp_pre:
    ds_read_b64_tr_b16 v[24:25], v15 offset:20480
    ds_read_b64_tr_b16 v[26:27], v15 offset:21760
    v_fma_f32 v40, v40, v12, v13
    v_fma_f32 v41, v41, v12, v13
    v_fma_f32 v42, v42, v12, v13
    v_fma_f32 v43, v43, v12, v13
    s_waitcnt lgkmcnt(6)
    v_mfma_f32_32x32x16_bf16 a[32:47], v[156:159], v[36:39], a[32:47]
    ds_read_b64_tr_b16 v[28:29], v15 offset:20544
    ds_read_b64_tr_b16 v[30:31], v15 offset:21824
    v_cvt_pk_bf16_f32 v164, v40, v41
    v_cvt_pk_bf16_f32 v165, v42, v43
    v_lshlrev_b32 v40, 16, v166
    v_and_b32 v41, 0xffff0000, v166
    s_add_u32 m0, s18, 24576
    s_waitcnt lgkmcnt(6)
    v_mfma_f32_32x32x16_bf16 a[48:63], v[156:159], v[16:19], a[48:63]
    buffer_load_dwordx4 v7, s[24:27], s55 offen lds
    ds_read_b64_tr_b16 v[32:33], v15 offset:20608
    ds_read_b64_tr_b16 v[34:35], v15 offset:21888
    v_lshlrev_b32 v42, 16, v167
    v_and_b32 v43, 0xffff0000, v167
    v_fma_f32 v40, v40, v12, v13
    v_fma_f32 v41, v41, v12, v13
    s_waitcnt lgkmcnt(6)
    v_mfma_f32_32x32x16_bf16 a[64:79], v[156:159], v[20:23], a[64:79]
    ds_read_b64_tr_b16 v[36:37], v15 offset:20672
    ds_read_b64_tr_b16 v[38:39], v15 offset:21952
    v_fma_f32 v42, v42, v12, v13
    v_fma_f32 v43, v43, v12, v13
    v_cvt_pk_bf16_f32 v166, v40, v41
    v_cvt_pk_bf16_f32 v167, v42, v43
    s_waitcnt lgkmcnt(6)
    v_mfma_f32_32x32x16_bf16 a[0:15], v[160:163], v[24:27], a[0:15]
    ds_read_b64_tr_b16 v[16:17], v15 offset:20736
    ds_read_b64_tr_b16 v[18:19], v15 offset:22016
    v_lshlrev_b32 v40, 16, v168
    v_and_b32 v41, 0xffff0000, v168
    v_lshlrev_b32 v42, 16, v169
    v_and_b32 v43, 0xffff0000, v169
    s_waitcnt lgkmcnt(6)
    v_mfma_f32_32x32x16_bf16 a[16:31], v[160:163], v[28:31], a[16:31]
    ds_read_b64_tr_b16 v[20:21], v15 offset:25600
    ds_read_b64_tr_b16 v[22:23], v15 offset:26880
    v_fma_f32 v40, v40, v12, v13
    v_fma_f32 v41, v41, v12, v13
    v_fma_f32 v42, v42, v12, v13
    v_fma_f32 v43, v43, v12, v13
    s_add_u32 s55, s36, 1966080
    s_add_u32 m0, s18, 40960
    s_waitcnt lgkmcnt(6)
    v_mfma_f32_32x32x16_bf16 a[32:47], v[160:163], v[32:35], a[32:47]
    buffer_load_dwordx4 v3, s[24:27], s55 offen lds
    ds_read_b64_tr_b16 v[24:25], v15 offset:25664
    ds_read_b64_tr_b16 v[26:27], v15 offset:26944
    v_cvt_pk_bf16_f32 v168, v40, v41
    v_cvt_pk_bf16_f32 v169, v42, v43
    v_lshlrev_b32 v40, 16, v170
    v_and_b32 v41, 0xffff0000, v170
    s_waitcnt lgkmcnt(6)
    v_mfma_f32_32x32x16_bf16 a[48:63], v[160:163], v[36:39], a[48:63]
    ds_read_b64_tr_b16 v[28:29], v15 offset:25728
    ds_read_b64_tr_b16 v[30:31], v15 offset:27008
    v_lshlrev_b32 v42, 16, v171
    v_and_b32 v43, 0xffff0000, v171
    v_fma_f32 v40, v40, v12, v13
    v_fma_f32 v41, v41, v12, v13
    s_waitcnt lgkmcnt(6)
    v_mfma_f32_32x32x16_bf16 a[64:79], v[160:163], v[16:19], a[64:79]
    ds_read_b64_tr_b16 v[32:33], v15 offset:25792
    ds_read_b64_tr_b16 v[34:35], v15 offset:27072
    v_fma_f32 v42, v42, v12, v13
    v_fma_f32 v43, v43, v12, v13
    v_cvt_pk_bf16_f32 v170, v40, v41
    v_cvt_pk_bf16_f32 v171, v42, v43
    s_waitcnt lgkmcnt(6)
    v_mfma_f32_32x32x16_bf16 a[0:15], v[164:167], v[20:23], a[0:15]
    ds_read_b64_tr_b16 v[36:37], v15 offset:25856
    ds_read_b64_tr_b16 v[38:39], v15 offset:27136
    v_lshlrev_b32 v40, 16, v172
    v_and_b32 v41, 0xffff0000, v172
    v_lshlrev_b32 v42, 16, v173
    v_and_b32 v43, 0xffff0000, v173
    s_add_u32 m0, s18, 41984
    s_waitcnt lgkmcnt(6)
    v_mfma_f32_32x32x16_bf16 a[16:31], v[164:167], v[24:27], a[16:31]
    buffer_load_dwordx4 v4, s[24:27], s55 offen lds
    ds_read_b64_tr_b16 v[16:17], v15 offset:30720
    ds_read_b64_tr_b16 v[18:19], v15 offset:32000
    v_fma_f32 v40, v40, v12, v13
    v_fma_f32 v41, v41, v12, v13
    v_fma_f32 v42, v42, v12, v13
    v_fma_f32 v43, v43, v12, v13
    s_waitcnt lgkmcnt(6)
    v_mfma_f32_32x32x16_bf16 a[32:47], v[164:167], v[28:31], a[32:47]
    ds_read_b64_tr_b16 v[20:21], v15 offset:30784
    ds_read_b64_tr_b16 v[22:23], v15 offset:32064
    v_cvt_pk_bf16_f32 v172, v40, v41
    v_cvt_pk_bf16_f32 v173, v42, v43
    v_lshlrev_b32 v40, 16, v174
    v_and_b32 v41, 0xffff0000, v174
    s_waitcnt lgkmcnt(6)
    v_mfma_f32_32x32x16_bf16 a[48:63], v[164:167], v[32:35], a[48:63]
    ds_read_b64_tr_b16 v[24:25], v15 offset:30848
    ds_read_b64_tr_b16 v[26:27], v15 offset:32128
    v_lshlrev_b32 v42, 16, v175
    v_and_b32 v43, 0xffff0000, v175
    v_fma_f32 v40, v40, v12, v13
    v_fma_f32 v41, v41, v12, v13
    s_waitcnt lgkmcnt(6)
    v_mfma_f32_32x32x16_bf16 a[64:79], v[164:167], v[36:39], a[64:79]
    ds_read_b64_tr_b16 v[28:29], v15 offset:30912
    ds_read_b64_tr_b16 v[30:31], v15 offset:32192
    v_fma_f32 v42, v42, v12, v13
    v_fma_f32 v43, v43, v12, v13
    v_cvt_pk_bf16_f32 v174, v40, v41
    v_cvt_pk_bf16_f32 v175, v42, v43
    s_add_u32 m0, s18, 43008
    s_waitcnt lgkmcnt(6)
    v_mfma_f32_32x32x16_bf16 a[0:15], v[168:171], v[16:19], a[0:15]
    buffer_load_dwordx4 v5, s[24:27], s55 offen lds
    ds_read_b64_tr_b16 v[32:33], v15 offset:30976
    ds_read_b64_tr_b16 v[34:35], v15 offset:32256
    v_lshlrev_b32 v40, 16, v176
    v_and_b32 v41, 0xffff0000, v176
    v_lshlrev_b32 v42, 16, v177
    v_and_b32 v43, 0xffff0000, v177
    s_waitcnt lgkmcnt(6)
    v_mfma_f32_32x32x16_bf16 a[16:31], v[168:171], v[20:23], a[16:31]
    ds_read_b64_tr_b16 v[36:37], v15 offset:35840
    ds_read_b64_tr_b16 v[38:39], v15 offset:37120
    v_fma_f32 v40, v40, v12, v13
    v_fma_f32 v41, v41, v12, v13
    v_fma_f32 v42, v42, v12, v13
    v_fma_f32 v43, v43, v12, v13
    s_waitcnt lgkmcnt(6)
    v_mfma_f32_32x32x16_bf16 a[32:47], v[168:171], v[24:27], a[32:47]
    ds_read_b64_tr_b16 v[16:17], v15 offset:35904
    ds_read_b64_tr_b16 v[18:19], v15 offset:37184
    v_cvt_pk_bf16_f32 v176, v40, v41
    v_cvt_pk_bf16_f32 v177, v42, v43
    v_lshlrev_b32 v40, 16, v178
    v_and_b32 v41, 0xffff0000, v178
    s_waitcnt lgkmcnt(6)
    v_mfma_f32_32x32x16_bf16 a[48:63], v[168:171], v[28:31], a[48:63]
    ds_read_b64_tr_b16 v[20:21], v15 offset:35968
    ds_read_b64_tr_b16 v[22:23], v15 offset:37248
    v_lshlrev_b32 v42, 16, v179
    v_and_b32 v43, 0xffff0000, v179
    v_fma_f32 v40, v40, v12, v13
    v_fma_f32 v41, v41, v12, v13
    s_add_u32 m0, s18, 44032
    s_waitcnt lgkmcnt(6)
    v_mfma_f32_32x32x16_bf16 a[64:79], v[168:171], v[32:35], a[64:79]
    buffer_load_dwordx4 v6, s[24:27], s55 offen lds
    ds_read_b64_tr_b16 v[24:25], v15 offset:36032
    ds_read_b64_tr_b16 v[26:27], v15 offset:37312
    v_fma_f32 v42, v42, v12, v13
    v_fma_f32 v43, v43, v12, v13
    v_cvt_pk_bf16_f32 v178, v40, v41
    v_cvt_pk_bf16_f32 v179, v42, v43
    s_waitcnt lgkmcnt(6)
    v_mfma_f32_32x32x16_bf16 a[0:15], v[172:175], v[36:39], a[0:15]
    ds_read_b64_tr_b16 v[28:29], v15 offset:36096
    ds_read_b64_tr_b16 v[30:31], v15 offset:37376
    v_lshlrev_b32 v40, 16, v180
    v_and_b32 v41, 0xffff0000, v180
    v_lshlrev_b32 v42, 16, v181
    v_and_b32 v43, 0xffff0000, v181
    s_waitcnt lgkmcnt(6)
    v_mfma_f32_32x32x16_bf16 a[16:31], v[172:175], v[16:19], a[16:31]
    s_waitcnt vmcnt(14)
    s_barrier
    ds_read_b64_tr_b16 v[32:33], v15 offset:40960
    ds_read_b64_tr_b16 v[34:35], v15 offset:42240
    v_fma_f32 v40, v40, v12, v13
    v_fma_f32 v41, v41, v12, v13
    v_fma_f32 v42, v42, v12, v13
    v_fma_f32 v43, v43, v12, v13
    s_waitcnt lgkmcnt(6)
    v_mfma_f32_32x32x16_bf16 a[32:47], v[172:175], v[20:23], a[32:47]
    ds_read_b64_tr_b16 v[36:37], v15 offset:41024
    ds_read_b64_tr_b16 v[38:39], v15 offset:42304
    v_cvt_pk_bf16_f32 v180, v40, v41
    v_cvt_pk_bf16_f32 v181, v42, v43
    v_lshlrev_b32 v40, 16, v182
    v_and_b32 v41, 0xffff0000, v182
    s_add_u32 m0, s18, 45056
    s_waitcnt lgkmcnt(6)
    v_mfma_f32_32x32x16_bf16 a[48:63], v[172:175], v[24:27], a[48:63]
    buffer_load_dwordx4 v7, s[24:27], s55 offen lds
    ds_read_b64_tr_b16 v[16:17], v15 offset:41088
    ds_read_b64_tr_b16 v[18:19], v15 offset:42368
    v_lshlrev_b32 v42, 16, v183
    v_and_b32 v43, 0xffff0000, v183
    v_fma_f32 v40, v40, v12, v13
    v_fma_f32 v41, v41, v12, v13
    s_waitcnt lgkmcnt(6)
    v_mfma_f32_32x32x16_bf16 a[64:79], v[172:175], v[28:31], a[64:79]
    ds_read_b64_tr_b16 v[20:21], v15 offset:41152
    ds_read_b64_tr_b16 v[22:23], v15 offset:42432
    v_fma_f32 v42, v42, v12, v13
    v_fma_f32 v43, v43, v12, v13
    v_cvt_pk_bf16_f32 v182, v40, v41
    v_cvt_pk_bf16_f32 v183, v42, v43
    s_waitcnt lgkmcnt(6)
    v_mfma_f32_32x32x16_bf16 a[0:15], v[176:179], v[32:35], a[0:15]
    ds_read_b64_tr_b16 v[24:25], v15 offset:41216
    ds_read_b64_tr_b16 v[26:27], v15 offset:42496
    v_lshlrev_b32 v40, 16, v184
    v_and_b32 v41, 0xffff0000, v184
    v_lshlrev_b32 v42, 16, v185
    v_and_b32 v43, 0xffff0000, v185
    s_waitcnt lgkmcnt(6)
    v_mfma_f32_32x32x16_bf16 a[16:31], v[176:179], v[36:39], a[16:31]
    ds_read_b64_tr_b16 v[28:29], v15 offset:46080
    ds_read_b64_tr_b16 v[30:31], v15 offset:47360
    v_fma_f32 v40, v40, v12, v13
    v_fma_f32 v41, v41, v12, v13
    v_fma_f32 v42, v42, v12, v13
    v_fma_f32 v43, v43, v12, v13
    s_add_u32 s55, s36, 2211840
    s_add_u32 m0, s18, 61440
    s_waitcnt lgkmcnt(6)
    v_mfma_f32_32x32x16_bf16 a[32:47], v[176:179], v[16:19], a[32:47]
    buffer_load_dwordx4 v3, s[24:27], s55 offen lds
    ds_read_b64_tr_b16 v[32:33], v15 offset:46144
    ds_read_b64_tr_b16 v[34:35], v15 offset:47424
    v_cvt_pk_bf16_f32 v184, v40, v41
    v_cvt_pk_bf16_f32 v185, v42, v43
    v_lshlrev_b32 v40, 16, v186
    v_and_b32 v41, 0xffff0000, v186
    s_waitcnt lgkmcnt(6)
    v_mfma_f32_32x32x16_bf16 a[48:63], v[176:179], v[20:23], a[48:63]
    ds_read_b64_tr_b16 v[36:37], v15 offset:46208
    ds_read_b64_tr_b16 v[38:39], v15 offset:47488
    v_lshlrev_b32 v42, 16, v187
    v_and_b32 v43, 0xffff0000, v187
    v_fma_f32 v40, v40, v12, v13
    v_fma_f32 v41, v41, v12, v13
    s_waitcnt lgkmcnt(6)
    v_mfma_f32_32x32x16_bf16 a[64:79], v[176:179], v[24:27], a[64:79]
    ds_read_b64_tr_b16 v[16:17], v15 offset:46272
    ds_read_b64_tr_b16 v[18:19], v15 offset:47552
    v_fma_f32 v42, v42, v12, v13
    v_fma_f32 v43, v43, v12, v13
    v_cvt_pk_bf16_f32 v186, v40, v41
    v_cvt_pk_bf16_f32 v187, v42, v43
    s_waitcnt lgkmcnt(6)
    v_mfma_f32_32x32x16_bf16 a[0:15], v[180:183], v[28:31], a[0:15]
    ds_read_b64_tr_b16 v[20:21], v15 offset:46336
    ds_read_b64_tr_b16 v[22:23], v15 offset:47616
    v_lshlrev_b32 v40, 16, v188
    v_and_b32 v41, 0xffff0000, v188
    v_lshlrev_b32 v42, 16, v189
    v_and_b32 v43, 0xffff0000, v189
    s_add_u32 m0, s18, 62464
    s_waitcnt lgkmcnt(6)
    v_mfma_f32_32x32x16_bf16 a[16:31], v[180:183], v[32:35], a[16:31]
    buffer_load_dwordx4 v4, s[24:27], s55 offen lds
    ds_read_b64_tr_b16 v[24:25], v15 offset:51200
    ds_read_b64_tr_b16 v[26:27], v15 offset:52480
    v_fma_f32 v40, v40, v12, v13
    v_fma_f32 v41, v41, v12, v13
    v_fma_f32 v42, v42, v12, v13
    v_fma_f32 v43, v43, v12, v13
    s_waitcnt lgkmcnt(6)
    v_mfma_f32_32x32x16_bf16 a[32:47], v[180:183], v[36:39], a[32:47]
    ds_read_b64_tr_b16 v[28:29], v15 offset:51264
    ds_read_b64_tr_b16 v[30:31], v15 offset:52544
    v_cvt_pk_bf16_f32 v188, v40, v41
    v_cvt_pk_bf16_f32 v189, v42, v43
    v_lshlrev_b32 v40, 16, v190
    v_and_b32 v41, 0xffff0000, v190
    s_waitcnt lgkmcnt(6)
    v_mfma_f32_32x32x16_bf16 a[48:63], v[180:183], v[16:19], a[48:63]
    ds_read_b64_tr_b16 v[32:33], v15 offset:51328
    ds_read_b64_tr_b16 v[34:35], v15 offset:52608
    v_lshlrev_b32 v42, 16, v191
    v_and_b32 v43, 0xffff0000, v191
    v_fma_f32 v40, v40, v12, v13
    v_fma_f32 v41, v41, v12, v13
    s_waitcnt lgkmcnt(6)
    v_mfma_f32_32x32x16_bf16 a[64:79], v[180:183], v[20:23], a[64:79]
    ds_read_b64_tr_b16 v[36:37], v15 offset:51392
    ds_read_b64_tr_b16 v[38:39], v15 offset:52672
    v_fma_f32 v42, v42, v12, v13
    v_fma_f32 v43, v43, v12, v13
    v_cvt_pk_bf16_f32 v190, v40, v41
    v_cvt_pk_bf16_f32 v191, v42, v43
    s_add_u32 m0, s18, 63488
    s_waitcnt lgkmcnt(6)
    v_mfma_f32_32x32x16_bf16 a[0:15], v[184:187], v[24:27], a[0:15]
    buffer_load_dwordx4 v5, s[24:27], s55 offen lds
    ds_read_b64_tr_b16 v[16:17], v15 offset:51456
    ds_read_b64_tr_b16 v[18:19], v15 offset:52736
    v_lshlrev_b32 v40, 16, v192
    v_and_b32 v41, 0xffff0000, v192
    v_lshlrev_b32 v42, 16, v193
    v_and_b32 v43, 0xffff0000, v193
    s_waitcnt lgkmcnt(6)
    v_mfma_f32_32x32x16_bf16 a[16:31], v[184:187], v[28:31], a[16:31]
    ds_read_b64_tr_b16 v[20:21], v15 offset:56320
    ds_read_b64_tr_b16 v[22:23], v15 offset:57600
    v_fma_f32 v40, v40, v12, v13
    v_fma_f32 v41, v41, v12, v13
    v_fma_f32 v42, v42, v12, v13
    v_fma_f32 v43, v43, v12, v13
    s_waitcnt lgkmcnt(6)
    v_mfma_f32_32x32x16_bf16 a[32:47], v[184:187], v[32:35], a[32:47]
    ds_read_b64_tr_b16 v[24:25], v15 offset:56384
    ds_read_b64_tr_b16 v[26:27], v15 offset:57664
    v_cvt_pk_bf16_f32 v192, v40, v41
    v_cvt_pk_bf16_f32 v193, v42, v43
    v_lshlrev_b32 v40, 16, v194
    v_and_b32 v41, 0xffff0000, v194
    s_waitcnt lgkmcnt(6)
    v_mfma_f32_32x32x16_bf16 a[48:63], v[184:187], v[36:39], a[48:63]
    ds_read_b64_tr_b16 v[28:29], v15 offset:56448
    ds_read_b64_tr_b16 v[30:31], v15 offset:57728
    v_lshlrev_b32 v42, 16, v195
    v_and_b32 v43, 0xffff0000, v195
    v_fma_f32 v40, v40, v12, v13
    v_fma_f32 v41, v41, v12, v13
    s_add_u32 m0, s18, 64512
    s_waitcnt lgkmcnt(6)
    v_mfma_f32_32x32x16_bf16 a[64:79], v[184:187], v[16:19], a[64:79]
    buffer_load_dwordx4 v6, s[24:27], s55 offen lds
    ds_read_b64_tr_b16 v[32:33], v15 offset:56512
    ds_read_b64_tr_b16 v[34:35], v15 offset:57792
    v_fma_f32 v42, v42, v12, v13
    v_fma_f32 v43, v43, v12, v13
    v_cvt_pk_bf16_f32 v194, v40, v41
    v_cvt_pk_bf16_f32 v195, v42, v43
    s_waitcnt lgkmcnt(6)
    v_mfma_f32_32x32x16_bf16 a[0:15], v[188:191], v[20:23], a[0:15]
    ds_read_b64_tr_b16 v[36:37], v15 offset:56576
    ds_read_b64_tr_b16 v[38:39], v15 offset:57856
    v_lshlrev_b32 v40, 16, v196
    v_and_b32 v41, 0xffff0000, v196
    v_lshlrev_b32 v42, 16, v197
    v_and_b32 v43, 0xffff0000, v197
    s_waitcnt lgkmcnt(6)
    v_mfma_f32_32x32x16_bf16 a[16:31], v[188:191], v[24:27], a[16:31]
    s_waitcnt vmcnt(14)
    s_barrier
    s_cmp_lg_u32 s14, 0
    s_cbranch_scc1 parallel_sum__linear_attn_block__dense_activation_relu__prompt_kernel_a_init_ok
    v_mov_b32 v68, 8
    s_mov_b64 exec, 1
    s_waitcnt vmcnt(10)
    v_cmp_ge_u32 vcc, v95, v68
    s_nop 3
    s_cmp_eq_u64 vcc, 1
    s_cbranch_scc1 parallel_sum__linear_attn_block__dense_activation_relu__prompt_kernel_a_init_done
    s_mov_b32 s42, 0
parallel_sum__linear_attn_block__dense_activation_relu__prompt_kernel_a_init_spin:
    buffer_load_dword v95, v1, s[32:35], 0 offen sc0 sc1
    s_waitcnt vmcnt(0)
    v_cmp_ge_u32 vcc, v95, v68
    s_add_u32 s42, s42, 1
    s_cmp_ge_u32 s42, 0x40000
    s_cbranch_scc1 parallel_sum__linear_attn_block__dense_activation_relu__prompt_kernel_a_init_done
    s_nop 0
    s_cmp_eq_u64 vcc, 1
    s_cbranch_scc0 parallel_sum__linear_attn_block__dense_activation_relu__prompt_kernel_a_init_spin
parallel_sum__linear_attn_block__dense_activation_relu__prompt_kernel_a_init_done:
    s_mov_b64 exec, -1
parallel_sum__linear_attn_block__dense_activation_relu__prompt_kernel_a_init_ok:
    ds_read_b64_tr_b16 v[16:17], v14 offset:0
    ds_read_b64_tr_b16 v[18:19], v14 offset:1280
    v_fma_f32 v40, v40, v12, v13
    v_fma_f32 v41, v41, v12, v13
    v_fma_f32 v42, v42, v12, v13
    v_fma_f32 v43, v43, v12, v13
    s_waitcnt lgkmcnt(6)
    v_mfma_f32_32x32x16_bf16 a[32:47], v[188:191], v[28:31], a[32:47]
    ds_read_b64_tr_b16 v[20:21], v14 offset:64
    ds_read_b64_tr_b16 v[22:23], v14 offset:1344
    v_cvt_pk_bf16_f32 v196, v40, v41
    v_cvt_pk_bf16_f32 v197, v42, v43
    v_lshlrev_b32 v40, 16, v198
    v_and_b32 v41, 0xffff0000, v198
    s_add_u32 m0, s18, 65536
    s_waitcnt lgkmcnt(6)
    v_mfma_f32_32x32x16_bf16 a[48:63], v[188:191], v[32:35], a[48:63]
    buffer_load_dwordx4 v7, s[24:27], s55 offen lds
    ds_read_b64_tr_b16 v[24:25], v14 offset:128
    ds_read_b64_tr_b16 v[26:27], v14 offset:1408
    v_lshlrev_b32 v42, 16, v199
    v_and_b32 v43, 0xffff0000, v199
    v_fma_f32 v40, v40, v12, v13
    v_fma_f32 v41, v41, v12, v13
    s_waitcnt lgkmcnt(6)
    v_mfma_f32_32x32x16_bf16 a[64:79], v[188:191], v[36:39], a[64:79]
    ds_read_b64_tr_b16 v[28:29], v14 offset:192
    ds_read_b64_tr_b16 v[30:31], v14 offset:1472
    v_fma_f32 v42, v42, v12, v13
    v_fma_f32 v43, v43, v12, v13
    v_cvt_pk_bf16_f32 v198, v40, v41
    v_cvt_pk_bf16_f32 v199, v42, v43
    s_waitcnt lgkmcnt(6)
    v_mfma_f32_32x32x16_bf16 a[0:15], v[192:195], v[16:19], a[0:15]
    ds_read_b64_tr_b16 v[32:33], v14 offset:256
    ds_read_b64_tr_b16 v[34:35], v14 offset:1536
    v_lshlrev_b32 v40, 16, v200
    v_and_b32 v41, 0xffff0000, v200
    v_lshlrev_b32 v42, 16, v201
    v_and_b32 v43, 0xffff0000, v201
    s_waitcnt lgkmcnt(6)
    v_mfma_f32_32x32x16_bf16 a[16:31], v[192:195], v[20:23], a[16:31]
    ds_read_b64_tr_b16 v[36:37], v14 offset:5120
    ds_read_b64_tr_b16 v[38:39], v14 offset:6400
    v_fma_f32 v40, v40, v12, v13
    v_fma_f32 v41, v41, v12, v13
    v_fma_f32 v42, v42, v12, v13
    v_fma_f32 v43, v43, v12, v13
    s_add_u32 s55, s37, 0
    s_add_u32 m0, s19, 81920
    s_waitcnt lgkmcnt(6)
    v_mfma_f32_32x32x16_bf16 a[32:47], v[192:195], v[24:27], a[32:47]
    buffer_load_dwordx4 v8, s[28:31], s55 offen lds
    ds_read_b64_tr_b16 v[16:17], v14 offset:5184
    ds_read_b64_tr_b16 v[18:19], v14 offset:6464
    v_cvt_pk_bf16_f32 v200, v40, v41
    v_cvt_pk_bf16_f32 v201, v42, v43
    v_lshlrev_b32 v40, 16, v202
    v_and_b32 v41, 0xffff0000, v202
    s_waitcnt lgkmcnt(6)
    v_mfma_f32_32x32x16_bf16 a[48:63], v[192:195], v[28:31], a[48:63]
    ds_read_b64_tr_b16 v[20:21], v14 offset:5248
    ds_read_b64_tr_b16 v[22:23], v14 offset:6528
    v_lshlrev_b32 v42, 16, v203
    v_and_b32 v43, 0xffff0000, v203
    v_fma_f32 v40, v40, v12, v13
    v_fma_f32 v41, v41, v12, v13
    s_waitcnt lgkmcnt(6)
    v_mfma_f32_32x32x16_bf16 a[64:79], v[192:195], v[32:35], a[64:79]
    ds_read_b64_tr_b16 v[24:25], v14 offset:5312
    ds_read_b64_tr_b16 v[26:27], v14 offset:6592
    v_fma_f32 v42, v42, v12, v13
    v_fma_f32 v43, v43, v12, v13
    v_cvt_pk_bf16_f32 v202, v40, v41
    v_cvt_pk_bf16_f32 v203, v42, v43
    s_waitcnt lgkmcnt(6)
    v_mfma_f32_32x32x16_bf16 a[0:15], v[196:199], v[36:39], a[0:15]
    ds_read_b64_tr_b16 v[28:29], v14 offset:5376
    ds_read_b64_tr_b16 v[30:31], v14 offset:6656
    v_lshlrev_b32 v40, 16, v204
    v_and_b32 v41, 0xffff0000, v204
    v_lshlrev_b32 v42, 16, v205
    v_and_b32 v43, 0xffff0000, v205
    s_add_u32 m0, s19, 82944
    s_waitcnt lgkmcnt(6)
    v_mfma_f32_32x32x16_bf16 a[16:31], v[196:199], v[16:19], a[16:31]
    buffer_load_dwordx4 v9, s[28:31], s55 offen lds
    ds_read_b64_tr_b16 v[32:33], v14 offset:10240
    ds_read_b64_tr_b16 v[34:35], v14 offset:11520
    v_fma_f32 v40, v40, v12, v13
    v_fma_f32 v41, v41, v12, v13
    v_fma_f32 v42, v42, v12, v13
    v_fma_f32 v43, v43, v12, v13
    s_waitcnt lgkmcnt(6)
    v_mfma_f32_32x32x16_bf16 a[32:47], v[196:199], v[20:23], a[32:47]
    ds_read_b64_tr_b16 v[36:37], v14 offset:10304
    ds_read_b64_tr_b16 v[38:39], v14 offset:11584
    v_cvt_pk_bf16_f32 v204, v40, v41
    v_cvt_pk_bf16_f32 v205, v42, v43
    v_lshlrev_b32 v40, 16, v206
    v_and_b32 v41, 0xffff0000, v206
    s_waitcnt lgkmcnt(6)
    v_mfma_f32_32x32x16_bf16 a[48:63], v[196:199], v[24:27], a[48:63]
    ds_read_b64_tr_b16 v[16:17], v14 offset:10368
    ds_read_b64_tr_b16 v[18:19], v14 offset:11648
    v_lshlrev_b32 v42, 16, v207
    v_and_b32 v43, 0xffff0000, v207
    v_fma_f32 v40, v40, v12, v13
    v_fma_f32 v41, v41, v12, v13
    s_waitcnt lgkmcnt(6)
    v_mfma_f32_32x32x16_bf16 a[64:79], v[196:199], v[28:31], a[64:79]
    ds_read_b64_tr_b16 v[20:21], v14 offset:10432
    ds_read_b64_tr_b16 v[22:23], v14 offset:11712
    v_fma_f32 v42, v42, v12, v13
    v_fma_f32 v43, v43, v12, v13
    v_cvt_pk_bf16_f32 v206, v40, v41
    v_cvt_pk_bf16_f32 v207, v42, v43
    s_add_u32 m0, s19, 83968
    s_waitcnt lgkmcnt(6)
    v_mfma_f32_32x32x16_bf16 a[0:15], v[200:203], v[32:35], a[0:15]
    buffer_load_dwordx4 v10, s[28:31], s55 offen lds
    ds_read_b64_tr_b16 v[24:25], v14 offset:10496
    ds_read_b64_tr_b16 v[26:27], v14 offset:11776
    v_lshlrev_b32 v40, 16, v208
    v_and_b32 v41, 0xffff0000, v208
    v_lshlrev_b32 v42, 16, v209
    v_and_b32 v43, 0xffff0000, v209
    s_waitcnt lgkmcnt(6)
    v_mfma_f32_32x32x16_bf16 a[16:31], v[200:203], v[36:39], a[16:31]
    ds_read_b64_tr_b16 v[28:29], v14 offset:15360
    ds_read_b64_tr_b16 v[30:31], v14 offset:16640
    v_fma_f32 v40, v40, v12, v13
    v_fma_f32 v41, v41, v12, v13
    v_fma_f32 v42, v42, v12, v13
    v_fma_f32 v43, v43, v12, v13
    s_waitcnt lgkmcnt(6)
    v_mfma_f32_32x32x16_bf16 a[32:47], v[200:203], v[16:19], a[32:47]
    ds_read_b64_tr_b16 v[32:33], v14 offset:15424
    ds_read_b64_tr_b16 v[34:35], v14 offset:16704
    v_cvt_pk_bf16_f32 v208, v40, v41
    v_cvt_pk_bf16_f32 v209, v42, v43
    v_lshlrev_b32 v40, 16, v210
    v_and_b32 v41, 0xffff0000, v210
    s_waitcnt lgkmcnt(6)
    v_mfma_f32_32x32x16_bf16 a[48:63], v[200:203], v[20:23], a[48:63]
    ds_read_b64_tr_b16 v[36:37], v14 offset:15488
    ds_read_b64_tr_b16 v[38:39], v14 offset:16768
    v_lshlrev_b32 v42, 16, v211
    v_and_b32 v43, 0xffff0000, v211
    v_fma_f32 v40, v40, v12, v13
    v_fma_f32 v41, v41, v12, v13
    s_waitcnt lgkmcnt(6)
    v_mfma_f32_32x32x16_bf16 a[64:79], v[200:203], v[24:27], a[64:79]
    ds_read_b64_tr_b16 v[16:17], v14 offset:15552
    ds_read_b64_tr_b16 v[18:19], v14 offset:16832
    v_fma_f32 v42, v42, v12, v13
    v_fma_f32 v43, v43, v12, v13
    v_cvt_pk_bf16_f32 v210, v40, v41
    v_cvt_pk_bf16_f32 v211, v42, v43
    s_waitcnt lgkmcnt(6)
    v_mfma_f32_32x32x16_bf16 a[0:15], v[204:207], v[28:31], a[0:15]
    ds_read_b64_tr_b16 v[20:21], v14 offset:15616
    ds_read_b64_tr_b16 v[22:23], v14 offset:16896
    v_lshlrev_b32 v40, 16, v212
    v_and_b32 v41, 0xffff0000, v212
    v_lshlrev_b32 v42, 16, v213
    v_and_b32 v43, 0xffff0000, v213
    s_waitcnt lgkmcnt(6)
    v_mfma_f32_32x32x16_bf16 a[16:31], v[204:207], v[32:35], a[16:31]
    s_waitcnt vmcnt(13)
    s_barrier
    ds_read_b64_tr_b16 v[24:25], v14 offset:20480
    ds_read_b64_tr_b16 v[26:27], v14 offset:21760
    v_fma_f32 v40, v40, v12, v13
    v_fma_f32 v41, v41, v12, v13
    v_fma_f32 v42, v42, v12, v13
    v_fma_f32 v43, v43, v12, v13
    s_add_u32 s55, s37, 221184
    s_add_u32 m0, s19, 102400
    s_waitcnt lgkmcnt(6)
    v_mfma_f32_32x32x16_bf16 a[32:47], v[204:207], v[36:39], a[32:47]
    buffer_load_dwordx4 v8, s[28:31], s55 offen lds
    ds_read_b64_tr_b16 v[28:29], v14 offset:20544
    ds_read_b64_tr_b16 v[30:31], v14 offset:21824
    v_cvt_pk_bf16_f32 v212, v40, v41
    v_cvt_pk_bf16_f32 v213, v42, v43
    v_lshlrev_b32 v40, 16, v214
    v_and_b32 v41, 0xffff0000, v214
    s_waitcnt lgkmcnt(6)
    v_mfma_f32_32x32x16_bf16 a[48:63], v[204:207], v[16:19], a[48:63]
    ds_read_b64_tr_b16 v[32:33], v14 offset:20608
    ds_read_b64_tr_b16 v[34:35], v14 offset:21888
    v_lshlrev_b32 v42, 16, v215
    v_and_b32 v43, 0xffff0000, v215
    v_fma_f32 v40, v40, v12, v13
    v_fma_f32 v41, v41, v12, v13
    s_waitcnt lgkmcnt(6)
    v_mfma_f32_32x32x16_bf16 a[64:79], v[204:207], v[20:23], a[64:79]
    ds_read_b64_tr_b16 v[36:37], v14 offset:20672
    ds_read_b64_tr_b16 v[38:39], v14 offset:21952
    v_fma_f32 v42, v42, v12, v13
    v_fma_f32 v43, v43, v12, v13
    v_cvt_pk_bf16_f32 v214, v40, v41
    v_cvt_pk_bf16_f32 v215, v42, v43
    s_waitcnt lgkmcnt(6)
    v_mfma_f32_32x32x16_bf16 a[0:15], v[208:211], v[24:27], a[0:15]
    ds_read_b64_tr_b16 v[16:17], v14 offset:20736
    ds_read_b64_tr_b16 v[18:19], v14 offset:22016
    v_lshlrev_b32 v40, 16, v216
    v_and_b32 v41, 0xffff0000, v216
    v_lshlrev_b32 v42, 16, v217
    v_and_b32 v43, 0xffff0000, v217
    s_add_u32 m0, s19, 103424
    s_waitcnt lgkmcnt(6)
    v_mfma_f32_32x32x16_bf16 a[16:31], v[208:211], v[28:31], a[16:31]
    buffer_load_dwordx4 v9, s[28:31], s55 offen lds
    ds_read_b64_tr_b16 v[20:21], v14 offset:25600
    ds_read_b64_tr_b16 v[22:23], v14 offset:26880
    v_fma_f32 v40, v40, v12, v13
    v_fma_f32 v41, v41, v12, v13
    v_fma_f32 v42, v42, v12, v13
    v_fma_f32 v43, v43, v12, v13
    s_waitcnt lgkmcnt(6)
    v_mfma_f32_32x32x16_bf16 a[32:47], v[208:211], v[32:35], a[32:47]
    ds_read_b64_tr_b16 v[24:25], v14 offset:25664
    ds_read_b64_tr_b16 v[26:27], v14 offset:26944
    v_cvt_pk_bf16_f32 v216, v40, v41
    v_cvt_pk_bf16_f32 v217, v42, v43
    v_lshlrev_b32 v40, 16, v218
    v_and_b32 v41, 0xffff0000, v218
    s_waitcnt lgkmcnt(6)
    v_mfma_f32_32x32x16_bf16 a[48:63], v[208:211], v[36:39], a[48:63]
    ds_read_b64_tr_b16 v[28:29], v14 offset:25728
    ds_read_b64_tr_b16 v[30:31], v14 offset:27008
    v_lshlrev_b32 v42, 16, v219
    v_and_b32 v43, 0xffff0000, v219
    v_fma_f32 v40, v40, v12, v13
    v_fma_f32 v41, v41, v12, v13
    s_waitcnt lgkmcnt(6)
    v_mfma_f32_32x32x16_bf16 a[64:79], v[208:211], v[16:19], a[64:79]
    ds_read_b64_tr_b16 v[32:33], v14 offset:25792
    ds_read_b64_tr_b16 v[34:35], v14 offset:27072
    v_fma_f32 v42, v42, v12, v13
    v_fma_f32 v43, v43, v12, v13
    v_cvt_pk_bf16_f32 v218, v40, v41
    v_cvt_pk_bf16_f32 v219, v42, v43
    s_add_u32 m0, s19, 104448
    s_waitcnt lgkmcnt(6)
    v_mfma_f32_32x32x16_bf16 a[0:15], v[212:215], v[20:23], a[0:15]
    buffer_load_dwordx4 v10, s[28:31], s55 offen lds
    ds_read_b64_tr_b16 v[36:37], v14 offset:25856
    ds_read_b64_tr_b16 v[38:39], v14 offset:27136
    v_lshlrev_b32 v40, 16, v220
    v_and_b32 v41, 0xffff0000, v220
    v_lshlrev_b32 v42, 16, v221
    v_and_b32 v43, 0xffff0000, v221
    s_waitcnt lgkmcnt(6)
    v_mfma_f32_32x32x16_bf16 a[16:31], v[212:215], v[24:27], a[16:31]
    ds_read_b64_tr_b16 v[16:17], v14 offset:30720
    ds_read_b64_tr_b16 v[18:19], v14 offset:32000
    v_fma_f32 v40, v40, v12, v13
    v_fma_f32 v41, v41, v12, v13
    v_fma_f32 v42, v42, v12, v13
    v_fma_f32 v43, v43, v12, v13
    s_waitcnt lgkmcnt(6)
    v_mfma_f32_32x32x16_bf16 a[32:47], v[212:215], v[28:31], a[32:47]
    ds_read_b64_tr_b16 v[20:21], v14 offset:30784
    ds_read_b64_tr_b16 v[22:23], v14 offset:32064
    v_cvt_pk_bf16_f32 v220, v40, v41
    v_cvt_pk_bf16_f32 v221, v42, v43
    v_lshlrev_b32 v40, 16, v222
    v_and_b32 v41, 0xffff0000, v222
    s_waitcnt lgkmcnt(6)
    v_mfma_f32_32x32x16_bf16 a[48:63], v[212:215], v[32:35], a[48:63]
    ds_read_b64_tr_b16 v[24:25], v14 offset:30848
    ds_read_b64_tr_b16 v[26:27], v14 offset:32128
    v_lshlrev_b32 v42, 16, v223
    v_and_b32 v43, 0xffff0000, v223
    v_fma_f32 v40, v40, v12, v13
    v_fma_f32 v41, v41, v12, v13
    s_waitcnt lgkmcnt(6)
    v_mfma_f32_32x32x16_bf16 a[64:79], v[212:215], v[36:39], a[64:79]
    ds_read_b64_tr_b16 v[28:29], v14 offset:30912
    ds_read_b64_tr_b16 v[30:31], v14 offset:32192
    v_fma_f32 v42, v42, v12, v13
    v_fma_f32 v43, v43, v12, v13
    v_cvt_pk_bf16_f32 v222, v40, v41
    v_cvt_pk_bf16_f32 v223, v42, v43
    s_waitcnt lgkmcnt(6)
    v_mfma_f32_32x32x16_bf16 a[0:15], v[216:219], v[16:19], a[0:15]
    ds_read_b64_tr_b16 v[32:33], v14 offset:30976
    ds_read_b64_tr_b16 v[34:35], v14 offset:32256
    v_lshlrev_b32 v40, 16, v224
    v_and_b32 v41, 0xffff0000, v224
    v_lshlrev_b32 v42, 16, v225
    v_and_b32 v43, 0xffff0000, v225
    s_waitcnt lgkmcnt(6)
    v_mfma_f32_32x32x16_bf16 a[16:31], v[216:219], v[20:23], a[16:31]
    ds_read_b64_tr_b16 v[36:37], v14 offset:35840
    ds_read_b64_tr_b16 v[38:39], v14 offset:37120
    v_fma_f32 v40, v40, v12, v13
    v_fma_f32 v41, v41, v12, v13
    v_fma_f32 v42, v42, v12, v13
    v_fma_f32 v43, v43, v12, v13
    s_waitcnt lgkmcnt(6)
    v_mfma_f32_32x32x16_bf16 a[32:47], v[216:219], v[24:27], a[32:47]
    ds_read_b64_tr_b16 v[16:17], v14 offset:35904
    ds_read_b64_tr_b16 v[18:19], v14 offset:37184
    v_cvt_pk_bf16_f32 v224, v40, v41
    v_cvt_pk_bf16_f32 v225, v42, v43
    v_lshlrev_b32 v40, 16, v226
    v_and_b32 v41, 0xffff0000, v226
    s_waitcnt lgkmcnt(6)
    v_mfma_f32_32x32x16_bf16 a[48:63], v[216:219], v[28:31], a[48:63]
    ds_read_b64_tr_b16 v[20:21], v14 offset:35968
    ds_read_b64_tr_b16 v[22:23], v14 offset:37248
    v_lshlrev_b32 v42, 16, v227
    v_and_b32 v43, 0xffff0000, v227
    v_fma_f32 v40, v40, v12, v13
    v_fma_f32 v41, v41, v12, v13
    s_waitcnt lgkmcnt(6)
    v_mfma_f32_32x32x16_bf16 a[64:79], v[216:219], v[32:35], a[64:79]
    ds_read_b64_tr_b16 v[24:25], v14 offset:36032
    ds_read_b64_tr_b16 v[26:27], v14 offset:37312
    v_fma_f32 v42, v42, v12, v13
    v_fma_f32 v43, v43, v12, v13
    v_cvt_pk_bf16_f32 v226, v40, v41
    v_cvt_pk_bf16_f32 v227, v42, v43
    s_waitcnt lgkmcnt(6)
    v_mfma_f32_32x32x16_bf16 a[0:15], v[220:223], v[36:39], a[0:15]
    ds_read_b64_tr_b16 v[28:29], v14 offset:36096
    ds_read_b64_tr_b16 v[30:31], v14 offset:37376
    v_lshlrev_b32 v40, 16, v228
    v_and_b32 v41, 0xffff0000, v228
    v_lshlrev_b32 v42, 16, v229
    v_and_b32 v43, 0xffff0000, v229
    s_waitcnt lgkmcnt(6)
    v_mfma_f32_32x32x16_bf16 a[16:31], v[220:223], v[16:19], a[16:31]
    s_waitcnt vmcnt(11)
    s_barrier
    ds_read_b64_tr_b16 v[32:33], v14 offset:40960
    ds_read_b64_tr_b16 v[34:35], v14 offset:42240
    v_fma_f32 v40, v40, v12, v13
    v_fma_f32 v41, v41, v12, v13
    v_fma_f32 v42, v42, v12, v13
    v_fma_f32 v43, v43, v12, v13
    s_add_u32 s55, s37, 442368
    s_add_u32 m0, s19, 0
    s_waitcnt lgkmcnt(6)
    v_mfma_f32_32x32x16_bf16 a[32:47], v[220:223], v[20:23], a[32:47]
    buffer_load_dwordx4 v8, s[28:31], s55 offen lds
    ds_read_b64_tr_b16 v[36:37], v14 offset:41024
    ds_read_b64_tr_b16 v[38:39], v14 offset:42304
    v_cvt_pk_bf16_f32 v228, v40, v41
    v_cvt_pk_bf16_f32 v229, v42, v43
    v_lshlrev_b32 v40, 16, v230
    v_and_b32 v41, 0xffff0000, v230
    s_waitcnt lgkmcnt(6)
    v_mfma_f32_32x32x16_bf16 a[48:63], v[220:223], v[24:27], a[48:63]
    ds_read_b64_tr_b16 v[16:17], v14 offset:41088
    ds_read_b64_tr_b16 v[18:19], v14 offset:42368
    v_lshlrev_b32 v42, 16, v231
    v_and_b32 v43, 0xffff0000, v231
    v_fma_f32 v40, v40, v12, v13
    v_fma_f32 v41, v41, v12, v13
    s_waitcnt lgkmcnt(6)
    v_mfma_f32_32x32x16_bf16 a[64:79], v[220:223], v[28:31], a[64:79]
    ds_read_b64_tr_b16 v[20:21], v14 offset:41152
    ds_read_b64_tr_b16 v[22:23], v14 offset:42432
    v_fma_f32 v42, v42, v12, v13
    v_fma_f32 v43, v43, v12, v13
    v_cvt_pk_bf16_f32 v230, v40, v41
    v_cvt_pk_bf16_f32 v231, v42, v43
    s_waitcnt lgkmcnt(6)
    v_mfma_f32_32x32x16_bf16 a[0:15], v[224:227], v[32:35], a[0:15]
    ds_read_b64_tr_b16 v[24:25], v14 offset:41216
    ds_read_b64_tr_b16 v[26:27], v14 offset:42496
    v_lshlrev_b32 v40, 16, v232
    v_and_b32 v41, 0xffff0000, v232
    v_lshlrev_b32 v42, 16, v233
    v_and_b32 v43, 0xffff0000, v233
    s_add_u32 m0, s19, 1024
    s_waitcnt lgkmcnt(6)
    v_mfma_f32_32x32x16_bf16 a[16:31], v[224:227], v[36:39], a[16:31]
    buffer_load_dwordx4 v9, s[28:31], s55 offen lds
    ds_read_b64_tr_b16 v[28:29], v14 offset:46080
    ds_read_b64_tr_b16 v[30:31], v14 offset:47360
    v_fma_f32 v40, v40, v12, v13
    v_fma_f32 v41, v41, v12, v13
    v_fma_f32 v42, v42, v12, v13
    v_fma_f32 v43, v43, v12, v13
    s_waitcnt lgkmcnt(6)
    v_mfma_f32_32x32x16_bf16 a[32:47], v[224:227], v[16:19], a[32:47]
    ds_read_b64_tr_b16 v[32:33], v14 offset:46144
    ds_read_b64_tr_b16 v[34:35], v14 offset:47424
    v_cvt_pk_bf16_f32 v232, v40, v41
    v_cvt_pk_bf16_f32 v233, v42, v43
    v_lshlrev_b32 v40, 16, v234
    v_and_b32 v41, 0xffff0000, v234
    s_waitcnt lgkmcnt(6)
    v_mfma_f32_32x32x16_bf16 a[48:63], v[224:227], v[20:23], a[48:63]
    ds_read_b64_tr_b16 v[36:37], v14 offset:46208
    ds_read_b64_tr_b16 v[38:39], v14 offset:47488
    v_lshlrev_b32 v42, 16, v235
    v_and_b32 v43, 0xffff0000, v235
    v_fma_f32 v40, v40, v12, v13
    v_fma_f32 v41, v41, v12, v13
    s_waitcnt lgkmcnt(6)
    v_mfma_f32_32x32x16_bf16 a[64:79], v[224:227], v[24:27], a[64:79]
    ds_read_b64_tr_b16 v[16:17], v14 offset:46272
    ds_read_b64_tr_b16 v[18:19], v14 offset:47552
    v_fma_f32 v42, v42, v12, v13
    v_fma_f32 v43, v43, v12, v13
    v_cvt_pk_bf16_f32 v234, v40, v41
    v_cvt_pk_bf16_f32 v235, v42, v43
    s_add_u32 m0, s19, 2048
    s_waitcnt lgkmcnt(6)
    v_mfma_f32_32x32x16_bf16 a[0:15], v[228:231], v[28:31], a[0:15]
    buffer_load_dwordx4 v10, s[28:31], s55 offen lds
    ds_read_b64_tr_b16 v[20:21], v14 offset:46336
    ds_read_b64_tr_b16 v[22:23], v14 offset:47616
    v_lshlrev_b32 v40, 16, v236
    v_and_b32 v41, 0xffff0000, v236
    v_lshlrev_b32 v42, 16, v237
    v_and_b32 v43, 0xffff0000, v237
    s_waitcnt lgkmcnt(6)
    v_mfma_f32_32x32x16_bf16 a[16:31], v[228:231], v[32:35], a[16:31]
    ds_read_b64_tr_b16 v[24:25], v14 offset:51200
    ds_read_b64_tr_b16 v[26:27], v14 offset:52480
    v_fma_f32 v40, v40, v12, v13
    v_fma_f32 v41, v41, v12, v13
    v_fma_f32 v42, v42, v12, v13
    v_fma_f32 v43, v43, v12, v13
    s_waitcnt lgkmcnt(6)
    v_mfma_f32_32x32x16_bf16 a[32:47], v[228:231], v[36:39], a[32:47]
    ds_read_b64_tr_b16 v[28:29], v14 offset:51264
    ds_read_b64_tr_b16 v[30:31], v14 offset:52544
    v_cvt_pk_bf16_f32 v236, v40, v41
    v_cvt_pk_bf16_f32 v237, v42, v43
    v_lshlrev_b32 v40, 16, v238
    v_and_b32 v41, 0xffff0000, v238
    s_waitcnt lgkmcnt(6)
    v_mfma_f32_32x32x16_bf16 a[48:63], v[228:231], v[16:19], a[48:63]
    ds_read_b64_tr_b16 v[32:33], v14 offset:51328
    ds_read_b64_tr_b16 v[34:35], v14 offset:52608
    v_lshlrev_b32 v42, 16, v239
    v_and_b32 v43, 0xffff0000, v239
    v_fma_f32 v40, v40, v12, v13
    v_fma_f32 v41, v41, v12, v13
    s_waitcnt lgkmcnt(6)
    v_mfma_f32_32x32x16_bf16 a[64:79], v[228:231], v[20:23], a[64:79]
    ds_read_b64_tr_b16 v[36:37], v14 offset:51392
    ds_read_b64_tr_b16 v[38:39], v14 offset:52672
    v_fma_f32 v42, v42, v12, v13
    v_fma_f32 v43, v43, v12, v13
    v_cvt_pk_bf16_f32 v238, v40, v41
    v_cvt_pk_bf16_f32 v239, v42, v43
    s_waitcnt lgkmcnt(6)
    v_mfma_f32_32x32x16_bf16 a[0:15], v[232:235], v[24:27], a[0:15]
    ds_read_b64_tr_b16 v[16:17], v14 offset:51456
    ds_read_b64_tr_b16 v[18:19], v14 offset:52736
    v_lshlrev_b32 v40, 16, v240
    v_and_b32 v41, 0xffff0000, v240
    v_lshlrev_b32 v42, 16, v241
    v_and_b32 v43, 0xffff0000, v241
    s_waitcnt lgkmcnt(6)
    v_mfma_f32_32x32x16_bf16 a[16:31], v[232:235], v[28:31], a[16:31]
    ds_read_b64_tr_b16 v[20:21], v14 offset:56320
    ds_read_b64_tr_b16 v[22:23], v14 offset:57600
    v_fma_f32 v40, v40, v12, v13
    v_fma_f32 v41, v41, v12, v13
    v_fma_f32 v42, v42, v12, v13
    v_fma_f32 v43, v43, v12, v13
    s_waitcnt lgkmcnt(6)
    v_mfma_f32_32x32x16_bf16 a[32:47], v[232:235], v[32:35], a[32:47]
    ds_read_b64_tr_b16 v[24:25], v14 offset:56384
    ds_read_b64_tr_b16 v[26:27], v14 offset:57664
    v_cvt_pk_bf16_f32 v240, v40, v41
    v_cvt_pk_bf16_f32 v241, v42, v43
    v_lshlrev_b32 v40, 16, v242
    v_and_b32 v41, 0xffff0000, v242
    s_waitcnt lgkmcnt(6)
    v_mfma_f32_32x32x16_bf16 a[48:63], v[232:235], v[36:39], a[48:63]
    ds_read_b64_tr_b16 v[28:29], v14 offset:56448
    ds_read_b64_tr_b16 v[30:31], v14 offset:57728
    v_lshlrev_b32 v42, 16, v243
    v_and_b32 v43, 0xffff0000, v243
    v_fma_f32 v40, v40, v12, v13
    v_fma_f32 v41, v41, v12, v13
    s_waitcnt lgkmcnt(6)
    v_mfma_f32_32x32x16_bf16 a[64:79], v[232:235], v[16:19], a[64:79]
    ds_read_b64_tr_b16 v[32:33], v14 offset:56512
    ds_read_b64_tr_b16 v[34:35], v14 offset:57792
    v_fma_f32 v42, v42, v12, v13
    v_fma_f32 v43, v43, v12, v13
    v_cvt_pk_bf16_f32 v242, v40, v41
    v_cvt_pk_bf16_f32 v243, v42, v43
    s_waitcnt lgkmcnt(6)
    v_mfma_f32_32x32x16_bf16 a[0:15], v[236:239], v[20:23], a[0:15]
    ds_read_b64_tr_b16 v[36:37], v14 offset:56576
    ds_read_b64_tr_b16 v[38:39], v14 offset:57856
    v_lshlrev_b32 v40, 16, v244
    v_and_b32 v41, 0xffff0000, v244
    v_lshlrev_b32 v42, 16, v245
    v_and_b32 v43, 0xffff0000, v245
    s_waitcnt lgkmcnt(6)
    v_mfma_f32_32x32x16_bf16 a[16:31], v[236:239], v[24:27], a[16:31]
    s_waitcnt vmcnt(9)
    s_barrier
    ds_read_b64_tr_b16 v[16:17], v15 offset:0
    ds_read_b64_tr_b16 v[18:19], v15 offset:1280
    v_fma_f32 v40, v40, v12, v13
    v_fma_f32 v41, v41, v12, v13
    v_fma_f32 v42, v42, v12, v13
    v_fma_f32 v43, v43, v12, v13
    s_add_u32 s55, s37, 663552
    s_add_u32 m0, s19, 20480
    s_waitcnt lgkmcnt(6)
    v_mfma_f32_32x32x16_bf16 a[32:47], v[236:239], v[28:31], a[32:47]
    buffer_load_dwordx4 v8, s[28:31], s55 offen lds
    ds_read_b64_tr_b16 v[20:21], v15 offset:64
    ds_read_b64_tr_b16 v[22:23], v15 offset:1344
    v_cvt_pk_bf16_f32 v244, v40, v41
    v_cvt_pk_bf16_f32 v245, v42, v43
    v_lshlrev_b32 v40, 16, v246
    v_and_b32 v41, 0xffff0000, v246
    s_waitcnt lgkmcnt(6)
    v_mfma_f32_32x32x16_bf16 a[48:63], v[236:239], v[32:35], a[48:63]
    ds_read_b64_tr_b16 v[24:25], v15 offset:128
    ds_read_b64_tr_b16 v[26:27], v15 offset:1408
    v_lshlrev_b32 v42, 16, v247
    v_and_b32 v43, 0xffff0000, v247
    v_fma_f32 v40, v40, v12, v13
    v_fma_f32 v41, v41, v12, v13
    s_waitcnt lgkmcnt(6)
    v_mfma_f32_32x32x16_bf16 a[64:79], v[236:239], v[36:39], a[64:79]
    ds_read_b64_tr_b16 v[28:29], v15 offset:192
    ds_read_b64_tr_b16 v[30:31], v15 offset:1472
    v_fma_f32 v42, v42, v12, v13
    v_fma_f32 v43, v43, v12, v13
    v_cvt_pk_bf16_f32 v246, v40, v41
    v_cvt_pk_bf16_f32 v247, v42, v43
    s_waitcnt lgkmcnt(6)
    v_mfma_f32_32x32x16_bf16 a[0:15], v[240:243], v[16:19], a[0:15]
    ds_read_b64_tr_b16 v[32:33], v15 offset:256
    ds_read_b64_tr_b16 v[34:35], v15 offset:1536
    v_lshlrev_b32 v40, 16, v248
    v_and_b32 v41, 0xffff0000, v248
    v_lshlrev_b32 v42, 16, v249
    v_and_b32 v43, 0xffff0000, v249
    s_add_u32 m0, s19, 21504
    s_waitcnt lgkmcnt(6)
    v_mfma_f32_32x32x16_bf16 a[16:31], v[240:243], v[20:23], a[16:31]
    buffer_load_dwordx4 v9, s[28:31], s55 offen lds
    ds_read_b64_tr_b16 v[36:37], v15 offset:5120
    ds_read_b64_tr_b16 v[38:39], v15 offset:6400
    v_fma_f32 v40, v40, v12, v13
    v_fma_f32 v41, v41, v12, v13
    v_fma_f32 v42, v42, v12, v13
    v_fma_f32 v43, v43, v12, v13
    s_waitcnt lgkmcnt(6)
    v_mfma_f32_32x32x16_bf16 a[32:47], v[240:243], v[24:27], a[32:47]
    ds_read_b64_tr_b16 v[16:17], v15 offset:5184
    ds_read_b64_tr_b16 v[18:19], v15 offset:6464
    v_cvt_pk_bf16_f32 v248, v40, v41
    v_cvt_pk_bf16_f32 v249, v42, v43
    v_lshlrev_b32 v40, 16, v250
    v_and_b32 v41, 0xffff0000, v250
    s_waitcnt lgkmcnt(6)
    v_mfma_f32_32x32x16_bf16 a[48:63], v[240:243], v[28:31], a[48:63]
    ds_read_b64_tr_b16 v[20:21], v15 offset:5248
    ds_read_b64_tr_b16 v[22:23], v15 offset:6528
    v_lshlrev_b32 v42, 16, v251
    v_and_b32 v43, 0xffff0000, v251
    v_fma_f32 v40, v40, v12, v13
    v_fma_f32 v41, v41, v12, v13
    s_waitcnt lgkmcnt(6)
    v_mfma_f32_32x32x16_bf16 a[64:79], v[240:243], v[32:35], a[64:79]
    ds_read_b64_tr_b16 v[24:25], v15 offset:5312
    ds_read_b64_tr_b16 v[26:27], v15 offset:6592
    v_fma_f32 v42, v42, v12, v13
    v_fma_f32 v43, v43, v12, v13
    v_cvt_pk_bf16_f32 v250, v40, v41
    v_cvt_pk_bf16_f32 v251, v42, v43
    s_add_u32 m0, s19, 22528
    s_waitcnt lgkmcnt(6)
    v_mfma_f32_32x32x16_bf16 a[0:15], v[244:247], v[36:39], a[0:15]
    buffer_load_dwordx4 v10, s[28:31], s55 offen lds
    ds_read_b64_tr_b16 v[28:29], v15 offset:5376
    ds_read_b64_tr_b16 v[30:31], v15 offset:6656
    v_lshlrev_b32 v40, 16, v252
    v_and_b32 v41, 0xffff0000, v252
    v_lshlrev_b32 v42, 16, v253
    v_and_b32 v43, 0xffff0000, v253
    s_waitcnt lgkmcnt(6)
    v_mfma_f32_32x32x16_bf16 a[16:31], v[244:247], v[16:19], a[16:31]
    ds_read_b64_tr_b16 v[32:33], v15 offset:10240
    ds_read_b64_tr_b16 v[34:35], v15 offset:11520
    v_fma_f32 v40, v40, v12, v13
    v_fma_f32 v41, v41, v12, v13
    v_fma_f32 v42, v42, v12, v13
    v_fma_f32 v43, v43, v12, v13
    s_waitcnt lgkmcnt(6)
    v_mfma_f32_32x32x16_bf16 a[32:47], v[244:247], v[20:23], a[32:47]
    ds_read_b64_tr_b16 v[36:37], v15 offset:10304
    ds_read_b64_tr_b16 v[38:39], v15 offset:11584
    v_cvt_pk_bf16_f32 v252, v40, v41
    v_cvt_pk_bf16_f32 v253, v42, v43
    v_lshlrev_b32 v40, 16, v254
    v_and_b32 v41, 0xffff0000, v254
    s_waitcnt lgkmcnt(6)
    v_mfma_f32_32x32x16_bf16 a[48:63], v[244:247], v[24:27], a[48:63]
    ds_read_b64_tr_b16 v[16:17], v15 offset:10368
    ds_read_b64_tr_b16 v[18:19], v15 offset:11648
    v_lshlrev_b32 v42, 16, v255
    v_and_b32 v43, 0xffff0000, v255
    v_fma_f32 v40, v40, v12, v13
    v_fma_f32 v41, v41, v12, v13
    s_waitcnt lgkmcnt(6)
    v_mfma_f32_32x32x16_bf16 a[64:79], v[244:247], v[28:31], a[64:79]
    ds_read_b64_tr_b16 v[20:21], v15 offset:10432
    ds_read_b64_tr_b16 v[22:23], v15 offset:11712
    v_fma_f32 v42, v42, v12, v13
    v_fma_f32 v43, v43, v12, v13
    v_cvt_pk_bf16_f32 v254, v40, v41
    v_cvt_pk_bf16_f32 v255, v42, v43
    s_waitcnt lgkmcnt(6)
    v_mfma_f32_32x32x16_bf16 a[0:15], v[248:251], v[32:35], a[0:15]
    ds_read_b64_tr_b16 v[24:25], v15 offset:10496
    ds_read_b64_tr_b16 v[26:27], v15 offset:11776
    s_waitcnt lgkmcnt(6)
    v_mfma_f32_32x32x16_bf16 a[16:31], v[248:251], v[36:39], a[16:31]
    ds_read_b64_tr_b16 v[28:29], v15 offset:15360
    ds_read_b64_tr_b16 v[30:31], v15 offset:16640
    s_waitcnt lgkmcnt(6)
    v_mfma_f32_32x32x16_bf16 a[32:47], v[248:251], v[16:19], a[32:47]
    ds_read_b64_tr_b16 v[32:33], v15 offset:15424
    ds_read_b64_tr_b16 v[34:35], v15 offset:16704
    s_waitcnt lgkmcnt(6)
    v_mfma_f32_32x32x16_bf16 a[48:63], v[248:251], v[20:23], a[48:63]
    ds_read_b64_tr_b16 v[36:37], v15 offset:15488
    ds_read_b64_tr_b16 v[38:39], v15 offset:16768
    s_waitcnt lgkmcnt(6)
    v_mfma_f32_32x32x16_bf16 a[64:79], v[248:251], v[24:27], a[64:79]
    ds_read_b64_tr_b16 v[16:17], v15 offset:15552
    ds_read_b64_tr_b16 v[18:19], v15 offset:16832
    s_waitcnt lgkmcnt(6)
    v_mfma_f32_32x32x16_bf16 a[0:15], v[252:255], v[28:31], a[0:15]
    ds_read_b64_tr_b16 v[20:21], v15 offset:15616
    ds_read_b64_tr_b16 v[22:23], v15 offset:16896
    s_waitcnt lgkmcnt(6)
    v_mfma_f32_32x32x16_bf16 a[16:31], v[252:255], v[32:35], a[16:31]
    s_waitcnt lgkmcnt(4)
    v_mfma_f32_32x32x16_bf16 a[32:47], v[252:255], v[36:39], a[32:47]
    s_waitcnt lgkmcnt(2)
    v_mfma_f32_32x32x16_bf16 a[48:63], v[252:255], v[16:19], a[48:63]
    s_waitcnt lgkmcnt(0)
    v_mfma_f32_32x32x16_bf16 a[64:79], v[252:255], v[20:23], a[64:79]
    s_nop 7
    v_accvgpr_read_b32 v16, a32
    v_accvgpr_read_b32 v17, a33
    v_accvgpr_read_b32 v18, a34
    v_accvgpr_read_b32 v19, a35
    v_accvgpr_read_b32 v20, a36
    v_accvgpr_read_b32 v21, a37
    v_accvgpr_read_b32 v22, a38
    v_accvgpr_read_b32 v23, a39
    v_accvgpr_read_b32 v24, a40
    v_accvgpr_read_b32 v25, a41
    v_accvgpr_read_b32 v26, a42
    v_accvgpr_read_b32 v27, a43
    v_accvgpr_read_b32 v28, a44
    v_accvgpr_read_b32 v29, a45
    v_accvgpr_read_b32 v30, a46
    v_accvgpr_read_b32 v31, a47
    v_cvt_pk_bf16_f32 v64, v16, v17
    v_cvt_pk_bf16_f32 v65, v18, v19
    v_cvt_pk_bf16_f32 v66, v20, v21
    v_cvt_pk_bf16_f32 v67, v22, v23
    v_cvt_pk_bf16_f32 v68, v24, v25
    v_cvt_pk_bf16_f32 v69, v26, v27
    v_cvt_pk_bf16_f32 v70, v28, v29
    v_cvt_pk_bf16_f32 v71, v30, v31
    v_accvgpr_read_b32 v16, a48
    v_accvgpr_read_b32 v17, a49
    v_accvgpr_read_b32 v18, a50
    v_accvgpr_read_b32 v19, a51
    v_accvgpr_read_b32 v20, a52
    v_accvgpr_read_b32 v21, a53
    v_accvgpr_read_b32 v22, a54
    v_accvgpr_read_b32 v23, a55
    v_accvgpr_read_b32 v24, a56
    v_accvgpr_read_b32 v25, a57
    v_accvgpr_read_b32 v26, a58
    v_accvgpr_read_b32 v27, a59
    v_accvgpr_read_b32 v28, a60
    v_accvgpr_read_b32 v29, a61
    v_accvgpr_read_b32 v30, a62
    v_accvgpr_read_b32 v31, a63
    v_cvt_pk_bf16_f32 v72, v16, v17
    v_cvt_pk_bf16_f32 v73, v18, v19
    v_cvt_pk_bf16_f32 v74, v20, v21
    v_cvt_pk_bf16_f32 v75, v22, v23
    v_cvt_pk_bf16_f32 v76, v24, v25
    v_cvt_pk_bf16_f32 v77, v26, v27
    v_cvt_pk_bf16_f32 v78, v28, v29
    v_cvt_pk_bf16_f32 v79, v30, v31
    v_accvgpr_read_b32 v16, a64
    v_accvgpr_read_b32 v17, a65
    v_accvgpr_read_b32 v18, a66
    v_accvgpr_read_b32 v19, a67
    v_accvgpr_read_b32 v20, a68
    v_accvgpr_read_b32 v21, a69
    v_accvgpr_read_b32 v22, a70
    v_accvgpr_read_b32 v23, a71
    v_accvgpr_read_b32 v24, a72
    v_accvgpr_read_b32 v25, a73
    v_accvgpr_read_b32 v26, a74
    v_accvgpr_read_b32 v27, a75
    v_accvgpr_read_b32 v28, a76
    v_accvgpr_read_b32 v29, a77
    v_accvgpr_read_b32 v30, a78
    v_accvgpr_read_b32 v31, a79
    v_cvt_pk_bf16_f32 v80, v16, v17
    v_cvt_pk_bf16_f32 v81, v18, v19
    v_cvt_pk_bf16_f32 v82, v20, v21
    v_cvt_pk_bf16_f32 v83, v22, v23
    v_cvt_pk_bf16_f32 v84, v24, v25
    v_cvt_pk_bf16_f32 v85, v26, v27
    v_cvt_pk_bf16_f32 v86, v28, v29
    v_cvt_pk_bf16_f32 v87, v30, v31
    v_mov_b32 v32, 0x3f803f80
    v_cndmask_b32 v64, v64, v32, s[62:63]
    v_cndmask_b32 v65, v65, v32, s[62:63]
    v_cndmask_b32 v66, v66, v32, s[62:63]
    v_cndmask_b32 v67, v67, v32, s[62:63]
    v_cndmask_b32 v68, v68, v32, s[62:63]
    v_cndmask_b32 v69, v69, v32, s[62:63]
    v_cndmask_b32 v70, v70, v32, s[62:63]
    v_cndmask_b32 v71, v71, v32, s[62:63]
    v_accvgpr_read_b32 v16, a0
    v_accvgpr_read_b32 v17, a1
    v_accvgpr_read_b32 v18, a2
    v_accvgpr_read_b32 v19, a3
    v_accvgpr_read_b32 v20, a4
    v_accvgpr_read_b32 v21, a5
    v_accvgpr_read_b32 v22, a6
    v_accvgpr_read_b32 v23, a7
    v_accvgpr_read_b32 v24, a8
    v_accvgpr_read_b32 v25, a9
    v_accvgpr_read_b32 v26, a10
    v_accvgpr_read_b32 v27, a11
    v_accvgpr_read_b32 v28, a12
    v_accvgpr_read_b32 v29, a13
    v_accvgpr_read_b32 v30, a14
    v_accvgpr_read_b32 v31, a15
    v_min_f32 v32, 0, v16
    v_min_f32 v33, 0, v17
    v_min_f32 v34, 0, v18
    v_min_f32 v35, 0, v19
    v_min_f32 v36, 0, v20
    v_min_f32 v37, 0, v21
    v_min_f32 v38, 0, v22
    v_min_f32 v39, 0, v23
    v_mul_f32 v32, s57, v32
    v_mul_f32 v33, s57, v33
    v_mul_f32 v34, s57, v34
    v_mul_f32 v35, s57, v35
    v_mul_f32 v36, s57, v36
    v_mul_f32 v37, s57, v37
    v_mul_f32 v38, s57, v38
    v_mul_f32 v39, s57, v39
    v_exp_f32 v32, v32
    v_exp_f32 v33, v33
    v_exp_f32 v34, v34
    v_exp_f32 v35, v35
    v_exp_f32 v36, v36
    v_exp_f32 v37, v37
    v_exp_f32 v38, v38
    v_exp_f32 v39, v39
    v_max_f32 v16, 0, v16
    v_max_f32 v17, 0, v17
    v_max_f32 v18, 0, v18
    v_max_f32 v19, 0, v19
    v_max_f32 v20, 0, v20
    v_max_f32 v21, 0, v21
    v_max_f32 v22, 0, v22
    v_max_f32 v23, 0, v23
    v_add_f32 v16, s56, v16
    v_add_f32 v17, s56, v17
    v_add_f32 v18, s56, v18
    v_add_f32 v19, s56, v19
    v_add_f32 v20, s56, v20
    v_add_f32 v21, s56, v21
    v_add_f32 v22, s56, v22
    v_add_f32 v23, s56, v23
    v_add_f32 v16, v16, v32
    v_add_f32 v17, v17, v33
    v_add_f32 v18, v18, v34
    v_add_f32 v19, v19, v35
    v_add_f32 v20, v20, v36
    v_add_f32 v21, v21, v37
    v_add_f32 v22, v22, v38
    v_add_f32 v23, v23, v39
    v_min_f32 v32, 0, v24
    v_min_f32 v33, 0, v25
    v_min_f32 v34, 0, v26
    v_min_f32 v35, 0, v27
    v_min_f32 v36, 0, v28
    v_min_f32 v37, 0, v29
    v_min_f32 v38, 0, v30
    v_min_f32 v39, 0, v31
    v_mul_f32 v32, s57, v32
    v_mul_f32 v33, s57, v33
    v_mul_f32 v34, s57, v34
    v_mul_f32 v35, s57, v35
    v_mul_f32 v36, s57, v36
    v_mul_f32 v37, s57, v37
    v_mul_f32 v38, s57, v38
    v_mul_f32 v39, s57, v39
    v_exp_f32 v32, v32
    v_exp_f32 v33, v33
    v_exp_f32 v34, v34
    v_exp_f32 v35, v35
    v_exp_f32 v36, v36
    v_exp_f32 v37, v37
    v_exp_f32 v38, v38
    v_exp_f32 v39, v39
    v_max_f32 v24, 0, v24
    v_max_f32 v25, 0, v25
    v_max_f32 v26, 0, v26
    v_max_f32 v27, 0, v27
    v_max_f32 v28, 0, v28
    v_max_f32 v29, 0, v29
    v_max_f32 v30, 0, v30
    v_max_f32 v31, 0, v31
    v_add_f32 v24, s56, v24
    v_add_f32 v25, s56, v25
    v_add_f32 v26, s56, v26
    v_add_f32 v27, s56, v27
    v_add_f32 v28, s56, v28
    v_add_f32 v29, s56, v29
    v_add_f32 v30, s56, v30
    v_add_f32 v31, s56, v31
    v_add_f32 v24, v24, v32
    v_add_f32 v25, v25, v33
    v_add_f32 v26, v26, v34
    v_add_f32 v27, v27, v35
    v_add_f32 v28, v28, v36
    v_add_f32 v29, v29, v37
    v_add_f32 v30, v30, v38
    v_add_f32 v31, v31, v39
    v_cvt_pk_bf16_f32 v40, v16, v17
    v_cvt_pk_bf16_f32 v41, v18, v19
    v_cvt_pk_bf16_f32 v42, v20, v21
    v_cvt_pk_bf16_f32 v43, v22, v23
    v_cvt_pk_bf16_f32 v44, v24, v25
    v_cvt_pk_bf16_f32 v45, v26, v27
    v_cvt_pk_bf16_f32 v46, v28, v29
    v_cvt_pk_bf16_f32 v47, v30, v31
    v_accvgpr_read_b32 v16, a16
    v_accvgpr_read_b32 v17, a17
    v_accvgpr_read_b32 v18, a18
    v_accvgpr_read_b32 v19, a19
    v_accvgpr_read_b32 v20, a20
    v_accvgpr_read_b32 v21, a21
    v_accvgpr_read_b32 v22, a22
    v_accvgpr_read_b32 v23, a23
    v_accvgpr_read_b32 v24, a24
    v_accvgpr_read_b32 v25, a25
    v_accvgpr_read_b32 v26, a26
    v_accvgpr_read_b32 v27, a27
    v_accvgpr_read_b32 v28, a28
    v_accvgpr_read_b32 v29, a29
    v_accvgpr_read_b32 v30, a30
    v_accvgpr_read_b32 v31, a31
    v_min_f32 v32, 0, v16
    v_min_f32 v33, 0, v17
    v_min_f32 v34, 0, v18
    v_min_f32 v35, 0, v19
    v_min_f32 v36, 0, v20
    v_min_f32 v37, 0, v21
    v_min_f32 v38, 0, v22
    v_min_f32 v39, 0, v23
    v_mul_f32 v32, s57, v32
    v_mul_f32 v33, s57, v33
    v_mul_f32 v34, s57, v34
    v_mul_f32 v35, s57, v35
    v_mul_f32 v36, s57, v36
    v_mul_f32 v37, s57, v37
    v_mul_f32 v38, s57, v38
    v_mul_f32 v39, s57, v39
    v_exp_f32 v32, v32
    v_exp_f32 v33, v33
    v_exp_f32 v34, v34
    v_exp_f32 v35, v35
    v_exp_f32 v36, v36
    v_exp_f32 v37, v37
    v_exp_f32 v38, v38
    v_exp_f32 v39, v39
    v_max_f32 v16, 0, v16
    v_max_f32 v17, 0, v17
    v_max_f32 v18, 0, v18
    v_max_f32 v19, 0, v19
    v_max_f32 v20, 0, v20
    v_max_f32 v21, 0, v21
    v_max_f32 v22, 0, v22
    v_max_f32 v23, 0, v23
    v_add_f32 v16, s56, v16
    v_add_f32 v17, s56, v17
    v_add_f32 v18, s56, v18
    v_add_f32 v19, s56, v19
    v_add_f32 v20, s56, v20
    v_add_f32 v21, s56, v21
    v_add_f32 v22, s56, v22
    v_add_f32 v23, s56, v23
    v_add_f32 v16, v16, v32
    v_add_f32 v17, v17, v33
    v_add_f32 v18, v18, v34
    v_add_f32 v19, v19, v35
    v_add_f32 v20, v20, v36
    v_add_f32 v21, v21, v37
    v_add_f32 v22, v22, v38
    v_add_f32 v23, v23, v39
    v_min_f32 v32, 0, v24
    v_min_f32 v33, 0, v25
    v_min_f32 v34, 0, v26
    v_min_f32 v35, 0, v27
    v_min_f32 v36, 0, v28
    v_min_f32 v37, 0, v29
    v_min_f32 v38, 0, v30
    v_min_f32 v39, 0, v31
    v_mul_f32 v32, s57, v32
    v_mul_f32 v33, s57, v33
    v_mul_f32 v34, s57, v34
    v_mul_f32 v35, s57, v35
    v_mul_f32 v36, s57, v36
    v_mul_f32 v37, s57, v37
    v_mul_f32 v38, s57, v38
    v_mul_f32 v39, s57, v39
    v_exp_f32 v32, v32
    v_exp_f32 v33, v33
    v_exp_f32 v34, v34
    v_exp_f32 v35, v35
    v_exp_f32 v36, v36
    v_exp_f32 v37, v37
    v_exp_f32 v38, v38
    v_exp_f32 v39, v39
    v_max_f32 v24, 0, v24
    v_max_f32 v25, 0, v25
    v_max_f32 v26, 0, v26
    v_max_f32 v27, 0, v27
    v_max_f32 v28, 0, v28
    v_max_f32 v29, 0, v29
    v_max_f32 v30, 0, v30
    v_max_f32 v31, 0, v31
    v_add_f32 v24, s56, v24
    v_add_f32 v25, s56, v25
    v_add_f32 v26, s56, v26
    v_add_f32 v27, s56, v27
    v_add_f32 v28, s56, v28
    v_add_f32 v29, s56, v29
    v_add_f32 v30, s56, v30
    v_add_f32 v31, s56, v31
    v_add_f32 v24, v24, v32
    v_add_f32 v25, v25, v33
    v_add_f32 v26, v26, v34
    v_add_f32 v27, v27, v35
    v_add_f32 v28, v28, v36
    v_add_f32 v29, v29, v37
    v_add_f32 v30, v30, v38
    v_add_f32 v31, v31, v39
    v_cvt_pk_bf16_f32 v48, v16, v17
    v_cvt_pk_bf16_f32 v49, v18, v19
    v_cvt_pk_bf16_f32 v50, v20, v21
    v_cvt_pk_bf16_f32 v51, v22, v23
    v_cvt_pk_bf16_f32 v52, v24, v25
    v_cvt_pk_bf16_f32 v53, v26, v27
    v_cvt_pk_bf16_f32 v54, v28, v29
    v_cvt_pk_bf16_f32 v55, v30, v31
    v_accvgpr_read_b32 v16, a32
    v_accvgpr_read_b32 v17, a33
    v_accvgpr_read_b32 v18, a34
    v_accvgpr_read_b32 v19, a35
    v_accvgpr_read_b32 v20, a36
    v_accvgpr_read_b32 v21, a37
    v_accvgpr_read_b32 v22, a38
    v_accvgpr_read_b32 v23, a39
    v_accvgpr_read_b32 v24, a40
    v_accvgpr_read_b32 v25, a41
    v_accvgpr_read_b32 v26, a42
    v_accvgpr_read_b32 v27, a43
    v_accvgpr_read_b32 v28, a44
    v_accvgpr_read_b32 v29, a45
    v_accvgpr_read_b32 v30, a46
    v_accvgpr_read_b32 v31, a47
    v_min_f32 v32, 0, v16
    v_min_f32 v33, 0, v17
    v_min_f32 v34, 0, v18
    v_min_f32 v35, 0, v19
    v_min_f32 v36, 0, v20
    v_min_f32 v37, 0, v21
    v_min_f32 v38, 0, v22
    v_min_f32 v39, 0, v23
    v_mul_f32 v32, s57, v32
    v_mul_f32 v33, s57, v33
    v_mul_f32 v34, s57, v34
    v_mul_f32 v35, s57, v35
    v_mul_f32 v36, s57, v36
    v_mul_f32 v37, s57, v37
    v_mul_f32 v38, s57, v38
    v_mul_f32 v39, s57, v39
    v_exp_f32 v32, v32
    v_exp_f32 v33, v33
    v_exp_f32 v34, v34
    v_exp_f32 v35, v35
    v_exp_f32 v36, v36
    v_exp_f32 v37, v37
    v_exp_f32 v38, v38
    v_exp_f32 v39, v39
    v_max_f32 v16, 0, v16
    v_max_f32 v17, 0, v17
    v_max_f32 v18, 0, v18
    v_max_f32 v19, 0, v19
    v_max_f32 v20, 0, v20
    v_max_f32 v21, 0, v21
    v_max_f32 v22, 0, v22
    v_max_f32 v23, 0, v23
    v_add_f32 v16, s56, v16
    v_add_f32 v17, s56, v17
    v_add_f32 v18, s56, v18
    v_add_f32 v19, s56, v19
    v_add_f32 v20, s56, v20
    v_add_f32 v21, s56, v21
    v_add_f32 v22, s56, v22
    v_add_f32 v23, s56, v23
    v_add_f32 v16, v16, v32
    v_add_f32 v17, v17, v33
    v_add_f32 v18, v18, v34
    v_add_f32 v19, v19, v35
    v_add_f32 v20, v20, v36
    v_add_f32 v21, v21, v37
    v_add_f32 v22, v22, v38
    v_add_f32 v23, v23, v39
    v_min_f32 v32, 0, v24
    v_min_f32 v33, 0, v25
    v_min_f32 v34, 0, v26
    v_min_f32 v35, 0, v27
    v_min_f32 v36, 0, v28
    v_min_f32 v37, 0, v29
    v_min_f32 v38, 0, v30
    v_min_f32 v39, 0, v31
    v_mul_f32 v32, s57, v32
    v_mul_f32 v33, s57, v33
    v_mul_f32 v34, s57, v34
    v_mul_f32 v35, s57, v35
    v_mul_f32 v36, s57, v36
    v_mul_f32 v37, s57, v37
    v_mul_f32 v38, s57, v38
    v_mul_f32 v39, s57, v39
    v_exp_f32 v32, v32
    v_exp_f32 v33, v33
    v_exp_f32 v34, v34
    v_exp_f32 v35, v35
    v_exp_f32 v36, v36
    v_exp_f32 v37, v37
    v_exp_f32 v38, v38
    v_exp_f32 v39, v39
    v_max_f32 v24, 0, v24
    v_max_f32 v25, 0, v25
    v_max_f32 v26, 0, v26
    v_max_f32 v27, 0, v27
    v_max_f32 v28, 0, v28
    v_max_f32 v29, 0, v29
    v_max_f32 v30, 0, v30
    v_max_f32 v31, 0, v31
    v_add_f32 v24, s56, v24
    v_add_f32 v25, s56, v25
    v_add_f32 v26, s56, v26
    v_add_f32 v27, s56, v27
    v_add_f32 v28, s56, v28
    v_add_f32 v29, s56, v29
    v_add_f32 v30, s56, v30
    v_add_f32 v31, s56, v31
    v_add_f32 v24, v24, v32
    v_add_f32 v25, v25, v33
    v_add_f32 v26, v26, v34
    v_add_f32 v27, v27, v35
    v_add_f32 v28, v28, v36
    v_add_f32 v29, v29, v37
    v_add_f32 v30, v30, v38
    v_add_f32 v31, v31, v39
    v_cvt_pk_bf16_f32 v56, v16, v17
    v_cvt_pk_bf16_f32 v57, v18, v19
    v_cvt_pk_bf16_f32 v58, v20, v21
    v_cvt_pk_bf16_f32 v59, v22, v23
    v_cvt_pk_bf16_f32 v60, v24, v25
    v_cvt_pk_bf16_f32 v61, v26, v27
    v_cvt_pk_bf16_f32 v62, v28, v29
    v_cvt_pk_bf16_f32 v63, v30, v31
    v_mfma_f32_32x32x16_bf16 a[0:15], v[40:43], v[64:67], 0
    v_mfma_f32_32x32x16_bf16 a[0:15], v[44:47], v[68:71], a[0:15]
    v_mfma_f32_32x32x16_bf16 a[16:31], v[40:43], v[72:75], 0
    v_mfma_f32_32x32x16_bf16 a[16:31], v[44:47], v[76:79], a[16:31]
    v_mfma_f32_32x32x16_bf16 a[32:47], v[48:51], v[72:75], 0
    s_mov_b32 exec_lo, 0xffff0000
    s_mov_b32 exec_hi, 0xffff0000
    s_nop 6
    ds_write_b128 v90, a[0:3] offset:0
    s_mov_b64 exec, -1
    s_mov_b32 exec_lo, 0x1
    s_mov_b32 exec_hi, 0x1
    ds_write_b128 v91, a[0:3] offset:1600
    s_mov_b64 exec, -1
    v_mfma_f32_32x32x16_bf16 a[32:47], v[52:55], v[76:79], a[32:47]
    s_mov_b32 exec_lo, 0xffff0000
    s_mov_b32 exec_hi, 0xffff0000
    ds_write_b128 v90, a[4:7] offset:32
    s_mov_b64 exec, -1
    s_mov_b32 exec_lo, 0x1
    s_mov_b32 exec_hi, 0x1
    ds_write_b128 v91, a[4:7] offset:1632
    s_mov_b64 exec, -1
    v_mfma_f32_32x32x16_bf16 a[48:63], v[48:51], v[80:83], 0
    s_mov_b32 exec_lo, 0xffff0000
    s_mov_b32 exec_hi, 0x0
    ds_write_b128 v90, a[8:11] offset:64
    s_mov_b64 exec, -1
    s_mov_b32 exec_lo, 0x1
    s_mov_b32 exec_hi, 0x0
    ds_write_b128 v91, a[8:11] offset:1664
    s_mov_b64 exec, -1
    v_mfma_f32_32x32x16_bf16 a[48:63], v[52:55], v[84:87], a[48:63]
    s_mov_b32 exec_lo, 0x0
    s_mov_b32 exec_hi, 0x1
    ds_write_b128 v91, a[8:11] offset:3264
    s_mov_b64 exec, -1
    s_mov_b32 exec_lo, 0x1
    s_mov_b32 exec_hi, 0x1
    ds_write_b128 v91, a[12:15] offset:3296
    s_mov_b64 exec, -1
    v_mfma_f32_32x32x16_bf16 a[64:79], v[56:59], v[80:83], 0
    s_mov_b32 exec_lo, 0xf
    s_mov_b32 exec_hi, 0xf
    ds_write_b128 v90, a[16:19] offset:2560
    s_mov_b64 exec, -1
    s_mov_b32 exec_lo, 0xf
    s_mov_b32 exec_hi, 0xf
    ds_write_b128 v90, a[20:23] offset:2592
    s_mov_b64 exec, -1
    v_mfma_f32_32x32x16_bf16 a[64:79], v[60:63], v[84:87], a[64:79]
    s_mov_b32 exec_lo, 0xf
    s_mov_b32 exec_hi, 0xfffff0
    ds_write_b128 v90, a[24:27] offset:2624
    s_mov_b64 exec, -1
    s_mov_b32 exec_lo, 0xfffff0
    s_mov_b32 exec_hi, 0xfffff0
    ds_write_b128 v90, a[28:31] offset:2656
    s_mov_b64 exec, -1
    v_mfma_f32_32x32x16_bf16 a[80:95], v[48:51], v[64:67], 0
    s_mov_b32 exec_lo, 0xfffff0
    s_mov_b32 exec_hi, 0xfffff0
    ds_write_b128 v90, a[32:35] offset:2688
    s_mov_b64 exec, -1
    s_mov_b32 exec_lo, 0xff000000
    s_mov_b32 exec_hi, 0xff000000
    ds_write_b128 v90, a[36:39] offset:2720
    s_mov_b64 exec, -1
    v_mfma_f32_32x32x16_bf16 a[80:95], v[52:55], v[68:71], a[80:95]
    s_mov_b32 exec_lo, 0xff000000
    s_mov_b32 exec_hi, 0xff000000
    ds_write_b128 v90, a[40:43] offset:2752
    s_mov_b64 exec, -1
    s_mov_b32 exec_lo, 0xff000000
    s_mov_b32 exec_hi, 0x0
    ds_write_b128 v90, a[44:47] offset:2784
    s_mov_b64 exec, -1
    v_mfma_f32_32x32x16_bf16 a[96:111], v[56:59], v[64:67], 0
    s_mov_b32 exec_lo, 0xfff
    s_mov_b32 exec_hi, 0xfff
    ds_write_b128 v90, a[52:55] offset:5280
    s_mov_b64 exec, -1
    s_mov_b32 exec_lo, 0xfff
    s_mov_b32 exec_hi, 0xfff
    ds_write_b128 v90, a[56:59] offset:5312
    s_mov_b64 exec, -1
    v_mfma_f32_32x32x16_bf16 a[96:111], v[60:63], v[68:71], a[96:111]
    s_mov_b32 exec_lo, 0xfff
    s_mov_b32 exec_hi, 0xfffff000
    ds_write_b128 v90, a[60:63] offset:5344
    s_mov_b64 exec, -1
    s_mov_b32 exec_lo, 0xfffff000
    s_mov_b32 exec_hi, 0xfffff000
    ds_write_b128 v90, a[64:67] offset:5376
    s_mov_b64 exec, -1
    s_mov_b32 exec_lo, 0xfffff000
    s_mov_b32 exec_hi, 0xfffff000
    ds_write_b128 v90, a[68:71] offset:5408
    s_mov_b64 exec, -1
    s_mov_b32 exec_lo, 0x1
    s_mov_b32 exec_hi, 0x1
    ds_write_b128 v91, a[80:83] offset:3328
    s_mov_b64 exec, -1
    s_mov_b32 exec_lo, 0x1
    s_mov_b32 exec_hi, 0x1
    ds_write_b128 v91, a[84:87] offset:4960
    s_mov_b64 exec, -1
    s_mov_b32 exec_lo, 0x1
    s_mov_b32 exec_hi, 0x1
    ds_write_b128 v91, a[88:91] offset:4992
    s_mov_b64 exec, -1
    s_mov_b32 exec_lo, 0x1
    s_mov_b32 exec_hi, 0x0
    ds_write_b128 v91, a[92:95] offset:5024
    s_mov_b64 exec, -1
    s_mov_b32 exec_lo, 0x0
    s_mov_b32 exec_hi, 0x1
    ds_write_b128 v91, a[92:95] offset:6624
    s_mov_b64 exec, -1
    s_mov_b32 exec_lo, 0x1
    s_mov_b32 exec_hi, 0x1
    ds_write_b128 v91, a[96:99] offset:6656
    s_mov_b64 exec, -1
    s_mov_b32 exec_lo, 0x1
    s_mov_b32 exec_hi, 0x1
    ds_write_b128 v91, a[100:103] offset:6688
    s_mov_b64 exec, -1
    s_waitcnt lgkmcnt(0)
    s_barrier
    s_add_u32 s55, s37, 884736
    s_add_u32 m0, s19, 40960
    s_nop 0
    buffer_load_dwordx4 v8, s[28:31], s55 offen lds
    s_add_u32 m0, s19, 41984
    s_nop 0
    buffer_load_dwordx4 v9, s[28:31], s55 offen lds
    s_add_u32 m0, s19, 43008
    s_nop 0
    buffer_load_dwordx4 v10, s[28:31], s55 offen lds
    s_add_u32 s55, s37, 1105920
    s_add_u32 m0, s19, 61440
    s_nop 0
    buffer_load_dwordx4 v8, s[28:31], s55 offen lds
    s_add_u32 m0, s19, 62464
    s_nop 0
    buffer_load_dwordx4 v9, s[28:31], s55 offen lds
    s_add_u32 m0, s19, 63488
    s_nop 0
    buffer_load_dwordx4 v10, s[28:31], s55 offen lds
    v_lshlrev_b32 v44, 2, v0
    v_add_u32 v45, 122880, v44
    ds_read_b32 v16, v45 offset:0
    ds_read_b32 v17, v45 offset:7168
    ds_read_b32 v18, v45 offset:14336
    ds_read_b32 v19, v45 offset:21504
    ds_read_b32 v20, v45 offset:1024
    ds_read_b32 v21, v45 offset:8192
    ds_read_b32 v22, v45 offset:15360
    ds_read_b32 v23, v45 offset:22528
    ds_read_b32 v24, v45 offset:2048
    ds_read_b32 v25, v45 offset:9216
    ds_read_b32 v26, v45 offset:16384
    ds_read_b32 v27, v45 offset:23552
    ds_read_b32 v28, v45 offset:3072
    ds_read_b32 v29, v45 offset:10240
    ds_read_b32 v30, v45 offset:17408
    ds_read_b32 v31, v45 offset:24576
    ds_read_b32 v32, v45 offset:4096
    ds_read_b32 v33, v45 offset:11264
    ds_read_b32 v34, v45 offset:18432
    ds_read_b32 v35, v45 offset:25600
    ds_read_b32 v36, v45 offset:5120
    ds_read_b32 v37, v45 offset:12288
    ds_read_b32 v38, v45 offset:19456
    ds_read_b32 v39, v45 offset:26624
    ds_read_b32 v48, v45 offset:6144
    ds_read_b32 v49, v45 offset:13312
    ds_read_b32 v50, v45 offset:20480
    ds_read_b32 v51, v45 offset:27648
    s_add_u32 s42, s58, 4096
    s_waitcnt lgkmcnt(15)
    v_add_f32 v16, v16, v17
    v_add_f32 v18, v18, v19
    v_add_f32 v16, v16, v18
    buffer_atomic_add_f32 v16, v44, s[20:23], s58 offen offset:0
    v_add_f32 v20, v20, v21
    v_add_f32 v22, v22, v23
    v_add_f32 v20, v20, v22
    buffer_atomic_add_f32 v20, v44, s[20:23], s58 offen offset:1024
    v_add_f32 v24, v24, v25
    v_add_f32 v26, v26, v27
    v_add_f32 v24, v24, v26
    buffer_atomic_add_f32 v24, v44, s[20:23], s58 offen offset:2048
    s_waitcnt lgkmcnt(12)
    v_add_f32 v28, v28, v29
    v_add_f32 v30, v30, v31
    v_add_f32 v28, v28, v30
    buffer_atomic_add_f32 v28, v44, s[20:23], s58 offen offset:3072
    s_waitcnt lgkmcnt(8)
    v_add_f32 v32, v32, v33
    v_add_f32 v34, v34, v35
    v_add_f32 v32, v32, v34
    buffer_atomic_add_f32 v32, v44, s[20:23], s42 offen offset:0
    s_waitcnt lgkmcnt(4)
    v_add_f32 v36, v36, v37
    v_add_f32 v38, v38, v39
    v_add_f32 v36, v36, v38
    buffer_atomic_add_f32 v36, v44, s[20:23], s42 offen offset:1024
    s_waitcnt lgkmcnt(0)
    v_add_f32 v48, v48, v49
    v_add_f32 v50, v50, v51
    v_add_f32 v48, v48, v50
    buffer_atomic_add_f32 v48, v44, s[20:23], s42 offen offset:2048
    s_lshl_b32 s98, s16, 1
    s_and_b32 s99, s98, 7
    s_and_b32 s40, s15, 3
    s_lshl_b32 s40, s40, 1
    s_add_u32 s99, s99, s40
    s_add_u32 s44, s14, 0
    s_and_b32 s44, s44, 3
    s_lshl_b32 s45, s98, 2
    s_add_u32 s44, s44, s45
    s_mul_i32 s44, s44, 75776
    s_add_u32 s24, s44, 2621440
    s_add_u32 s44, s14, 1
    s_and_b32 s44, s44, 3
    s_lshl_b32 s45, s98, 2
    s_add_u32 s44, s44, s45
    s_mul_i32 s44, s44, 75776
    s_add_u32 s25, s44, 2621440
    s_add_u32 s44, s14, 2
    s_and_b32 s44, s44, 3
    s_lshl_b32 s45, s98, 2
    s_add_u32 s44, s44, s45
    s_mul_i32 s44, s44, 75776
    s_add_u32 s26, s44, 2621440
    s_add_u32 s44, s14, 3
    s_and_b32 s44, s44, 3
    s_lshl_b32 s45, s98, 2
    s_add_u32 s44, s44, s45
    s_mul_i32 s44, s44, 75776
    s_add_u32 s27, s44, 2621440
    s_mul_i32 s96, s15, 378880
    s_add_u32 s96, s96, 12320768
    s_add_u32 s97, s96, 4096
    v_lshlrev_b32 v5, 4, v2
    s_lshl_b32 s44, s14, 10
    v_add_u32 v6, s44, v5
    s_mul_i32 s44, s14, 5120
    v_add_u32 v7, s44, v5
    s_cmp_ge_u32 s14, 2
    s_cselect_b32 s46, 0x40000000, 0
    s_mul_i32 s44, s99, 6554
    s_lshr_b32 s44, s44, 16
    s_mul_i32 s44, s44, 10
    s_sub_u32 s100, s99, s44
    s_lshl_b32 s44, s100, 2
    s_add_u32 s44, s44, 16
    s_mul_i32 s45, s44, 5120
    s_lshl_b32 s44, s44, 10
    s_cmp_eq_u32 s100, 9
    s_cselect_b32 s101, s46, 0
    s_add_u32 s44, s44, s101
    s_add_u32 s45, s45, s101
    v_add_u32 v70, s44, v6
    v_add_u32 v73, s45, v7
    s_add_u32 s100, s100, 1
    s_cmp_eq_u32 s100, 10
    s_cselect_b32 s100, 0, s100
    s_lshl_b32 s44, s100, 2
    s_add_u32 s44, s44, 16
    s_mul_i32 s45, s44, 5120
    s_lshl_b32 s44, s44, 10
    s_cmp_eq_u32 s100, 9
    s_cselect_b32 s101, s46, 0
    s_add_u32 s44, s44, s101
    s_add_u32 s45, s45, s101
    v_add_u32 v71, s44, v6
    v_add_u32 v74, s45, v7
    s_add_u32 s100, s100, 1
    s_cmp_eq_u32 s100, 10
    s_cselect_b32 s100, 0, s100
    s_lshl_b32 s44, s100, 2
    s_add_u32 s44, s44, 16
    s_mul_i32 s45, s44, 5120
    s_lshl_b32 s44, s44, 10
    s_cmp_eq_u32 s100, 9
    s_cselect_b32 s101, s46, 0
    s_add_u32 s44, s44, s101
    s_add_u32 s45, s45, s101
    v_add_u32 v72, s44, v6
    v_add_u32 v75, s45, v7
    s_waitcnt vmcnt(22)
    s_barrier
    ds_read_b64_tr_b16 v[24:25], v89 offset:20480
    ds_read_b64_tr_b16 v[26:27], v89 offset:21248
    ds_read_b64_tr_b16 v[28:29], v89 offset:20544
    ds_read_b64_tr_b16 v[30:31], v89 offset:21312
    ds_read_b64_tr_b16 v[32:33], v89 offset:23552
    ds_read_b64_tr_b16 v[34:35], v89 offset:24320
    ds_read_b64_tr_b16 v[36:37], v89 offset:23616
    ds_read_b64_tr_b16 v[38:39], v89 offset:24384
    s_waitcnt lgkmcnt(6)
    v_mfma_f32_32x32x16_bf16 a[80:95], v[24:27], v[96:99], 0
    ds_read_b64_tr_b16 v[16:17], v89 offset:26624
    ds_read_b64_tr_b16 v[18:19], v89 offset:27392
    s_waitcnt lgkmcnt(6)
    v_mfma_f32_32x32x16_bf16 a[96:111], v[28:31], v[96:99], 0
    ds_read_b64_tr_b16 v[20:21], v89 offset:26688
    ds_read_b64_tr_b16 v[22:23], v89 offset:27456
    s_waitcnt lgkmcnt(6)
    v_mfma_f32_32x32x16_bf16 a[80:95], v[32:35], v[100:103], a[80:95]
    ds_read_b64_tr_b16 v[24:25], v89 offset:29696
    ds_read_b64_tr_b16 v[26:27], v89 offset:30464
    s_waitcnt lgkmcnt(6)
    v_mfma_f32_32x32x16_bf16 a[96:111], v[36:39], v[100:103], a[96:111]
    ds_read_b64_tr_b16 v[28:29], v89 offset:29760
    ds_read_b64_tr_b16 v[30:31], v89 offset:30528
    s_waitcnt lgkmcnt(6)
    v_mfma_f32_32x32x16_bf16 a[80:95], v[16:19], v[104:107], a[80:95]
    s_waitcnt vmcnt(19)
    s_barrier
    ds_read_b64_tr_b16 v[32:33], v89 offset:40960
    ds_read_b64_tr_b16 v[34:35], v89 offset:41728
    s_waitcnt lgkmcnt(6)
    v_mfma_f32_32x32x16_bf16 a[96:111], v[20:23], v[104:107], a[96:111]
    ds_read_b64_tr_b16 v[36:37], v89 offset:41024
    ds_read_b64_tr_b16 v[38:39], v89 offset:41792
    s_waitcnt lgkmcnt(6)
    v_mfma_f32_32x32x16_bf16 a[80:95], v[24:27], v[108:111], a[80:95]
    ds_read_b64_tr_b16 v[16:17], v89 offset:44032
    ds_read_b64_tr_b16 v[18:19], v89 offset:44800
    s_waitcnt lgkmcnt(6)
    v_mfma_f32_32x32x16_bf16 a[96:111], v[28:31], v[108:111], a[96:111]
    ds_read_b64_tr_b16 v[20:21], v89 offset:44096
    ds_read_b64_tr_b16 v[22:23], v89 offset:44864
    s_waitcnt lgkmcnt(6)
    v_mfma_f32_32x32x16_bf16 a[80:95], v[32:35], v[112:115], a[80:95]
    ds_read_b64_tr_b16 v[24:25], v89 offset:47104
    ds_read_b64_tr_b16 v[26:27], v89 offset:47872
    s_waitcnt lgkmcnt(6)
    v_mfma_f32_32x32x16_bf16 a[96:111], v[36:39], v[112:115], a[96:111]
    ds_read_b64_tr_b16 v[28:29], v89 offset:47168
    ds_read_b64_tr_b16 v[30:31], v89 offset:47936
    s_waitcnt lgkmcnt(6)
    v_mfma_f32_32x32x16_bf16 a[80:95], v[16:19], v[116:119], a[80:95]
    ds_read_b64_tr_b16 v[32:33], v89 offset:50176
    ds_read_b64_tr_b16 v[34:35], v89 offset:50944
    s_waitcnt lgkmcnt(6)
    v_mfma_f32_32x32x16_bf16 a[96:111], v[20:23], v[116:119], a[96:111]
    ds_read_b64_tr_b16 v[36:37], v89 offset:50240
    ds_read_b64_tr_b16 v[38:39], v89 offset:51008
    s_waitcnt lgkmcnt(6)
    v_mfma_f32_32x32x16_bf16 a[80:95], v[24:27], v[120:123], a[80:95]
    s_waitcnt vmcnt(16)
    s_barrier
    ds_read_b64_tr_b16 v[16:17], v88 offset:0
    ds_read_b64_tr_b16 v[18:19], v88 offset:768
    s_add_u32 s55, s37, 1327104
    s_add_u32 m0, s19, 81920
    s_waitcnt lgkmcnt(6)
    v_mfma_f32_32x32x16_bf16 a[96:111], v[28:31], v[120:123], a[96:111]
    buffer_load_dwordx4 v8, s[28:31], s55 offen lds
    ds_read_b64_tr_b16 v[20:21], v88 offset:64
    ds_read_b64_tr_b16 v[22:23], v88 offset:832
    s_waitcnt lgkmcnt(6)
    v_mfma_f32_32x32x16_bf16 a[80:95], v[32:35], v[124:127], a[80:95]
    ds_read_b64_tr_b16 v[24:25], v88 offset:3072
    ds_read_b64_tr_b16 v[26:27], v88 offset:3840
    s_add_u32 m0, s19, 82944
    s_waitcnt lgkmcnt(6)
    v_mfma_f32_32x32x16_bf16 a[96:111], v[36:39], v[124:127], a[96:111]
    buffer_load_dwordx4 v9, s[28:31], s55 offen lds
    ds_read_b64_tr_b16 v[28:29], v88 offset:3136
    ds_read_b64_tr_b16 v[30:31], v88 offset:3904
    s_waitcnt lgkmcnt(6)
    v_mfma_f32_32x32x16_bf16 a[80:95], v[16:19], v[128:131], a[80:95]
    ds_read_b64_tr_b16 v[32:33], v88 offset:6144
    ds_read_b64_tr_b16 v[34:35], v88 offset:6912
    s_add_u32 m0, s19, 83968
    s_waitcnt lgkmcnt(6)
    v_mfma_f32_32x32x16_bf16 a[96:111], v[20:23], v[128:131], a[96:111]
    buffer_load_dwordx4 v10, s[28:31], s55 offen lds
    ds_read_b64_tr_b16 v[36:37], v88 offset:6208
    ds_read_b64_tr_b16 v[38:39], v88 offset:6976
    s_waitcnt lgkmcnt(6)
    v_mfma_f32_32x32x16_bf16 a[80:95], v[24:27], v[132:135], a[80:95]
    ds_read_b64_tr_b16 v[16:17], v88 offset:9216
    ds_read_b64_tr_b16 v[18:19], v88 offset:9984
    s_waitcnt lgkmcnt(6)
    v_mfma_f32_32x32x16_bf16 a[96:111], v[28:31], v[132:135], a[96:111]
    ds_read_b64_tr_b16 v[20:21], v88 offset:9280
    ds_read_b64_tr_b16 v[22:23], v88 offset:10048
    s_waitcnt lgkmcnt(6)
    v_mfma_f32_32x32x16_bf16 a[80:95], v[32:35], v[136:139], a[80:95]
    s_waitcnt vmcnt(16)
    s_barrier
    ds_read_b64_tr_b16 v[24:25], v88 offset:20480
    ds_read_b64_tr_b16 v[26:27], v88 offset:21248
    s_add_u32 s55, s37, 1548288
    s_add_u32 m0, s19, 102400
    s_waitcnt lgkmcnt(6)
    v_mfma_f32_32x32x16_bf16 a[96:111], v[36:39], v[136:139], a[96:111]
    buffer_load_dwordx4 v8, s[28:31], s55 offen lds
    ds_read_b64_tr_b16 v[28:29], v88 offset:20544
    ds_read_b64_tr_b16 v[30:31], v88 offset:21312
    s_waitcnt lgkmcnt(6)
    v_mfma_f32_32x32x16_bf16 a[80:95], v[16:19], v[140:143], a[80:95]
    ds_read_b64_tr_b16 v[32:33], v88 offset:23552
    ds_read_b64_tr_b16 v[34:35], v88 offset:24320
    s_add_u32 m0, s19, 103424
    s_waitcnt lgkmcnt(6)
    v_mfma_f32_32x32x16_bf16 a[96:111], v[20:23], v[140:143], a[96:111]
    buffer_load_dwordx4 v9, s[28:31], s55 offen lds
    ds_read_b64_tr_b16 v[36:37], v88 offset:23616
    ds_read_b64_tr_b16 v[38:39], v88 offset:24384
    s_waitcnt lgkmcnt(6)
    v_mfma_f32_32x32x16_bf16 a[80:95], v[24:27], v[144:147], a[80:95]
    ds_read_b64_tr_b16 v[16:17], v88 offset:26624
    ds_read_b64_tr_b16 v[18:19], v88 offset:27392
    s_add_u32 m0, s19, 104448
    s_waitcnt lgkmcnt(6)
    v_mfma_f32_32x32x16_bf16 a[96:111], v[28:31], v[144:147], a[96:111]
    buffer_load_dwordx4 v10, s[28:31], s55 offen lds
    ds_read_b64_tr_b16 v[20:21], v88 offset:26688
    ds_read_b64_tr_b16 v[22:23], v88 offset:27456
    s_waitcnt lgkmcnt(6)
    v_mfma_f32_32x32x16_bf16 a[80:95], v[32:35], v[148:151], a[80:95]
    ds_read_b64_tr_b16 v[24:25], v88 offset:29696
    ds_read_b64_tr_b16 v[26:27], v88 offset:30464
    s_waitcnt lgkmcnt(6)
    v_mfma_f32_32x32x16_bf16 a[96:111], v[36:39], v[148:151], a[96:111]
    ds_read_b64_tr_b16 v[28:29], v88 offset:29760
    ds_read_b64_tr_b16 v[30:31], v88 offset:30528
    s_waitcnt lgkmcnt(6)
    v_mfma_f32_32x32x16_bf16 a[80:95], v[16:19], v[152:155], a[80:95]
    s_waitcnt vmcnt(16)
    s_barrier
    ds_read_b64_tr_b16 v[32:33], v88 offset:40960
    ds_read_b64_tr_b16 v[34:35], v88 offset:41728
    s_add_u32 s55, s37, 1769472
    s_add_u32 m0, s19, 0
    s_waitcnt lgkmcnt(6)
    v_mfma_f32_32x32x16_bf16 a[96:111], v[20:23], v[152:155], a[96:111]
    buffer_load_dwordx4 v8, s[28:31], s55 offen lds
    ds_read_b64_tr_b16 v[36:37], v88 offset:41024
    ds_read_b64_tr_b16 v[38:39], v88 offset:41792
    s_waitcnt lgkmcnt(6)
    v_mfma_f32_32x32x16_bf16 a[80:95], v[24:27], v[156:159], a[80:95]
    ds_read_b64_tr_b16 v[16:17], v88 offset:44032
    ds_read_b64_tr_b16 v[18:19], v88 offset:44800
    s_add_u32 m0, s19, 1024
    s_waitcnt lgkmcnt(6)
    v_mfma_f32_32x32x16_bf16 a[96:111], v[28:31], v[156:159], a[96:111]
    buffer_load_dwordx4 v9, s[28:31], s55 offen lds
    ds_read_b64_tr_b16 v[20:21], v88 offset:44096
    ds_read_b64_tr_b16 v[22:23], v88 offset:44864
    s_add_u32 m0, s19, 2048
    s_nop 0
    buffer_load_dwordx4 v10, s[28:31], s55 offen lds
    s_cmp_lg_u32 s14, 0
    s_cbranch_scc1 parallel_sum__linear_attn_block__dense_activation_relu__prompt_kernel_a_w2cp_pre
    s_mov_b32 s40, 15571968
    v_mul_u32_u24 v1, 128, v2
    v_add_u32 v1, s40, v1
    s_mov_b64 exec, 255
    buffer_load_dword v95, v1, s[20:23], 0 offen sc0 sc1
    s_mov_b64 exec, -1
parallel_sum__linear_attn_block__dense_activation_relu__prompt_kernel_a_w2cp_pre:
    s_waitcnt lgkmcnt(6)
    v_mfma_f32_32x32x16_bf16 a[80:95], v[32:35], v[160:163], a[80:95]
    ds_read_b64_tr_b16 v[24:25], v88 offset:47104
    ds_read_b64_tr_b16 v[26:27], v88 offset:47872
    s_waitcnt lgkmcnt(6)
    v_mfma_f32_32x32x16_bf16 a[96:111], v[36:39], v[160:163], a[96:111]
    ds_read_b64_tr_b16 v[28:29], v88 offset:47168
    ds_read_b64_tr_b16 v[30:31], v88 offset:47936
    s_waitcnt lgkmcnt(6)
    v_mfma_f32_32x32x16_bf16 a[80:95], v[16:19], v[164:167], a[80:95]
    ds_read_b64_tr_b16 v[32:33], v88 offset:50176
    ds_read_b64_tr_b16 v[34:35], v88 offset:50944
    s_waitcnt lgkmcnt(6)
    v_mfma_f32_32x32x16_bf16 a[96:111], v[20:23], v[164:167], a[96:111]
    ds_read_b64_tr_b16 v[36:37], v88 offset:50240
    ds_read_b64_tr_b16 v[38:39], v88 offset:51008
    s_waitcnt lgkmcnt(6)
    v_mfma_f32_32x32x16_bf16 a[80:95], v[24:27], v[168:171], a[80:95]
    s_waitcnt vmcnt(16)
    s_barrier
    ds_read_b64_tr_b16 v[16:17], v89 offset:0
    ds_read_b64_tr_b16 v[18:19], v89 offset:768
    s_add_u32 s55, s37, 1990656
    s_add_u32 m0, s19, 20480
    s_waitcnt lgkmcnt(6)
    v_mfma_f32_32x32x16_bf16 a[96:111], v[28:31], v[168:171], a[96:111]
    buffer_load_dwordx4 v8, s[28:31], s55 offen lds
    ds_read_b64_tr_b16 v[20:21], v89 offset:64
    ds_read_b64_tr_b16 v[22:23], v89 offset:832
    s_waitcnt lgkmcnt(6)
    v_mfma_f32_32x32x16_bf16 a[80:95], v[32:35], v[172:175], a[80:95]
    ds_read_b64_tr_b16 v[24:25], v89 offset:3072
    ds_read_b64_tr_b16 v[26:27], v89 offset:3840
    s_add_u32 m0, s19, 21504
    s_waitcnt lgkmcnt(6)
    v_mfma_f32_32x32x16_bf16 a[96:111], v[36:39], v[172:175], a[96:111]
    buffer_load_dwordx4 v9, s[28:31], s55 offen lds
    ds_read_b64_tr_b16 v[28:29], v89 offset:3136
    ds_read_b64_tr_b16 v[30:31], v89 offset:3904
    s_waitcnt lgkmcnt(6)
    v_mfma_f32_32x32x16_bf16 a[80:95], v[16:19], v[176:179], a[80:95]
    ds_read_b64_tr_b16 v[32:33], v89 offset:6144
    ds_read_b64_tr_b16 v[34:35], v89 offset:6912
    s_add_u32 m0, s19, 22528
    s_waitcnt lgkmcnt(6)
    v_mfma_f32_32x32x16_bf16 a[96:111], v[20:23], v[176:179], a[96:111]
    buffer_load_dwordx4 v10, s[28:31], s55 offen lds
    ds_read_b64_tr_b16 v[36:37], v89 offset:6208
    ds_read_b64_tr_b16 v[38:39], v89 offset:6976
    s_waitcnt lgkmcnt(6)
    v_mfma_f32_32x32x16_bf16 a[80:95], v[24:27], v[180:183], a[80:95]
    ds_read_b64_tr_b16 v[16:17], v89 offset:9216
    ds_read_b64_tr_b16 v[18:19], v89 offset:9984
    s_waitcnt lgkmcnt(6)
    v_mfma_f32_32x32x16_bf16 a[96:111], v[28:31], v[180:183], a[96:111]
    ds_read_b64_tr_b16 v[20:21], v89 offset:9280
    ds_read_b64_tr_b16 v[22:23], v89 offset:10048
    s_cmp_lg_u32 s14, 0
    s_cbranch_scc1 parallel_sum__linear_attn_block__dense_activation_relu__prompt_kernel_a_w2c_ok
    v_mov_b32 v68, 16
    s_mov_b64 exec, 255
    s_waitcnt vmcnt(3)
    v_cmp_ge_u32 vcc, v95, v68
    s_nop 3
    s_cmp_eq_u64 vcc, 255
    s_cbranch_scc1 parallel_sum__linear_attn_block__dense_activation_relu__prompt_kernel_a_w2c_done
    s_mov_b32 s42, 0
parallel_sum__linear_attn_block__dense_activation_relu__prompt_kernel_a_w2c_spin:
    buffer_load_dword v95, v1, s[20:23], 0 offen sc0 sc1
    s_waitcnt vmcnt(0)
    v_cmp_ge_u32 vcc, v95, v68
    s_add_u32 s42, s42, 1
    s_cmp_ge_u32 s42, 0x40000
    s_cbranch_scc1 parallel_sum__linear_attn_block__dense_activation_relu__prompt_kernel_a_w2c_done
    s_nop 0
    s_cmp_eq_u64 vcc, 255
    s_cbranch_scc0 parallel_sum__linear_attn_block__dense_activation_relu__prompt_kernel_a_w2c_spin
parallel_sum__linear_attn_block__dense_activation_relu__prompt_kernel_a_w2c_done:
    s_mov_b64 exec, -1
parallel_sum__linear_attn_block__dense_activation_relu__prompt_kernel_a_w2c_ok:
    s_waitcnt vmcnt(12)
    s_barrier
    s_cmp_lg_u32 s14, 0
    s_cbranch_scc1 parallel_sum__linear_attn_block__dense_activation_relu__prompt_kernel_a_kv_sig
    v_mov_b32 v44, 1
    s_lshl_b32 s40, s15, 7
    s_add_u32 s40, s40, 15564800
    v_mov_b32 v45, s40
    s_mov_b64 exec, 1
    buffer_atomic_add v44, v45, s[20:23], 0 offen
    s_mov_b64 exec, -1
parallel_sum__linear_attn_block__dense_activation_relu__prompt_kernel_a_kv_sig:
    s_waitcnt lgkmcnt(6)
    v_mfma_f32_32x32x16_bf16 a[80:95], v[32:35], v[184:187], a[80:95]
    buffer_load_dwordx4 a[164:167], v73, s[20:23], s96 offen offset:0 sc1
    s_waitcnt vmcnt(10)
    s_barrier
    ds_read_b64_tr_b16 v[24:25], v89 offset:20480
    ds_read_b64_tr_b16 v[26:27], v89 offset:21248
    s_waitcnt lgkmcnt(6)
    v_mfma_f32_32x32x16_bf16 a[96:111], v[36:39], v[184:187], a[96:111]
    ds_read_b64_tr_b16 v[28:29], v89 offset:20544
    ds_read_b64_tr_b16 v[30:31], v89 offset:21312
    s_waitcnt lgkmcnt(6)
    v_mfma_f32_32x32x16_bf16 a[80:95], v[16:19], v[188:191], a[80:95]
    buffer_load_dwordx4 a[168:171], v73, s[20:23], s96 offen offset:1024 sc1
    ds_read_b64_tr_b16 v[32:33], v89 offset:23552
    ds_read_b64_tr_b16 v[34:35], v89 offset:24320
    s_waitcnt lgkmcnt(6)
    v_mfma_f32_32x32x16_bf16 a[96:111], v[20:23], v[188:191], a[96:111]
    ds_read_b64_tr_b16 v[36:37], v89 offset:23616
    ds_read_b64_tr_b16 v[38:39], v89 offset:24384
    s_waitcnt lgkmcnt(6)
    v_mfma_f32_32x32x16_bf16 a[80:95], v[24:27], v[192:195], a[80:95]
    buffer_load_dwordx4 a[172:175], v73, s[20:23], s96 offen offset:2048 sc1
    ds_read_b64_tr_b16 v[16:17], v89 offset:26624
    ds_read_b64_tr_b16 v[18:19], v89 offset:27392
    s_waitcnt lgkmcnt(6)
    v_mfma_f32_32x32x16_bf16 a[96:111], v[28:31], v[192:195], a[96:111]
    ds_read_b64_tr_b16 v[20:21], v89 offset:26688
    ds_read_b64_tr_b16 v[22:23], v89 offset:27456
    s_waitcnt lgkmcnt(6)
    v_mfma_f32_32x32x16_bf16 a[80:95], v[32:35], v[196:199], a[80:95]
    buffer_load_dwordx4 a[176:179], v73, s[20:23], s96 offen offset:3072 sc1
    ds_read_b64_tr_b16 v[24:25], v89 offset:29696
    ds_read_b64_tr_b16 v[26:27], v89 offset:30464
    s_waitcnt lgkmcnt(6)
    v_mfma_f32_32x32x16_bf16 a[96:111], v[36:39], v[196:199], a[96:111]
    ds_read_b64_tr_b16 v[28:29], v89 offset:29760
    ds_read_b64_tr_b16 v[30:31], v89 offset:30528
    s_waitcnt lgkmcnt(6)
    v_mfma_f32_32x32x16_bf16 a[80:95], v[16:19], v[200:203], a[80:95]
    buffer_load_dwordx4 a[180:183], v73, s[20:23], s97 offen offset:0 sc1
    s_waitcnt vmcnt(11)
    s_barrier
    ds_read_b64_tr_b16 v[32:33], v89 offset:40960
    ds_read_b64_tr_b16 v[34:35], v89 offset:41728
    s_waitcnt lgkmcnt(6)
    v_mfma_f32_32x32x16_bf16 a[96:111], v[20:23], v[200:203], a[96:111]
    ds_read_b64_tr_b16 v[36:37], v89 offset:41024
    ds_read_b64_tr_b16 v[38:39], v89 offset:41792
    s_waitcnt lgkmcnt(6)
    v_mfma_f32_32x32x16_bf16 a[80:95], v[24:27], v[204:207], a[80:95]
    buffer_load_dwordx4 a[200:203], v74, s[20:23], s96 offen offset:0 sc1
    ds_read_b64_tr_b16 v[16:17], v89 offset:44032
    ds_read_b64_tr_b16 v[18:19], v89 offset:44800
    s_waitcnt lgkmcnt(6)
    v_mfma_f32_32x32x16_bf16 a[96:111], v[28:31], v[204:207], a[96:111]
    ds_read_b64_tr_b16 v[20:21], v89 offset:44096
    ds_read_b64_tr_b16 v[22:23], v89 offset:44864
    s_waitcnt lgkmcnt(6)
    v_mfma_f32_32x32x16_bf16 a[80:95], v[32:35], v[208:211], a[80:95]
    buffer_load_dwordx4 a[204:207], v74, s[20:23], s96 offen offset:1024 sc1
    ds_read_b64_tr_b16 v[24:25], v89 offset:47104
    ds_read_b64_tr_b16 v[26:27], v89 offset:47872
    s_waitcnt lgkmcnt(6)
    v_mfma_f32_32x32x16_bf16 a[96:111], v[36:39], v[208:211], a[96:111]
    ds_read_b64_tr_b16 v[28:29], v89 offset:47168
    ds_read_b64_tr_b16 v[30:31], v89 offset:47936
    s_waitcnt lgkmcnt(6)
    v_mfma_f32_32x32x16_bf16 a[80:95], v[16:19], v[212:215], a[80:95]
    buffer_load_dwordx4 a[208:211], v74, s[20:23], s96 offen offset:2048 sc1
    ds_read_b64_tr_b16 v[32:33], v89 offset:50176
    ds_read_b64_tr_b16 v[34:35], v89 offset:50944
    s_waitcnt lgkmcnt(6)
    v_mfma_f32_32x32x16_bf16 a[96:111], v[20:23], v[212:215], a[96:111]
    ds_read_b64_tr_b16 v[36:37], v89 offset:50240
    ds_read_b64_tr_b16 v[38:39], v89 offset:51008
    s_waitcnt lgkmcnt(6)
    v_mfma_f32_32x32x16_bf16 a[80:95], v[24:27], v[216:219], a[80:95]
    buffer_load_dwordx4 a[212:215], v74, s[20:23], s96 offen offset:3072 sc1
    s_waitcnt vmcnt(12)
    s_barrier
    ds_read_b64_tr_b16 v[16:17], v88 offset:0
    ds_read_b64_tr_b16 v[18:19], v88 offset:768
    s_waitcnt lgkmcnt(6)
    v_mfma_f32_32x32x16_bf16 a[96:111], v[28:31], v[216:219], a[96:111]
    ds_read_b64_tr_b16 v[20:21], v88 offset:64
    ds_read_b64_tr_b16 v[22:23], v88 offset:832
    s_waitcnt lgkmcnt(6)
    v_mfma_f32_32x32x16_bf16 a[80:95], v[32:35], v[220:223], a[80:95]
    buffer_load_dwordx4 a[216:219], v74, s[20:23], s97 offen offset:0 sc1
    ds_read_b64_tr_b16 v[24:25], v88 offset:3072
    ds_read_b64_tr_b16 v[26:27], v88 offset:3840
    s_waitcnt lgkmcnt(6)
    v_mfma_f32_32x32x16_bf16 a[96:111], v[36:39], v[220:223], a[96:111]
    ds_read_b64_tr_b16 v[28:29], v88 offset:3136
    ds_read_b64_tr_b16 v[30:31], v88 offset:3904
    s_waitcnt lgkmcnt(6)
    v_mfma_f32_32x32x16_bf16 a[80:95], v[16:19], v[224:227], a[80:95]
    buffer_load_dwordx4 a[236:239], v75, s[20:23], s96 offen offset:0 sc1
    ds_read_b64_tr_b16 v[32:33], v88 offset:6144
    ds_read_b64_tr_b16 v[34:35], v88 offset:6912
    s_waitcnt lgkmcnt(6)
    v_mfma_f32_32x32x16_bf16 a[96:111], v[20:23], v[224:227], a[96:111]
    ds_read_b64_tr_b16 v[36:37], v88 offset:6208
    ds_read_b64_tr_b16 v[38:39], v88 offset:6976
    s_waitcnt lgkmcnt(6)
    v_mfma_f32_32x32x16_bf16 a[80:95], v[24:27], v[228:231], a[80:95]
    buffer_load_dwordx4 a[240:243], v75, s[20:23], s96 offen offset:1024 sc1
    ds_read_b64_tr_b16 v[16:17], v88 offset:9216
    ds_read_b64_tr_b16 v[18:19], v88 offset:9984
    s_waitcnt lgkmcnt(6)
    v_mfma_f32_32x32x16_bf16 a[96:111], v[28:31], v[228:231], a[96:111]
    ds_read_b64_tr_b16 v[20:21], v88 offset:9280
    ds_read_b64_tr_b16 v[22:23], v88 offset:10048
    s_cmp_lg_u32 s14, 0
    s_cbranch_scc1 parallel_sum__linear_attn_block__dense_activation_relu__prompt_kernel_a_hbp_pre
    s_lshl_b32 s40, s16, 7
    s_add_u32 s40, s40, 15565824
    v_mov_b32 v1, s40
    s_mov_b64 exec, 1
    buffer_load_dword v95, v1, s[20:23], 0 offen sc0 sc1
    s_mov_b64 exec, -1
parallel_sum__linear_attn_block__dense_activation_relu__prompt_kernel_a_hbp_pre:
    s_waitcnt lgkmcnt(6)
    v_mfma_f32_32x32x16_bf16 a[80:95], v[32:35], v[232:235], a[80:95]
    buffer_load_dwordx4 a[244:247], v75, s[20:23], s96 offen offset:2048 sc1
    s_waitcnt vmcnt(13)
    s_barrier
    ds_read_b64_tr_b16 v[24:25], v88 offset:20480
    ds_read_b64_tr_b16 v[26:27], v88 offset:21248
    s_waitcnt lgkmcnt(6)
    v_mfma_f32_32x32x16_bf16 a[96:111], v[36:39], v[232:235], a[96:111]
    ds_read_b64_tr_b16 v[28:29], v88 offset:20544
    ds_read_b64_tr_b16 v[30:31], v88 offset:21312
    s_waitcnt lgkmcnt(6)
    v_mfma_f32_32x32x16_bf16 a[80:95], v[16:19], v[236:239], a[80:95]
    buffer_load_dwordx4 a[248:251], v75, s[20:23], s96 offen offset:3072 sc1
    ds_read_b64_tr_b16 v[32:33], v88 offset:23552
    ds_read_b64_tr_b16 v[34:35], v88 offset:24320
    s_waitcnt lgkmcnt(6)
    v_mfma_f32_32x32x16_bf16 a[96:111], v[20:23], v[236:239], a[96:111]
    ds_read_b64_tr_b16 v[36:37], v88 offset:23616
    ds_read_b64_tr_b16 v[38:39], v88 offset:24384
    s_waitcnt lgkmcnt(6)
    v_mfma_f32_32x32x16_bf16 a[80:95], v[24:27], v[240:243], a[80:95]
    buffer_load_dwordx4 a[252:255], v75, s[20:23], s97 offen offset:0 sc1
    ds_read_b64_tr_b16 v[16:17], v88 offset:26624
    ds_read_b64_tr_b16 v[18:19], v88 offset:27392
    s_waitcnt lgkmcnt(6)
    v_mfma_f32_32x32x16_bf16 a[96:111], v[28:31], v[240:243], a[96:111]
    ds_read_b64_tr_b16 v[20:21], v88 offset:26688
    ds_read_b64_tr_b16 v[22:23], v88 offset:27456
    s_waitcnt lgkmcnt(6)
    v_mfma_f32_32x32x16_bf16 a[80:95], v[32:35], v[244:247], a[80:95]
    ds_read_b64_tr_b16 v[24:25], v88 offset:29696
    ds_read_b64_tr_b16 v[26:27], v88 offset:30464
    s_waitcnt lgkmcnt(6)
    v_mfma_f32_32x32x16_bf16 a[96:111], v[36:39], v[244:247], a[96:111]
    ds_read_b64_tr_b16 v[28:29], v88 offset:29760
    ds_read_b64_tr_b16 v[30:31], v88 offset:30528
    s_waitcnt lgkmcnt(6)
    v_mfma_f32_32x32x16_bf16 a[80:95], v[16:19], v[248:251], a[80:95]
    s_waitcnt lgkmcnt(4)
    v_mfma_f32_32x32x16_bf16 a[96:111], v[20:23], v[248:251], a[96:111]
    s_waitcnt lgkmcnt(2)
    v_mfma_f32_32x32x16_bf16 a[80:95], v[24:27], v[252:255], a[80:95]
    s_waitcnt lgkmcnt(0)
    v_mfma_f32_32x32x16_bf16 a[96:111], v[28:31], v[252:255], a[96:111]
    s_cmp_lg_u32 s14, 0
    s_cbranch_scc1 parallel_sum__linear_attn_block__dense_activation_relu__prompt_kernel_a_hb_ok
    v_mov_b32 v68, 8
    s_mov_b64 exec, 1
    s_waitcnt vmcnt(3)
    v_cmp_ge_u32 vcc, v95, v68
    s_nop 3
    s_cmp_eq_u64 vcc, 1
    s_cbranch_scc1 parallel_sum__linear_attn_block__dense_activation_relu__prompt_kernel_a_hb_done
    s_mov_b32 s42, 0
parallel_sum__linear_attn_block__dense_activation_relu__prompt_kernel_a_hb_spin:
    buffer_load_dword v95, v1, s[20:23], 0 offen sc0 sc1
    s_waitcnt vmcnt(0)
    v_cmp_ge_u32 vcc, v95, v68
    s_add_u32 s42, s42, 1
    s_cmp_ge_u32 s42, 0x40000
    s_cbranch_scc1 parallel_sum__linear_attn_block__dense_activation_relu__prompt_kernel_a_hb_done
    s_nop 0
    s_cmp_eq_u64 vcc, 1
    s_cbranch_scc0 parallel_sum__linear_attn_block__dense_activation_relu__prompt_kernel_a_hb_spin
parallel_sum__linear_attn_block__dense_activation_relu__prompt_kernel_a_hb_done:
    s_mov_b64 exec, -1
parallel_sum__linear_attn_block__dense_activation_relu__prompt_kernel_a_hb_ok:
    s_barrier
    buffer_load_dwordx4 a[148:151], v70, s[20:23], s24 offen sc1
    v_accvgpr_read_b32 v40, a80
    v_accvgpr_read_b32 v41, a81
    v_cvt_pk_bf16_f32 v48, v40, v41
    v_pk_max_i16 v48, v48, 0
    v_accvgpr_read_b32 v42, a82
    v_accvgpr_read_b32 v43, a83
    buffer_load_dwordx4 a[152:155], v70, s[20:23], s25 offen sc1
    v_cvt_pk_bf16_f32 v49, v42, v43
    v_pk_max_i16 v49, v49, 0
    v_accvgpr_read_b32 v40, a84
    v_accvgpr_read_b32 v41, a85
    v_cvt_pk_bf16_f32 v50, v40, v41
    v_pk_max_i16 v50, v50, 0
    buffer_load_dwordx4 a[156:159], v70, s[20:23], s26 offen sc1
    v_accvgpr_read_b32 v42, a86
    v_accvgpr_read_b32 v43, a87
    v_cvt_pk_bf16_f32 v51, v42, v43
    v_pk_max_i16 v51, v51, 0
    v_accvgpr_read_b32 v40, a88
    v_accvgpr_read_b32 v41, a89
    buffer_load_dwordx4 a[160:163], v70, s[20:23], s27 offen sc1
    v_cvt_pk_bf16_f32 v52, v40, v41
    v_pk_max_i16 v52, v52, 0
    v_accvgpr_read_b32 v42, a90
    v_accvgpr_read_b32 v43, a91
    v_cvt_pk_bf16_f32 v53, v42, v43
    v_pk_max_i16 v53, v53, 0
    buffer_load_dwordx4 a[184:187], v71, s[20:23], s24 offen sc1
    v_accvgpr_read_b32 v40, a92
    v_accvgpr_read_b32 v41, a93
    v_cvt_pk_bf16_f32 v54, v40, v41
    v_pk_max_i16 v54, v54, 0
    v_accvgpr_read_b32 v42, a94
    v_accvgpr_read_b32 v43, a95
    buffer_load_dwordx4 a[188:191], v71, s[20:23], s25 offen sc1
    v_cvt_pk_bf16_f32 v55, v42, v43
    v_pk_max_i16 v55, v55, 0
    buffer_store_dwordx4 v[48:51], v11, s[20:23], s48 offen offset:0 sc1
    buffer_store_dwordx4 v[52:55], v11, s[20:23], s48 offen offset:512 sc1
    v_accvgpr_read_b32 v40, a96
    v_accvgpr_read_b32 v41, a97
    buffer_load_dwordx4 a[192:195], v71, s[20:23], s26 offen sc1
    v_cvt_pk_bf16_f32 v56, v40, v41
    v_pk_max_i16 v56, v56, 0
    v_accvgpr_read_b32 v42, a98
    v_accvgpr_read_b32 v43, a99
    v_cvt_pk_bf16_f32 v57, v42, v43
    v_pk_max_i16 v57, v57, 0
    buffer_load_dwordx4 a[196:199], v71, s[20:23], s27 offen sc1
    v_accvgpr_read_b32 v40, a100
    v_accvgpr_read_b32 v41, a101
    v_cvt_pk_bf16_f32 v58, v40, v41
    v_pk_max_i16 v58, v58, 0
    v_accvgpr_read_b32 v42, a102
    v_accvgpr_read_b32 v43, a103
    buffer_load_dwordx4 a[220:223], v72, s[20:23], s24 offen sc1
    v_cvt_pk_bf16_f32 v59, v42, v43
    v_pk_max_i16 v59, v59, 0
    v_accvgpr_read_b32 v40, a104
    v_accvgpr_read_b32 v41, a105
    v_cvt_pk_bf16_f32 v60, v40, v41
    v_pk_max_i16 v60, v60, 0
    buffer_load_dwordx4 a[224:227], v72, s[20:23], s25 offen sc1
    v_accvgpr_read_b32 v42, a106
    v_accvgpr_read_b32 v43, a107
    v_cvt_pk_bf16_f32 v61, v42, v43
    v_pk_max_i16 v61, v61, 0
    v_accvgpr_read_b32 v40, a108
    v_accvgpr_read_b32 v41, a109
    buffer_load_dwordx4 a[228:231], v72, s[20:23], s26 offen sc1
    v_cvt_pk_bf16_f32 v62, v40, v41
    v_pk_max_i16 v62, v62, 0
    v_accvgpr_read_b32 v42, a110
    v_accvgpr_read_b32 v43, a111
    v_cvt_pk_bf16_f32 v63, v42, v43
    v_pk_max_i16 v63, v63, 0
    buffer_load_dwordx4 a[232:235], v72, s[20:23], s27 offen sc1
    buffer_store_dwordx4 v[56:59], v11, s[20:23], s48 offen offset:1024 sc1
    buffer_store_dwordx4 v[60:63], v11, s[20:23], s48 offen offset:1536 sc1
    s_mov_b32 s8, s76
    s_mov_b32 s9, s77
    s_mov_b32 s10, 2621440
    s_mov_b32 s11, 0x20000
    v_add_u32 v8, 0, v2
    v_mul_u32_u24 v9, 6554, v8
    v_lshrrev_b32 v9, 16, v9
    v_mul_u32_u24 v116, 10, v9
    v_sub_u32 v116, v8, v116
    v_lshlrev_b32 v116, 4, v116
    v_mul_u32_u24 v9, 1280, v9
    v_add_u32 v116, v116, v9
    v_add_u32 v8, 64, v2
    v_mul_u32_u24 v9, 6554, v8
    v_lshrrev_b32 v9, 16, v9
    v_mul_u32_u24 v117, 10, v9
    v_sub_u32 v117, v8, v117
    v_lshlrev_b32 v117, 4, v117
    v_mul_u32_u24 v9, 1280, v9
    v_add_u32 v117, v117, v9
    v_add_u32 v8, 128, v2
    v_mul_u32_u24 v9, 6554, v8
    v_lshrrev_b32 v9, 16, v9
    v_mul_u32_u24 v118, 10, v9
    v_sub_u32 v118, v8, v118
    v_lshlrev_b32 v118, 4, v118
    v_mul_u32_u24 v9, 1280, v9
    v_add_u32 v118, v118, v9
    v_add_u32 v9, 0x40000000, v118
    v_cmp_gt_u32 vcc, 32, v2
    s_nop 1
    v_cndmask_b32 v118, v9, v118, vcc
    s_lshl_b32 s44, s98, 6
    s_lshl_b32 s45, s14, 4
    s_add_u32 s44, s44, s45
    s_mul_i32 s28, s44, 1280
    s_mul_i32 s44, s15, 160
    s_add_u32 s28, s28, s44
    s_mul_i32 s29, s14, 3072
    s_add_u32 s29, s29, 61440
    v_and_b32 v8, 15, v2
    v_mul_u32_u24 v8, 160, v8
    v_lshrrev_b32 v9, 4, v2
    v_lshl_add_u32 v8, v9, 3, v8
    v_add_u32 v8, s29, v8
    v_add_u32 v9, s29, v5
    s_add_u32 s44, s14, 1
    s_and_b32 s44, s44, 3
    s_mul_i32 s44, s44, 15360
    s_add_u32 s44, s44, 0
    v_add_u32 v10, s44, v5
    s_add_u32 s44, s14, 2
    s_and_b32 s44, s44, 3
    s_mul_i32 s44, s44, 15360
    s_add_u32 s44, s44, 5120
    v_add_u32 v11, s44, v5
    s_add_u32 s44, s14, 3
    s_and_b32 s44, s44, 3
    s_mul_i32 s44, s44, 15360
    s_add_u32 s44, s44, 10240
    v_add_u32 v12, s44, v5
    s_mul_i32 s44, s14, 15360
    s_add_u32 s44, s44, 0
    v_add_u32 v13, s44, v5
    s_waitcnt vmcnt(12)
    v_mfma_f32_16x16x32_bf16 v[128:131], a[164:167], a[148:151], 0
    v_mfma_f32_16x16x32_bf16 v[132:135], a[168:171], a[148:151], 0
    s_add_u32 s100, s100, 1
    s_cmp_eq_u32 s100, 10
    s_cselect_b32 s100, 0, s100
    s_lshl_b32 s44, s100, 2
    s_add_u32 s44, s44, 16
    s_mul_i32 s45, s44, 5120
    s_lshl_b32 s44, s44, 10
    s_cmp_eq_u32 s100, 9
    s_cselect_b32 s101, s46, 0
    s_add_u32 s44, s44, s101
    s_add_u32 s45, s45, s101
    v_add_u32 v3, s44, v6
    v_add_u32 v4, s45, v7
    buffer_load_dwordx4 a[128:131], v4, s[20:23], s96 offen offset:0 sc1
    v_mfma_f32_16x16x32_bf16 v[136:139], a[172:175], a[148:151], 0
    v_mfma_f32_16x16x32_bf16 v[140:143], a[176:179], a[148:151], 0
    buffer_load_dwordx4 a[132:135], v4, s[20:23], s96 offen offset:1024 sc1
    v_mfma_f32_16x16x32_bf16 v[144:147], a[180:183], a[148:151], 0
    v_mfma_f32_16x16x32_bf16 v[148:151], a[164:167], a[152:155], 0
    buffer_load_dwordx4 a[136:139], v4, s[20:23], s96 offen offset:2048 sc1
    v_mfma_f32_16x16x32_bf16 v[152:155], a[168:171], a[152:155], 0
    v_mfma_f32_16x16x32_bf16 v[156:159], a[172:175], a[152:155], 0
    buffer_load_dwordx4 a[140:143], v4, s[20:23], s96 offen offset:3072 sc1
    v_mfma_f32_16x16x32_bf16 v[160:163], a[176:179], a[152:155], 0
    v_mfma_f32_16x16x32_bf16 v[164:167], a[180:183], a[152:155], 0
    buffer_load_dwordx4 a[144:147], v4, s[20:23], s97 offen offset:0 sc1
    v_mfma_f32_16x16x32_bf16 v[168:171], a[164:167], a[156:159], 0
    v_mfma_f32_16x16x32_bf16 v[172:175], a[168:171], a[156:159], 0
    buffer_load_dwordx4 a[112:115], v3, s[20:23], s24 offen sc1
    v_mfma_f32_16x16x32_bf16 v[176:179], a[172:175], a[156:159], 0
    v_mfma_f32_16x16x32_bf16 v[180:183], a[176:179], a[156:159], 0
    buffer_load_dwordx4 a[116:119], v3, s[20:23], s25 offen sc1
    v_mfma_f32_16x16x32_bf16 v[184:187], a[180:183], a[156:159], 0
    v_mfma_f32_16x16x32_bf16 v[188:191], a[164:167], a[160:163], 0
    buffer_load_dwordx4 a[120:123], v3, s[20:23], s26 offen sc1
    v_mfma_f32_16x16x32_bf16 v[192:195], a[168:171], a[160:163], 0
    v_mfma_f32_16x16x32_bf16 v[196:199], a[172:175], a[160:163], 0
    buffer_load_dwordx4 a[124:127], v3, s[20:23], s27 offen sc1
    v_mfma_f32_16x16x32_bf16 v[200:203], a[176:179], a[160:163], 0
    v_mfma_f32_16x16x32_bf16 v[204:207], a[180:183], a[160:163], 0
    s_waitcnt vmcnt(9)
    s_barrier
    s_cmp_lg_u32 s14, 0
    s_cbranch_scc1 parallel_sum__linear_attn_block__dense_activation_relu__prompt_kernel_a_own_sig
    v_mov_b32 v108, 1
    s_lshl_b32 s40, s16, 7
    s_add_u32 s40, s40, 15567872
    v_mov_b32 v109, s40
    s_mov_b64 exec, 1
    buffer_atomic_add v108, v109, s[20:23], 0 offen
    s_mov_b64 exec, -1
parallel_sum__linear_attn_block__dense_activation_relu__prompt_kernel_a_own_sig:
    v_mfma_f32_16x16x32_bf16 v[128:131], a[200:203], a[184:187], v[128:131]
    v_mfma_f32_16x16x32_bf16 v[132:135], a[204:207], a[184:187], v[132:135]
    s_add_u32 s100, s100, 1
    s_cmp_eq_u32 s100, 10
    s_cselect_b32 s100, 0, s100
    s_lshl_b32 s44, s100, 2
    s_add_u32 s44, s44, 16
    s_mul_i32 s45, s44, 5120
    s_lshl_b32 s44, s44, 10
    s_cmp_eq_u32 s100, 9
    s_cselect_b32 s101, s46, 0
    s_add_u32 s44, s44, s101
    s_add_u32 s45, s45, s101
    v_add_u32 v3, s44, v6
    v_add_u32 v4, s45, v7
    buffer_load_dwordx4 a[164:167], v4, s[20:23], s96 offen offset:0 sc1
    v_mfma_f32_16x16x32_bf16 v[136:139], a[208:211], a[184:187], v[136:139]
    v_mfma_f32_16x16x32_bf16 v[140:143], a[212:215], a[184:187], v[140:143]
    buffer_load_dwordx4 a[168:171], v4, s[20:23], s96 offen offset:1024 sc1
    v_mfma_f32_16x16x32_bf16 v[144:147], a[216:219], a[184:187], v[144:147]
    v_mfma_f32_16x16x32_bf16 v[148:151], a[200:203], a[188:191], v[148:151]
    buffer_load_dwordx4 a[172:175], v4, s[20:23], s96 offen offset:2048 sc1
    v_mfma_f32_16x16x32_bf16 v[152:155], a[204:207], a[188:191], v[152:155]
    v_mfma_f32_16x16x32_bf16 v[156:159], a[208:211], a[188:191], v[156:159]
    buffer_load_dwordx4 a[176:179], v4, s[20:23], s96 offen offset:3072 sc1
    v_mfma_f32_16x16x32_bf16 v[160:163], a[212:215], a[188:191], v[160:163]
    v_mfma_f32_16x16x32_bf16 v[164:167], a[216:219], a[188:191], v[164:167]
    buffer_load_dwordx4 a[180:183], v4, s[20:23], s97 offen offset:0 sc1
    v_mfma_f32_16x16x32_bf16 v[168:171], a[200:203], a[192:195], v[168:171]
    v_mfma_f32_16x16x32_bf16 v[172:175], a[204:207], a[192:195], v[172:175]
    buffer_load_dwordx4 a[148:151], v3, s[20:23], s24 offen sc1
    v_mfma_f32_16x16x32_bf16 v[176:179], a[208:211], a[192:195], v[176:179]
    v_mfma_f32_16x16x32_bf16 v[180:183], a[212:215], a[192:195], v[180:183]
    buffer_load_dwordx4 a[152:155], v3, s[20:23], s25 offen sc1
    v_mfma_f32_16x16x32_bf16 v[184:187], a[216:219], a[192:195], v[184:187]
    v_mfma_f32_16x16x32_bf16 v[188:191], a[200:203], a[196:199], v[188:191]
    buffer_load_dwordx4 a[156:159], v3, s[20:23], s26 offen sc1
    v_mfma_f32_16x16x32_bf16 v[192:195], a[204:207], a[196:199], v[192:195]
    v_mfma_f32_16x16x32_bf16 v[196:199], a[208:211], a[196:199], v[196:199]
    buffer_load_dwordx4 a[160:163], v3, s[20:23], s27 offen sc1
    v_mfma_f32_16x16x32_bf16 v[200:203], a[212:215], a[196:199], v[200:203]
    v_mfma_f32_16x16x32_bf16 v[204:207], a[216:219], a[196:199], v[204:207]
    v_mfma_f32_16x16x32_bf16 v[128:131], a[236:239], a[220:223], v[128:131]
    v_mfma_f32_16x16x32_bf16 v[132:135], a[240:243], a[220:223], v[132:135]
    s_add_u32 s100, s100, 1
    s_cmp_eq_u32 s100, 10
    s_cselect_b32 s100, 0, s100
    s_lshl_b32 s44, s100, 2
    s_add_u32 s44, s44, 16
    s_mul_i32 s45, s44, 5120
    s_lshl_b32 s44, s44, 10
    s_cmp_eq_u32 s100, 9
    s_cselect_b32 s101, s46, 0
    s_add_u32 s44, s44, s101
    s_add_u32 s45, s45, s101
    v_add_u32 v3, s44, v6
    v_add_u32 v4, s45, v7
    buffer_load_dwordx4 a[200:203], v4, s[20:23], s96 offen offset:0 sc1
    v_mfma_f32_16x16x32_bf16 v[136:139], a[244:247], a[220:223], v[136:139]
    v_mfma_f32_16x16x32_bf16 v[140:143], a[248:251], a[220:223], v[140:143]
    buffer_load_dwordx4 a[204:207], v4, s[20:23], s96 offen offset:1024 sc1
    v_mfma_f32_16x16x32_bf16 v[144:147], a[252:255], a[220:223], v[144:147]
    v_mfma_f32_16x16x32_bf16 v[148:151], a[236:239], a[224:227], v[148:151]
    buffer_load_dwordx4 a[208:211], v4, s[20:23], s96 offen offset:2048 sc1
    v_mfma_f32_16x16x32_bf16 v[152:155], a[240:243], a[224:227], v[152:155]
    v_mfma_f32_16x16x32_bf16 v[156:159], a[244:247], a[224:227], v[156:159]
    buffer_load_dwordx4 a[212:215], v4, s[20:23], s96 offen offset:3072 sc1
    v_mfma_f32_16x16x32_bf16 v[160:163], a[248:251], a[224:227], v[160:163]
    v_mfma_f32_16x16x32_bf16 v[164:167], a[252:255], a[224:227], v[164:167]
    buffer_load_dwordx4 a[216:219], v4, s[20:23], s97 offen offset:0 sc1
    v_mfma_f32_16x16x32_bf16 v[168:171], a[236:239], a[228:231], v[168:171]
    v_mfma_f32_16x16x32_bf16 v[172:175], a[240:243], a[228:231], v[172:175]
    buffer_load_dwordx4 a[184:187], v3, s[20:23], s24 offen sc1
    v_mfma_f32_16x16x32_bf16 v[176:179], a[244:247], a[228:231], v[176:179]
    v_mfma_f32_16x16x32_bf16 v[180:183], a[248:251], a[228:231], v[180:183]
    buffer_load_dwordx4 a[188:191], v3, s[20:23], s25 offen sc1
    v_mfma_f32_16x16x32_bf16 v[184:187], a[252:255], a[228:231], v[184:187]
    v_mfma_f32_16x16x32_bf16 v[188:191], a[236:239], a[232:235], v[188:191]
    buffer_load_dwordx4 a[192:195], v3, s[20:23], s26 offen sc1
    v_mfma_f32_16x16x32_bf16 v[192:195], a[240:243], a[232:235], v[192:195]
    v_mfma_f32_16x16x32_bf16 v[196:199], a[244:247], a[232:235], v[196:199]
    buffer_load_dwordx4 a[196:199], v3, s[20:23], s27 offen sc1
    v_mfma_f32_16x16x32_bf16 v[200:203], a[248:251], a[232:235], v[200:203]
    v_mfma_f32_16x16x32_bf16 v[204:207], a[252:255], a[232:235], v[204:207]
    s_waitcnt vmcnt(18)
    v_mfma_f32_16x16x32_bf16 v[128:131], a[128:131], a[112:115], v[128:131]
    v_mfma_f32_16x16x32_bf16 v[132:135], a[132:135], a[112:115], v[132:135]
    s_add_u32 s100, s100, 1
    s_cmp_eq_u32 s100, 10
    s_cselect_b32 s100, 0, s100
    s_lshl_b32 s44, s100, 2
    s_add_u32 s44, s44, 16
    s_mul_i32 s45, s44, 5120
    s_lshl_b32 s44, s44, 10
    s_cmp_eq_u32 s100, 9
    s_cselect_b32 s101, s46, 0
    s_add_u32 s44, s44, s101
    s_add_u32 s45, s45, s101
    v_add_u32 v3, s44, v6
    v_add_u32 v4, s45, v7
    buffer_load_dwordx4 a[236:239], v4, s[20:23], s96 offen offset:0 sc1
    v_mfma_f32_16x16x32_bf16 v[136:139], a[136:139], a[112:115], v[136:139]
    v_mfma_f32_16x16x32_bf16 v[140:143], a[140:143], a[112:115], v[140:143]
    buffer_load_dwordx4 a[240:243], v4, s[20:23], s96 offen offset:1024 sc1
    v_mfma_f32_16x16x32_bf16 v[144:147], a[144:147], a[112:115], v[144:147]
    v_mfma_f32_16x16x32_bf16 v[148:151], a[128:131], a[116:119], v[148:151]
    buffer_load_dwordx4 a[244:247], v4, s[20:23], s96 offen offset:2048 sc1
    v_mfma_f32_16x16x32_bf16 v[152:155], a[132:135], a[116:119], v[152:155]
    v_mfma_f32_16x16x32_bf16 v[156:159], a[136:139], a[116:119], v[156:159]
    buffer_load_dwordx4 a[248:251], v4, s[20:23], s96 offen offset:3072 sc1
    v_mfma_f32_16x16x32_bf16 v[160:163], a[140:143], a[116:119], v[160:163]
    v_mfma_f32_16x16x32_bf16 v[164:167], a[144:147], a[116:119], v[164:167]
    buffer_load_dwordx4 a[252:255], v4, s[20:23], s97 offen offset:0 sc1
    v_mfma_f32_16x16x32_bf16 v[168:171], a[128:131], a[120:123], v[168:171]
    v_mfma_f32_16x16x32_bf16 v[172:175], a[132:135], a[120:123], v[172:175]
    buffer_load_dwordx4 a[220:223], v3, s[20:23], s24 offen sc1
    v_mfma_f32_16x16x32_bf16 v[176:179], a[136:139], a[120:123], v[176:179]
    v_mfma_f32_16x16x32_bf16 v[180:183], a[140:143], a[120:123], v[180:183]
    buffer_load_dwordx4 a[224:227], v3, s[20:23], s25 offen sc1
    v_mfma_f32_16x16x32_bf16 v[184:187], a[144:147], a[120:123], v[184:187]
    v_mfma_f32_16x16x32_bf16 v[188:191], a[128:131], a[124:127], v[188:191]
    buffer_load_dwordx4 a[228:231], v3, s[20:23], s26 offen sc1
    v_mfma_f32_16x16x32_bf16 v[192:195], a[132:135], a[124:127], v[192:195]
    v_mfma_f32_16x16x32_bf16 v[196:199], a[136:139], a[124:127], v[196:199]
    buffer_load_dwordx4 a[232:235], v3, s[20:23], s27 offen sc1
    v_mfma_f32_16x16x32_bf16 v[200:203], a[140:143], a[124:127], v[200:203]
    v_mfma_f32_16x16x32_bf16 v[204:207], a[144:147], a[124:127], v[204:207]
    s_waitcnt vmcnt(18)
    v_mfma_f32_16x16x32_bf16 v[128:131], a[164:167], a[148:151], v[128:131]
    v_mfma_f32_16x16x32_bf16 v[132:135], a[168:171], a[148:151], v[132:135]
    s_add_u32 s100, s100, 1
    s_cmp_eq_u32 s100, 10
    s_cselect_b32 s100, 0, s100
    s_lshl_b32 s44, s100, 2
    s_add_u32 s44, s44, 16
    s_mul_i32 s45, s44, 5120
    s_lshl_b32 s44, s44, 10
    s_cmp_eq_u32 s100, 9
    s_cselect_b32 s101, s46, 0
    s_add_u32 s44, s44, s101
    s_add_u32 s45, s45, s101
    v_add_u32 v3, s44, v6
    v_add_u32 v4, s45, v7
    buffer_load_dwordx4 a[128:131], v4, s[20:23], s96 offen offset:0 sc1
    v_mfma_f32_16x16x32_bf16 v[136:139], a[172:175], a[148:151], v[136:139]
    v_mfma_f32_16x16x32_bf16 v[140:143], a[176:179], a[148:151], v[140:143]
    buffer_load_dwordx4 a[132:135], v4, s[20:23], s96 offen offset:1024 sc1
    v_mfma_f32_16x16x32_bf16 v[144:147], a[180:183], a[148:151], v[144:147]
    v_mfma_f32_16x16x32_bf16 v[148:151], a[164:167], a[152:155], v[148:151]
    buffer_load_dwordx4 a[136:139], v4, s[20:23], s96 offen offset:2048 sc1
    v_mfma_f32_16x16x32_bf16 v[152:155], a[168:171], a[152:155], v[152:155]
    v_mfma_f32_16x16x32_bf16 v[156:159], a[172:175], a[152:155], v[156:159]
    buffer_load_dwordx4 a[140:143], v4, s[20:23], s96 offen offset:3072 sc1
    v_mfma_f32_16x16x32_bf16 v[160:163], a[176:179], a[152:155], v[160:163]
    v_mfma_f32_16x16x32_bf16 v[164:167], a[180:183], a[152:155], v[164:167]
    buffer_load_dwordx4 a[144:147], v4, s[20:23], s97 offen offset:0 sc1
    v_mfma_f32_16x16x32_bf16 v[168:171], a[164:167], a[156:159], v[168:171]
    v_mfma_f32_16x16x32_bf16 v[172:175], a[168:171], a[156:159], v[172:175]
    buffer_load_dwordx4 a[112:115], v3, s[20:23], s24 offen sc1
    v_mfma_f32_16x16x32_bf16 v[176:179], a[172:175], a[156:159], v[176:179]
    v_mfma_f32_16x16x32_bf16 v[180:183], a[176:179], a[156:159], v[180:183]
    buffer_load_dwordx4 a[116:119], v3, s[20:23], s25 offen sc1
    v_mfma_f32_16x16x32_bf16 v[184:187], a[180:183], a[156:159], v[184:187]
    v_mfma_f32_16x16x32_bf16 v[188:191], a[164:167], a[160:163], v[188:191]
    buffer_load_dwordx4 a[120:123], v3, s[20:23], s26 offen sc1
    v_mfma_f32_16x16x32_bf16 v[192:195], a[168:171], a[160:163], v[192:195]
    v_mfma_f32_16x16x32_bf16 v[196:199], a[172:175], a[160:163], v[196:199]
    buffer_load_dwordx4 a[124:127], v3, s[20:23], s27 offen sc1
    v_mfma_f32_16x16x32_bf16 v[200:203], a[176:179], a[160:163], v[200:203]
    v_mfma_f32_16x16x32_bf16 v[204:207], a[180:183], a[160:163], v[204:207]
    s_waitcnt vmcnt(18)
    v_mfma_f32_16x16x32_bf16 v[128:131], a[200:203], a[184:187], v[128:131]
    v_mfma_f32_16x16x32_bf16 v[132:135], a[204:207], a[184:187], v[132:135]
    s_add_u32 s100, s100, 1
    s_cmp_eq_u32 s100, 10
    s_cselect_b32 s100, 0, s100
    s_lshl_b32 s44, s100, 2
    s_add_u32 s44, s44, 16
    s_mul_i32 s45, s44, 5120
    s_lshl_b32 s44, s44, 10
    s_cmp_eq_u32 s100, 9
    s_cselect_b32 s101, s46, 0
    s_add_u32 s44, s44, s101
    s_add_u32 s45, s45, s101
    v_add_u32 v3, s44, v6
    v_add_u32 v4, s45, v7
    buffer_load_dwordx4 a[164:167], v4, s[20:23], s96 offen offset:0 sc1
    v_mfma_f32_16x16x32_bf16 v[136:139], a[208:211], a[184:187], v[136:139]
    v_mfma_f32_16x16x32_bf16 v[140:143], a[212:215], a[184:187], v[140:143]
    buffer_load_dwordx4 a[168:171], v4, s[20:23], s96 offen offset:1024 sc1
    v_mfma_f32_16x16x32_bf16 v[144:147], a[216:219], a[184:187], v[144:147]
    v_mfma_f32_16x16x32_bf16 v[148:151], a[200:203], a[188:191], v[148:151]
    buffer_load_dwordx4 a[172:175], v4, s[20:23], s96 offen offset:2048 sc1
    v_mfma_f32_16x16x32_bf16 v[152:155], a[204:207], a[188:191], v[152:155]
    v_mfma_f32_16x16x32_bf16 v[156:159], a[208:211], a[188:191], v[156:159]
    buffer_load_dwordx4 a[176:179], v4, s[20:23], s96 offen offset:3072 sc1
    v_mfma_f32_16x16x32_bf16 v[160:163], a[212:215], a[188:191], v[160:163]
    v_mfma_f32_16x16x32_bf16 v[164:167], a[216:219], a[188:191], v[164:167]
    buffer_load_dwordx4 a[180:183], v4, s[20:23], s97 offen offset:0 sc1
    v_mfma_f32_16x16x32_bf16 v[168:171], a[200:203], a[192:195], v[168:171]
    v_mfma_f32_16x16x32_bf16 v[172:175], a[204:207], a[192:195], v[172:175]
    buffer_load_dwordx4 a[148:151], v3, s[20:23], s24 offen sc1
    v_mfma_f32_16x16x32_bf16 v[176:179], a[208:211], a[192:195], v[176:179]
    v_mfma_f32_16x16x32_bf16 v[180:183], a[212:215], a[192:195], v[180:183]
    buffer_load_dwordx4 a[152:155], v3, s[20:23], s25 offen sc1
    v_mfma_f32_16x16x32_bf16 v[184:187], a[216:219], a[192:195], v[184:187]
    v_mfma_f32_16x16x32_bf16 v[188:191], a[200:203], a[196:199], v[188:191]
    buffer_load_dwordx4 a[156:159], v3, s[20:23], s26 offen sc1
    v_mfma_f32_16x16x32_bf16 v[192:195], a[204:207], a[196:199], v[192:195]
    v_mfma_f32_16x16x32_bf16 v[196:199], a[208:211], a[196:199], v[196:199]
    buffer_load_dwordx4 a[160:163], v3, s[20:23], s27 offen sc1
    v_mfma_f32_16x16x32_bf16 v[200:203], a[212:215], a[196:199], v[200:203]
    v_mfma_f32_16x16x32_bf16 v[204:207], a[216:219], a[196:199], v[204:207]
    s_cmp_lg_u32 s14, 0
    s_cbranch_scc1 parallel_sum__linear_attn_block__dense_activation_relu__prompt_kernel_a_hap_pre
    s_lshl_b32 s40, s16, 7
    s_add_u32 s40, s40, 15567872
    v_mov_b32 v1, s40
    s_mov_b64 exec, 1
    buffer_load_dword v95, v1, s[20:23], 0 offen sc0 sc1
    s_mov_b64 exec, -1
parallel_sum__linear_attn_block__dense_activation_relu__prompt_kernel_a_hap_pre:
    s_waitcnt vmcnt(18)
    v_mfma_f32_16x16x32_bf16 v[128:131], a[236:239], a[220:223], v[128:131]
    v_mfma_f32_16x16x32_bf16 v[132:135], a[240:243], a[220:223], v[132:135]
    s_add_u32 s100, s100, 1
    s_cmp_eq_u32 s100, 10
    s_cselect_b32 s100, 0, s100
    s_lshl_b32 s44, s100, 2
    s_add_u32 s44, s44, 16
    s_mul_i32 s45, s44, 5120
    s_lshl_b32 s44, s44, 10
    s_cmp_eq_u32 s100, 9
    s_cselect_b32 s101, s46, 0
    s_add_u32 s44, s44, s101
    s_add_u32 s45, s45, s101
    v_add_u32 v3, s44, v6
    v_add_u32 v4, s45, v7
    buffer_load_dwordx4 a[200:203], v4, s[20:23], s96 offen offset:0 sc1
    v_mfma_f32_16x16x32_bf16 v[136:139], a[244:247], a[220:223], v[136:139]
    v_mfma_f32_16x16x32_bf16 v[140:143], a[248:251], a[220:223], v[140:143]
    buffer_load_dwordx4 a[204:207], v4, s[20:23], s96 offen offset:1024 sc1
    v_mfma_f32_16x16x32_bf16 v[144:147], a[252:255], a[220:223], v[144:147]
    v_mfma_f32_16x16x32_bf16 v[148:151], a[236:239], a[224:227], v[148:151]
    buffer_load_dwordx4 a[208:211], v4, s[20:23], s96 offen offset:2048 sc1
    v_mfma_f32_16x16x32_bf16 v[152:155], a[240:243], a[224:227], v[152:155]
    v_mfma_f32_16x16x32_bf16 v[156:159], a[244:247], a[224:227], v[156:159]
    buffer_load_dwordx4 a[212:215], v4, s[20:23], s96 offen offset:3072 sc1
    v_mfma_f32_16x16x32_bf16 v[160:163], a[248:251], a[224:227], v[160:163]
    v_mfma_f32_16x16x32_bf16 v[164:167], a[252:255], a[224:227], v[164:167]
    buffer_load_dwordx4 a[216:219], v4, s[20:23], s97 offen offset:0 sc1
    v_mfma_f32_16x16x32_bf16 v[168:171], a[236:239], a[228:231], v[168:171]
    v_mfma_f32_16x16x32_bf16 v[172:175], a[240:243], a[228:231], v[172:175]
    buffer_load_dwordx4 a[184:187], v3, s[20:23], s24 offen sc1
    v_mfma_f32_16x16x32_bf16 v[176:179], a[244:247], a[228:231], v[176:179]
    v_mfma_f32_16x16x32_bf16 v[180:183], a[248:251], a[228:231], v[180:183]
    buffer_load_dwordx4 a[188:191], v3, s[20:23], s25 offen sc1
    v_mfma_f32_16x16x32_bf16 v[184:187], a[252:255], a[228:231], v[184:187]
    v_mfma_f32_16x16x32_bf16 v[188:191], a[236:239], a[232:235], v[188:191]
    buffer_load_dwordx4 a[192:195], v3, s[20:23], s26 offen sc1
    v_mfma_f32_16x16x32_bf16 v[192:195], a[240:243], a[232:235], v[192:195]
    v_mfma_f32_16x16x32_bf16 v[196:199], a[244:247], a[232:235], v[196:199]
    buffer_load_dwordx4 a[196:199], v3, s[20:23], s27 offen sc1
    v_mfma_f32_16x16x32_bf16 v[200:203], a[248:251], a[232:235], v[200:203]
    v_mfma_f32_16x16x32_bf16 v[204:207], a[252:255], a[232:235], v[204:207]
    s_cmp_lg_u32 s14, 0
    s_cbranch_scc1 parallel_sum__linear_attn_block__dense_activation_relu__prompt_kernel_a_ha_ok
    v_mov_b32 v106, 8
    s_mov_b64 exec, 1
    s_waitcnt vmcnt(9)
    v_cmp_ge_u32 vcc, v95, v106
    s_nop 3
    s_cmp_eq_u64 vcc, 1
    s_cbranch_scc1 parallel_sum__linear_attn_block__dense_activation_relu__prompt_kernel_a_ha_done
    s_mov_b32 s42, 0
parallel_sum__linear_attn_block__dense_activation_relu__prompt_kernel_a_ha_spin:
    buffer_load_dword v95, v1, s[20:23], 0 offen sc0 sc1
    s_waitcnt vmcnt(0)
    v_cmp_ge_u32 vcc, v95, v106
    s_add_u32 s42, s42, 1
    s_cmp_ge_u32 s42, 0x40000
    s_cbranch_scc1 parallel_sum__linear_attn_block__dense_activation_relu__prompt_kernel_a_ha_done
    s_nop 0
    s_cmp_eq_u64 vcc, 1
    s_cbranch_scc0 parallel_sum__linear_attn_block__dense_activation_relu__prompt_kernel_a_ha_spin
parallel_sum__linear_attn_block__dense_activation_relu__prompt_kernel_a_ha_done:
    s_mov_b64 exec, -1
parallel_sum__linear_attn_block__dense_activation_relu__prompt_kernel_a_ha_ok:
    s_barrier
    s_waitcnt vmcnt(18)
    v_mfma_f32_16x16x32_bf16 v[128:131], a[128:131], a[112:115], v[128:131]
    v_mfma_f32_16x16x32_bf16 v[132:135], a[132:135], a[112:115], v[132:135]
    s_mul_i32 s44, s99, 16384
    s_lshr_b32 s44, s44, 16
    s_mul_i32 s44, s44, 4
    s_sub_u32 s100, s99, s44
    s_lshl_b32 s44, s100, 2
    s_add_u32 s44, s44, 0
    s_mul_i32 s45, s44, 5120
    s_lshl_b32 s44, s44, 10
    v_add_u32 v3, s44, v6
    v_add_u32 v4, s45, v7
    buffer_load_dwordx4 a[236:239], v4, s[20:23], s96 offen offset:0 sc1
    v_mfma_f32_16x16x32_bf16 v[136:139], a[136:139], a[112:115], v[136:139]
    v_mfma_f32_16x16x32_bf16 v[140:143], a[140:143], a[112:115], v[140:143]
    buffer_load_dwordx4 a[240:243], v4, s[20:23], s96 offen offset:1024 sc1
    v_mfma_f32_16x16x32_bf16 v[144:147], a[144:147], a[112:115], v[144:147]
    v_mfma_f32_16x16x32_bf16 v[148:151], a[128:131], a[116:119], v[148:151]
    buffer_load_dwordx4 a[244:247], v4, s[20:23], s96 offen offset:2048 sc1
    v_mfma_f32_16x16x32_bf16 v[152:155], a[132:135], a[116:119], v[152:155]
    v_mfma_f32_16x16x32_bf16 v[156:159], a[136:139], a[116:119], v[156:159]
    buffer_load_dwordx4 a[248:251], v4, s[20:23], s96 offen offset:3072 sc1
    v_mfma_f32_16x16x32_bf16 v[160:163], a[140:143], a[116:119], v[160:163]
    v_mfma_f32_16x16x32_bf16 v[164:167], a[144:147], a[116:119], v[164:167]
    buffer_load_dwordx4 a[252:255], v4, s[20:23], s97 offen offset:0 sc1
    v_mfma_f32_16x16x32_bf16 v[168:171], a[128:131], a[120:123], v[168:171]
    v_mfma_f32_16x16x32_bf16 v[172:175], a[132:135], a[120:123], v[172:175]
    buffer_load_dwordx4 a[220:223], v3, s[20:23], s24 offen sc1
    v_mfma_f32_16x16x32_bf16 v[176:179], a[136:139], a[120:123], v[176:179]
    v_mfma_f32_16x16x32_bf16 v[180:183], a[140:143], a[120:123], v[180:183]
    buffer_load_dwordx4 a[224:227], v3, s[20:23], s25 offen sc1
    v_mfma_f32_16x16x32_bf16 v[184:187], a[144:147], a[120:123], v[184:187]
    v_mfma_f32_16x16x32_bf16 v[188:191], a[128:131], a[124:127], v[188:191]
    buffer_load_dwordx4 a[228:231], v3, s[20:23], s26 offen sc1
    v_mfma_f32_16x16x32_bf16 v[192:195], a[132:135], a[124:127], v[192:195]
    v_mfma_f32_16x16x32_bf16 v[196:199], a[136:139], a[124:127], v[196:199]
    buffer_load_dwordx4 a[232:235], v3, s[20:23], s27 offen sc1
    v_mfma_f32_16x16x32_bf16 v[200:203], a[140:143], a[124:127], v[200:203]
    v_mfma_f32_16x16x32_bf16 v[204:207], a[144:147], a[124:127], v[204:207]
    s_waitcnt vmcnt(18)
    v_mfma_f32_16x16x32_bf16 v[128:131], a[164:167], a[148:151], v[128:131]
    v_mfma_f32_16x16x32_bf16 v[132:135], a[168:171], a[148:151], v[132:135]
    s_add_u32 s100, s100, 1
    s_cmp_eq_u32 s100, 4
    s_cselect_b32 s100, 0, s100
    s_lshl_b32 s44, s100, 2
    s_add_u32 s44, s44, 0
    s_mul_i32 s45, s44, 5120
    s_lshl_b32 s44, s44, 10
    v_add_u32 v3, s44, v6
    v_add_u32 v4, s45, v7
    buffer_load_dwordx4 a[128:131], v4, s[20:23], s96 offen offset:0 sc1
    v_mfma_f32_16x16x32_bf16 v[136:139], a[172:175], a[148:151], v[136:139]
    v_mfma_f32_16x16x32_bf16 v[140:143], a[176:179], a[148:151], v[140:143]
    buffer_load_dwordx4 a[132:135], v4, s[20:23], s96 offen offset:1024 sc1
    v_mfma_f32_16x16x32_bf16 v[144:147], a[180:183], a[148:151], v[144:147]
    v_mfma_f32_16x16x32_bf16 v[148:151], a[164:167], a[152:155], v[148:151]
    buffer_load_dwordx4 a[136:139], v4, s[20:23], s96 offen offset:2048 sc1
    v_mfma_f32_16x16x32_bf16 v[152:155], a[168:171], a[152:155], v[152:155]
    v_mfma_f32_16x16x32_bf16 v[156:159], a[172:175], a[152:155], v[156:159]
    buffer_load_dwordx4 a[140:143], v4, s[20:23], s96 offen offset:3072 sc1
    v_mfma_f32_16x16x32_bf16 v[160:163], a[176:179], a[152:155], v[160:163]
    v_mfma_f32_16x16x32_bf16 v[164:167], a[180:183], a[152:155], v[164:167]
    buffer_load_dwordx4 a[144:147], v4, s[20:23], s97 offen offset:0 sc1
    v_mfma_f32_16x16x32_bf16 v[168:171], a[164:167], a[156:159], v[168:171]
    v_mfma_f32_16x16x32_bf16 v[172:175], a[168:171], a[156:159], v[172:175]
    buffer_load_dwordx4 a[112:115], v3, s[20:23], s24 offen sc1
    v_mfma_f32_16x16x32_bf16 v[176:179], a[172:175], a[156:159], v[176:179]
    v_mfma_f32_16x16x32_bf16 v[180:183], a[176:179], a[156:159], v[180:183]
    buffer_load_dwordx4 a[116:119], v3, s[20:23], s25 offen sc1
    v_mfma_f32_16x16x32_bf16 v[184:187], a[180:183], a[156:159], v[184:187]
    v_mfma_f32_16x16x32_bf16 v[188:191], a[164:167], a[160:163], v[188:191]
    buffer_load_dwordx4 a[120:123], v3, s[20:23], s26 offen sc1
    v_mfma_f32_16x16x32_bf16 v[192:195], a[168:171], a[160:163], v[192:195]
    v_mfma_f32_16x16x32_bf16 v[196:199], a[172:175], a[160:163], v[196:199]
    buffer_load_dwordx4 a[124:127], v3, s[20:23], s27 offen sc1
    v_mfma_f32_16x16x32_bf16 v[200:203], a[176:179], a[160:163], v[200:203]
    v_mfma_f32_16x16x32_bf16 v[204:207], a[180:183], a[160:163], v[204:207]
    s_waitcnt vmcnt(18)
    v_mfma_f32_16x16x32_bf16 v[128:131], a[200:203], a[184:187], v[128:131]
    v_mfma_f32_16x16x32_bf16 v[132:135], a[204:207], a[184:187], v[132:135]
    s_add_u32 s100, s100, 1
    s_cmp_eq_u32 s100, 4
    s_cselect_b32 s100, 0, s100
    s_lshl_b32 s44, s100, 2
    s_add_u32 s44, s44, 0
    s_mul_i32 s45, s44, 5120
    s_lshl_b32 s44, s44, 10
    v_add_u32 v3, s44, v6
    v_add_u32 v4, s45, v7
    buffer_load_dwordx4 a[164:167], v4, s[20:23], s96 offen offset:0 sc1
    v_mfma_f32_16x16x32_bf16 v[136:139], a[208:211], a[184:187], v[136:139]
    v_mfma_f32_16x16x32_bf16 v[140:143], a[212:215], a[184:187], v[140:143]
    buffer_load_dwordx4 a[168:171], v4, s[20:23], s96 offen offset:1024 sc1
    v_mfma_f32_16x16x32_bf16 v[144:147], a[216:219], a[184:187], v[144:147]
    v_mfma_f32_16x16x32_bf16 v[148:151], a[200:203], a[188:191], v[148:151]
    buffer_load_dwordx4 a[172:175], v4, s[20:23], s96 offen offset:2048 sc1
    v_mfma_f32_16x16x32_bf16 v[152:155], a[204:207], a[188:191], v[152:155]
    v_mfma_f32_16x16x32_bf16 v[156:159], a[208:211], a[188:191], v[156:159]
    buffer_load_dwordx4 a[176:179], v4, s[20:23], s96 offen offset:3072 sc1
    v_mfma_f32_16x16x32_bf16 v[160:163], a[212:215], a[188:191], v[160:163]
    v_mfma_f32_16x16x32_bf16 v[164:167], a[216:219], a[188:191], v[164:167]
    buffer_load_dwordx4 a[180:183], v4, s[20:23], s97 offen offset:0 sc1
    v_mfma_f32_16x16x32_bf16 v[168:171], a[200:203], a[192:195], v[168:171]
    v_mfma_f32_16x16x32_bf16 v[172:175], a[204:207], a[192:195], v[172:175]
    buffer_load_dwordx4 a[148:151], v3, s[20:23], s24 offen sc1
    v_mfma_f32_16x16x32_bf16 v[176:179], a[208:211], a[192:195], v[176:179]
    v_mfma_f32_16x16x32_bf16 v[180:183], a[212:215], a[192:195], v[180:183]
    buffer_load_dwordx4 a[152:155], v3, s[20:23], s25 offen sc1
    v_mfma_f32_16x16x32_bf16 v[184:187], a[216:219], a[192:195], v[184:187]
    v_mfma_f32_16x16x32_bf16 v[188:191], a[200:203], a[196:199], v[188:191]
    buffer_load_dwordx4 a[156:159], v3, s[20:23], s26 offen sc1
    v_mfma_f32_16x16x32_bf16 v[192:195], a[204:207], a[196:199], v[192:195]
    v_mfma_f32_16x16x32_bf16 v[196:199], a[208:211], a[196:199], v[196:199]
    buffer_load_dwordx4 a[160:163], v3, s[20:23], s27 offen sc1
    v_mfma_f32_16x16x32_bf16 v[200:203], a[212:215], a[196:199], v[200:203]
    v_mfma_f32_16x16x32_bf16 v[204:207], a[216:219], a[196:199], v[204:207]
    s_cmp_lg_u32 s14, 0
    s_cbranch_scc1 parallel_sum__linear_attn_block__dense_activation_relu__prompt_kernel_a_obp_pre
    s_lshl_b32 s40, s16, 7
    s_add_u32 s40, s40, 15569920
    v_mov_b32 v1, s40
    s_mov_b64 exec, 1
    buffer_load_dword v95, v1, s[20:23], 0 offen sc0 sc1
    s_mov_b64 exec, -1
parallel_sum__linear_attn_block__dense_activation_relu__prompt_kernel_a_obp_pre:
    s_waitcnt vmcnt(18)
    v_mfma_f32_16x16x32_bf16 v[128:131], a[236:239], a[220:223], v[128:131]
    v_mfma_f32_16x16x32_bf16 v[132:135], a[240:243], a[220:223], v[132:135]
    s_add_u32 s100, s100, 1
    s_cmp_eq_u32 s100, 4
    s_cselect_b32 s100, 0, s100
    s_lshl_b32 s44, s100, 2
    s_add_u32 s44, s44, 0
    s_mul_i32 s45, s44, 5120
    s_lshl_b32 s44, s44, 10
    v_add_u32 v3, s44, v6
    v_add_u32 v4, s45, v7
    buffer_load_dwordx4 a[200:203], v4, s[20:23], s96 offen offset:0 sc1
    v_mfma_f32_16x16x32_bf16 v[136:139], a[244:247], a[220:223], v[136:139]
    v_mfma_f32_16x16x32_bf16 v[140:143], a[248:251], a[220:223], v[140:143]
    buffer_load_dwordx4 a[204:207], v4, s[20:23], s96 offen offset:1024 sc1
    v_mfma_f32_16x16x32_bf16 v[144:147], a[252:255], a[220:223], v[144:147]
    v_mfma_f32_16x16x32_bf16 v[148:151], a[236:239], a[224:227], v[148:151]
    buffer_load_dwordx4 a[208:211], v4, s[20:23], s96 offen offset:2048 sc1
    v_mfma_f32_16x16x32_bf16 v[152:155], a[240:243], a[224:227], v[152:155]
    v_mfma_f32_16x16x32_bf16 v[156:159], a[244:247], a[224:227], v[156:159]
    buffer_load_dwordx4 a[212:215], v4, s[20:23], s96 offen offset:3072 sc1
    v_mfma_f32_16x16x32_bf16 v[160:163], a[248:251], a[224:227], v[160:163]
    v_mfma_f32_16x16x32_bf16 v[164:167], a[252:255], a[224:227], v[164:167]
    buffer_load_dwordx4 a[216:219], v4, s[20:23], s97 offen offset:0 sc1
    v_mfma_f32_16x16x32_bf16 v[168:171], a[236:239], a[228:231], v[168:171]
    v_mfma_f32_16x16x32_bf16 v[172:175], a[240:243], a[228:231], v[172:175]
    buffer_load_dwordx4 a[184:187], v3, s[20:23], s24 offen sc1
    v_mfma_f32_16x16x32_bf16 v[176:179], a[244:247], a[228:231], v[176:179]
    v_mfma_f32_16x16x32_bf16 v[180:183], a[248:251], a[228:231], v[180:183]
    buffer_load_dwordx4 a[188:191], v3, s[20:23], s25 offen sc1
    v_mfma_f32_16x16x32_bf16 v[184:187], a[252:255], a[228:231], v[184:187]
    v_mfma_f32_16x16x32_bf16 v[188:191], a[236:239], a[232:235], v[188:191]
    buffer_load_dwordx4 a[192:195], v3, s[20:23], s26 offen sc1
    v_mfma_f32_16x16x32_bf16 v[192:195], a[240:243], a[232:235], v[192:195]
    v_mfma_f32_16x16x32_bf16 v[196:199], a[244:247], a[232:235], v[196:199]
    buffer_load_dwordx4 a[196:199], v3, s[20:23], s27 offen sc1
    v_mfma_f32_16x16x32_bf16 v[200:203], a[248:251], a[232:235], v[200:203]
    v_mfma_f32_16x16x32_bf16 v[204:207], a[252:255], a[232:235], v[204:207]
    s_cmp_lg_u32 s14, 0
    s_cbranch_scc1 parallel_sum__linear_attn_block__dense_activation_relu__prompt_kernel_a_ob_ok
    v_mov_b32 v106, 8
    s_mov_b64 exec, 1
    s_waitcnt vmcnt(9)
    v_cmp_ge_u32 vcc, v95, v106
    s_nop 3
    s_cmp_eq_u64 vcc, 1
    s_cbranch_scc1 parallel_sum__linear_attn_block__dense_activation_relu__prompt_kernel_a_ob_done
    s_mov_b32 s42, 0
parallel_sum__linear_attn_block__dense_activation_relu__prompt_kernel_a_ob_spin:
    buffer_load_dword v95, v1, s[20:23], 0 offen sc0 sc1
    s_waitcnt vmcnt(0)
    v_cmp_ge_u32 vcc, v95, v106
    s_add_u32 s42, s42, 1
    s_cmp_ge_u32 s42, 0x40000
    s_cbranch_scc1 parallel_sum__linear_attn_block__dense_activation_relu__prompt_kernel_a_ob_done
    s_nop 0
    s_cmp_eq_u64 vcc, 1
    s_cbranch_scc0 parallel_sum__linear_attn_block__dense_activation_relu__prompt_kernel_a_ob_spin
parallel_sum__linear_attn_block__dense_activation_relu__prompt_kernel_a_ob_done:
    s_mov_b64 exec, -1
parallel_sum__linear_attn_block__dense_activation_relu__prompt_kernel_a_ob_ok:
    s_barrier
    s_waitcnt vmcnt(18)
    v_mfma_f32_16x16x32_bf16 v[128:131], a[128:131], a[112:115], v[128:131]
    v_mfma_f32_16x16x32_bf16 v[132:135], a[132:135], a[112:115], v[132:135]
    s_mul_i32 s44, s99, 13108
    s_lshr_b32 s44, s44, 16
    s_mul_i32 s44, s44, 5
    s_sub_u32 s100, s99, s44
    s_lshl_b32 s44, s100, 2
    s_add_u32 s44, s44, 54
    s_mul_i32 s45, s44, 5120
    s_lshl_b32 s44, s44, 10
    v_add_u32 v3, s44, v6
    v_add_u32 v4, s45, v7
    buffer_load_dwordx4 a[236:239], v4, s[20:23], s96 offen offset:0 sc1
    v_mfma_f32_16x16x32_bf16 v[136:139], a[136:139], a[112:115], v[136:139]
    v_mfma_f32_16x16x32_bf16 v[140:143], a[140:143], a[112:115], v[140:143]
    buffer_load_dwordx4 a[240:243], v4, s[20:23], s96 offen offset:1024 sc1
    v_mfma_f32_16x16x32_bf16 v[144:147], a[144:147], a[112:115], v[144:147]
    v_mfma_f32_16x16x32_bf16 v[148:151], a[128:131], a[116:119], v[148:151]
    buffer_load_dwordx4 a[244:247], v4, s[20:23], s96 offen offset:2048 sc1
    v_mfma_f32_16x16x32_bf16 v[152:155], a[132:135], a[116:119], v[152:155]
    v_mfma_f32_16x16x32_bf16 v[156:159], a[136:139], a[116:119], v[156:159]
    buffer_load_dwordx4 a[248:251], v4, s[20:23], s96 offen offset:3072 sc1
    v_mfma_f32_16x16x32_bf16 v[160:163], a[140:143], a[116:119], v[160:163]
    v_mfma_f32_16x16x32_bf16 v[164:167], a[144:147], a[116:119], v[164:167]
    buffer_load_dwordx4 a[252:255], v4, s[20:23], s97 offen offset:0 sc1
    v_mfma_f32_16x16x32_bf16 v[168:171], a[128:131], a[120:123], v[168:171]
    v_mfma_f32_16x16x32_bf16 v[172:175], a[132:135], a[120:123], v[172:175]
    buffer_load_dwordx4 a[220:223], v3, s[20:23], s24 offen sc1
    v_mfma_f32_16x16x32_bf16 v[176:179], a[136:139], a[120:123], v[176:179]
    v_mfma_f32_16x16x32_bf16 v[180:183], a[140:143], a[120:123], v[180:183]
    buffer_load_dwordx4 a[224:227], v3, s[20:23], s25 offen sc1
    v_mfma_f32_16x16x32_bf16 v[184:187], a[144:147], a[120:123], v[184:187]
    v_mfma_f32_16x16x32_bf16 v[188:191], a[128:131], a[124:127], v[188:191]
    buffer_load_dwordx4 a[228:231], v3, s[20:23], s26 offen sc1
    v_mfma_f32_16x16x32_bf16 v[192:195], a[132:135], a[124:127], v[192:195]
    v_mfma_f32_16x16x32_bf16 v[196:199], a[136:139], a[124:127], v[196:199]
    buffer_load_dwordx4 a[232:235], v3, s[20:23], s27 offen sc1
    v_mfma_f32_16x16x32_bf16 v[200:203], a[140:143], a[124:127], v[200:203]
    v_mfma_f32_16x16x32_bf16 v[204:207], a[144:147], a[124:127], v[204:207]
    s_waitcnt vmcnt(18)
    v_mfma_f32_16x16x32_bf16 v[128:131], a[164:167], a[148:151], v[128:131]
    v_mfma_f32_16x16x32_bf16 v[132:135], a[168:171], a[148:151], v[132:135]
    s_add_u32 s100, s100, 1
    s_cmp_eq_u32 s100, 5
    s_cselect_b32 s100, 0, s100
    s_lshl_b32 s44, s100, 2
    s_add_u32 s44, s44, 54
    s_mul_i32 s45, s44, 5120
    s_lshl_b32 s44, s44, 10
    v_add_u32 v3, s44, v6
    v_add_u32 v4, s45, v7
    buffer_load_dwordx4 a[128:131], v4, s[20:23], s96 offen offset:0 sc1
    v_mfma_f32_16x16x32_bf16 v[136:139], a[172:175], a[148:151], v[136:139]
    v_mfma_f32_16x16x32_bf16 v[140:143], a[176:179], a[148:151], v[140:143]
    buffer_load_dwordx4 a[132:135], v4, s[20:23], s96 offen offset:1024 sc1
    v_mfma_f32_16x16x32_bf16 v[144:147], a[180:183], a[148:151], v[144:147]
    v_mfma_f32_16x16x32_bf16 v[148:151], a[164:167], a[152:155], v[148:151]
    buffer_load_dwordx4 a[136:139], v4, s[20:23], s96 offen offset:2048 sc1
    v_mfma_f32_16x16x32_bf16 v[152:155], a[168:171], a[152:155], v[152:155]
    v_mfma_f32_16x16x32_bf16 v[156:159], a[172:175], a[152:155], v[156:159]
    buffer_load_dwordx4 a[140:143], v4, s[20:23], s96 offen offset:3072 sc1
    v_mfma_f32_16x16x32_bf16 v[160:163], a[176:179], a[152:155], v[160:163]
    v_mfma_f32_16x16x32_bf16 v[164:167], a[180:183], a[152:155], v[164:167]
    buffer_load_dwordx4 a[144:147], v4, s[20:23], s97 offen offset:0 sc1
    v_mfma_f32_16x16x32_bf16 v[168:171], a[164:167], a[156:159], v[168:171]
    v_mfma_f32_16x16x32_bf16 v[172:175], a[168:171], a[156:159], v[172:175]
    buffer_load_dwordx4 a[112:115], v3, s[20:23], s24 offen sc1
    v_mfma_f32_16x16x32_bf16 v[176:179], a[172:175], a[156:159], v[176:179]
    v_mfma_f32_16x16x32_bf16 v[180:183], a[176:179], a[156:159], v[180:183]
    buffer_load_dwordx4 a[116:119], v3, s[20:23], s25 offen sc1
    v_mfma_f32_16x16x32_bf16 v[184:187], a[180:183], a[156:159], v[184:187]
    v_mfma_f32_16x16x32_bf16 v[188:191], a[164:167], a[160:163], v[188:191]
    buffer_load_dwordx4 a[120:123], v3, s[20:23], s26 offen sc1
    v_mfma_f32_16x16x32_bf16 v[192:195], a[168:171], a[160:163], v[192:195]
    v_mfma_f32_16x16x32_bf16 v[196:199], a[172:175], a[160:163], v[196:199]
    buffer_load_dwordx4 a[124:127], v3, s[20:23], s27 offen sc1
    v_mfma_f32_16x16x32_bf16 v[200:203], a[176:179], a[160:163], v[200:203]
    v_mfma_f32_16x16x32_bf16 v[204:207], a[180:183], a[160:163], v[204:207]
    s_waitcnt vmcnt(18)
    v_mfma_f32_16x16x32_bf16 v[128:131], a[200:203], a[184:187], v[128:131]
    v_mfma_f32_16x16x32_bf16 v[132:135], a[204:207], a[184:187], v[132:135]
    s_add_u32 s100, s100, 1
    s_cmp_eq_u32 s100, 5
    s_cselect_b32 s100, 0, s100
    s_lshl_b32 s44, s100, 2
    s_add_u32 s44, s44, 54
    s_mul_i32 s45, s44, 5120
    s_lshl_b32 s44, s44, 10
    v_add_u32 v3, s44, v6
    v_add_u32 v4, s45, v7
    buffer_load_dwordx4 a[164:167], v4, s[20:23], s96 offen offset:0 sc1
    v_mfma_f32_16x16x32_bf16 v[136:139], a[208:211], a[184:187], v[136:139]
    v_mfma_f32_16x16x32_bf16 v[140:143], a[212:215], a[184:187], v[140:143]
    buffer_load_dwordx4 a[168:171], v4, s[20:23], s96 offen offset:1024 sc1
    v_mfma_f32_16x16x32_bf16 v[144:147], a[216:219], a[184:187], v[144:147]
    v_mfma_f32_16x16x32_bf16 v[148:151], a[200:203], a[188:191], v[148:151]
    buffer_load_dwordx4 a[172:175], v4, s[20:23], s96 offen offset:2048 sc1
    v_mfma_f32_16x16x32_bf16 v[152:155], a[204:207], a[188:191], v[152:155]
    v_mfma_f32_16x16x32_bf16 v[156:159], a[208:211], a[188:191], v[156:159]
    buffer_load_dwordx4 a[176:179], v4, s[20:23], s96 offen offset:3072 sc1
    v_mfma_f32_16x16x32_bf16 v[160:163], a[212:215], a[188:191], v[160:163]
    v_mfma_f32_16x16x32_bf16 v[164:167], a[216:219], a[188:191], v[164:167]
    buffer_load_dwordx4 a[180:183], v4, s[20:23], s97 offen offset:0 sc1
    v_mfma_f32_16x16x32_bf16 v[168:171], a[200:203], a[192:195], v[168:171]
    v_mfma_f32_16x16x32_bf16 v[172:175], a[204:207], a[192:195], v[172:175]
    buffer_load_dwordx4 a[148:151], v3, s[20:23], s24 offen sc1
    v_mfma_f32_16x16x32_bf16 v[176:179], a[208:211], a[192:195], v[176:179]
    v_mfma_f32_16x16x32_bf16 v[180:183], a[212:215], a[192:195], v[180:183]
    buffer_load_dwordx4 a[152:155], v3, s[20:23], s25 offen sc1
    v_mfma_f32_16x16x32_bf16 v[184:187], a[216:219], a[192:195], v[184:187]
    v_mfma_f32_16x16x32_bf16 v[188:191], a[200:203], a[196:199], v[188:191]
    buffer_load_dwordx4 a[156:159], v3, s[20:23], s26 offen sc1
    v_mfma_f32_16x16x32_bf16 v[192:195], a[204:207], a[196:199], v[192:195]
    v_mfma_f32_16x16x32_bf16 v[196:199], a[208:211], a[196:199], v[196:199]
    buffer_load_dwordx4 a[160:163], v3, s[20:23], s27 offen sc1
    v_mfma_f32_16x16x32_bf16 v[200:203], a[212:215], a[196:199], v[200:203]
    v_mfma_f32_16x16x32_bf16 v[204:207], a[216:219], a[196:199], v[204:207]
    s_waitcnt vmcnt(18)
    v_mfma_f32_16x16x32_bf16 v[128:131], a[236:239], a[220:223], v[128:131]
    v_mfma_f32_16x16x32_bf16 v[132:135], a[240:243], a[220:223], v[132:135]
    s_add_u32 s100, s100, 1
    s_cmp_eq_u32 s100, 5
    s_cselect_b32 s100, 0, s100
    s_lshl_b32 s44, s100, 2
    s_add_u32 s44, s44, 54
    s_mul_i32 s45, s44, 5120
    s_lshl_b32 s44, s44, 10
    v_add_u32 v3, s44, v6
    v_add_u32 v4, s45, v7
    buffer_load_dwordx4 a[200:203], v4, s[20:23], s96 offen offset:0 sc1
    v_mfma_f32_16x16x32_bf16 v[136:139], a[244:247], a[220:223], v[136:139]
    v_mfma_f32_16x16x32_bf16 v[140:143], a[248:251], a[220:223], v[140:143]
    buffer_load_dwordx4 a[204:207], v4, s[20:23], s96 offen offset:1024 sc1
    v_mfma_f32_16x16x32_bf16 v[144:147], a[252:255], a[220:223], v[144:147]
    v_mfma_f32_16x16x32_bf16 v[148:151], a[236:239], a[224:227], v[148:151]
    buffer_load_dwordx4 a[208:211], v4, s[20:23], s96 offen offset:2048 sc1
    v_mfma_f32_16x16x32_bf16 v[152:155], a[240:243], a[224:227], v[152:155]
    v_mfma_f32_16x16x32_bf16 v[156:159], a[244:247], a[224:227], v[156:159]
    buffer_load_dwordx4 a[212:215], v4, s[20:23], s96 offen offset:3072 sc1
    v_mfma_f32_16x16x32_bf16 v[160:163], a[248:251], a[224:227], v[160:163]
    v_mfma_f32_16x16x32_bf16 v[164:167], a[252:255], a[224:227], v[164:167]
    buffer_load_dwordx4 a[216:219], v4, s[20:23], s97 offen offset:0 sc1
    v_mfma_f32_16x16x32_bf16 v[168:171], a[236:239], a[228:231], v[168:171]
    v_mfma_f32_16x16x32_bf16 v[172:175], a[240:243], a[228:231], v[172:175]
    buffer_load_dwordx4 a[184:187], v3, s[20:23], s24 offen sc1
    v_mfma_f32_16x16x32_bf16 v[176:179], a[244:247], a[228:231], v[176:179]
    v_mfma_f32_16x16x32_bf16 v[180:183], a[248:251], a[228:231], v[180:183]
    buffer_load_dwordx4 a[188:191], v3, s[20:23], s25 offen sc1
    v_mfma_f32_16x16x32_bf16 v[184:187], a[252:255], a[228:231], v[184:187]
    v_mfma_f32_16x16x32_bf16 v[188:191], a[236:239], a[232:235], v[188:191]
    buffer_load_dwordx4 a[192:195], v3, s[20:23], s26 offen sc1
    v_mfma_f32_16x16x32_bf16 v[192:195], a[240:243], a[232:235], v[192:195]
    v_mfma_f32_16x16x32_bf16 v[196:199], a[244:247], a[232:235], v[196:199]
    buffer_load_dwordx4 a[196:199], v3, s[20:23], s27 offen sc1
    v_mfma_f32_16x16x32_bf16 v[200:203], a[248:251], a[232:235], v[200:203]
    v_mfma_f32_16x16x32_bf16 v[204:207], a[252:255], a[232:235], v[204:207]
    s_waitcnt vmcnt(18)
    v_mfma_f32_16x16x32_bf16 v[128:131], a[128:131], a[112:115], v[128:131]
    v_mfma_f32_16x16x32_bf16 v[132:135], a[132:135], a[112:115], v[132:135]
    s_add_u32 s100, s100, 1
    s_cmp_eq_u32 s100, 5
    s_cselect_b32 s100, 0, s100
    s_lshl_b32 s44, s100, 2
    s_add_u32 s44, s44, 54
    s_mul_i32 s45, s44, 5120
    s_lshl_b32 s44, s44, 10
    v_add_u32 v3, s44, v6
    v_add_u32 v4, s45, v7
    buffer_load_dwordx4 a[236:239], v4, s[20:23], s96 offen offset:0 sc1
    v_mfma_f32_16x16x32_bf16 v[136:139], a[136:139], a[112:115], v[136:139]
    v_mfma_f32_16x16x32_bf16 v[140:143], a[140:143], a[112:115], v[140:143]
    buffer_load_dwordx4 a[240:243], v4, s[20:23], s96 offen offset:1024 sc1
    v_mfma_f32_16x16x32_bf16 v[144:147], a[144:147], a[112:115], v[144:147]
    v_mfma_f32_16x16x32_bf16 v[148:151], a[128:131], a[116:119], v[148:151]
    buffer_load_dwordx4 a[244:247], v4, s[20:23], s96 offen offset:2048 sc1
    v_mfma_f32_16x16x32_bf16 v[152:155], a[132:135], a[116:119], v[152:155]
    v_mfma_f32_16x16x32_bf16 v[156:159], a[136:139], a[116:119], v[156:159]
    buffer_load_dwordx4 a[248:251], v4, s[20:23], s96 offen offset:3072 sc1
    v_mfma_f32_16x16x32_bf16 v[160:163], a[140:143], a[116:119], v[160:163]
    v_mfma_f32_16x16x32_bf16 v[164:167], a[144:147], a[116:119], v[164:167]
    buffer_load_dwordx4 a[252:255], v4, s[20:23], s97 offen offset:0 sc1
    v_mfma_f32_16x16x32_bf16 v[168:171], a[128:131], a[120:123], v[168:171]
    v_mfma_f32_16x16x32_bf16 v[172:175], a[132:135], a[120:123], v[172:175]
    buffer_load_dwordx4 a[220:223], v3, s[20:23], s24 offen sc1
    v_mfma_f32_16x16x32_bf16 v[176:179], a[136:139], a[120:123], v[176:179]
    v_mfma_f32_16x16x32_bf16 v[180:183], a[140:143], a[120:123], v[180:183]
    buffer_load_dwordx4 a[224:227], v3, s[20:23], s25 offen sc1
    v_mfma_f32_16x16x32_bf16 v[184:187], a[144:147], a[120:123], v[184:187]
    v_mfma_f32_16x16x32_bf16 v[188:191], a[128:131], a[124:127], v[188:191]
    buffer_load_dwordx4 a[228:231], v3, s[20:23], s26 offen sc1
    v_mfma_f32_16x16x32_bf16 v[192:195], a[132:135], a[124:127], v[192:195]
    v_mfma_f32_16x16x32_bf16 v[196:199], a[136:139], a[124:127], v[196:199]
    buffer_load_dwordx4 a[232:235], v3, s[20:23], s27 offen sc1
    v_mfma_f32_16x16x32_bf16 v[200:203], a[140:143], a[124:127], v[200:203]
    v_mfma_f32_16x16x32_bf16 v[204:207], a[144:147], a[124:127], v[204:207]
    s_waitcnt vmcnt(18)
    v_mfma_f32_16x16x32_bf16 v[128:131], a[164:167], a[148:151], v[128:131]
    v_mfma_f32_16x16x32_bf16 v[132:135], a[168:171], a[148:151], v[132:135]
    s_add_u32 m0, s29, 0
    s_nop 0
    buffer_load_dwordx4 v116, s[4:7], s28 offen lds
    v_mfma_f32_16x16x32_bf16 v[136:139], a[172:175], a[148:151], v[136:139]
    v_mfma_f32_16x16x32_bf16 v[140:143], a[176:179], a[148:151], v[140:143]
    s_add_u32 m0, s29, 1024
    s_nop 0
    buffer_load_dwordx4 v117, s[4:7], s28 offen lds
    v_mfma_f32_16x16x32_bf16 v[144:147], a[180:183], a[148:151], v[144:147]
    v_mfma_f32_16x16x32_bf16 v[148:151], a[164:167], a[152:155], v[148:151]
    s_add_u32 m0, s29, 2048
    s_nop 0
    buffer_load_dwordx4 v118, s[4:7], s28 offen lds
    v_mfma_f32_16x16x32_bf16 v[152:155], a[168:171], a[152:155], v[152:155]
    v_mfma_f32_16x16x32_bf16 v[156:159], a[172:175], a[152:155], v[156:159]
    v_mfma_f32_16x16x32_bf16 v[160:163], a[176:179], a[152:155], v[160:163]
    v_mfma_f32_16x16x32_bf16 v[164:167], a[180:183], a[152:155], v[164:167]
    v_mfma_f32_16x16x32_bf16 v[168:171], a[164:167], a[156:159], v[168:171]
    v_mfma_f32_16x16x32_bf16 v[172:175], a[168:171], a[156:159], v[172:175]
    v_mfma_f32_16x16x32_bf16 v[176:179], a[172:175], a[156:159], v[176:179]
    v_mfma_f32_16x16x32_bf16 v[180:183], a[176:179], a[156:159], v[180:183]
    v_mfma_f32_16x16x32_bf16 v[184:187], a[180:183], a[156:159], v[184:187]
    v_mfma_f32_16x16x32_bf16 v[188:191], a[164:167], a[160:163], v[188:191]
    v_mfma_f32_16x16x32_bf16 v[192:195], a[168:171], a[160:163], v[192:195]
    v_mfma_f32_16x16x32_bf16 v[196:199], a[172:175], a[160:163], v[196:199]
    v_mfma_f32_16x16x32_bf16 v[200:203], a[176:179], a[160:163], v[200:203]
    v_mfma_f32_16x16x32_bf16 v[204:207], a[180:183], a[160:163], v[204:207]
    s_waitcnt vmcnt(12)
    v_mfma_f32_16x16x32_bf16 v[128:131], a[200:203], a[184:187], v[128:131]
    v_mfma_f32_16x16x32_bf16 v[132:135], a[204:207], a[184:187], v[132:135]
    v_mfma_f32_16x16x32_bf16 v[136:139], a[208:211], a[184:187], v[136:139]
    v_mfma_f32_16x16x32_bf16 v[140:143], a[212:215], a[184:187], v[140:143]
    v_mfma_f32_16x16x32_bf16 v[144:147], a[216:219], a[184:187], v[144:147]
    v_mfma_f32_16x16x32_bf16 v[148:151], a[200:203], a[188:191], v[148:151]
    v_mfma_f32_16x16x32_bf16 v[152:155], a[204:207], a[188:191], v[152:155]
    v_mfma_f32_16x16x32_bf16 v[156:159], a[208:211], a[188:191], v[156:159]
    v_mfma_f32_16x16x32_bf16 v[160:163], a[212:215], a[188:191], v[160:163]
    v_mfma_f32_16x16x32_bf16 v[164:167], a[216:219], a[188:191], v[164:167]
    v_mfma_f32_16x16x32_bf16 v[168:171], a[200:203], a[192:195], v[168:171]
    v_mfma_f32_16x16x32_bf16 v[172:175], a[204:207], a[192:195], v[172:175]
    v_mfma_f32_16x16x32_bf16 v[176:179], a[208:211], a[192:195], v[176:179]
    v_mfma_f32_16x16x32_bf16 v[180:183], a[212:215], a[192:195], v[180:183]
    v_mfma_f32_16x16x32_bf16 v[184:187], a[216:219], a[192:195], v[184:187]
    v_mfma_f32_16x16x32_bf16 v[188:191], a[200:203], a[196:199], v[188:191]
    v_mfma_f32_16x16x32_bf16 v[192:195], a[204:207], a[196:199], v[192:195]
    v_mfma_f32_16x16x32_bf16 v[196:199], a[208:211], a[196:199], v[196:199]
    v_mfma_f32_16x16x32_bf16 v[200:203], a[212:215], a[196:199], v[200:203]
    v_mfma_f32_16x16x32_bf16 v[204:207], a[216:219], a[196:199], v[204:207]
    s_waitcnt vmcnt(3)
    v_mfma_f32_16x16x32_bf16 v[148:151], a[236:239], a[224:227], v[148:151]
    v_mfma_f32_16x16x32_bf16 v[152:155], a[240:243], a[224:227], v[152:155]
    v_mfma_f32_16x16x32_bf16 v[156:159], a[244:247], a[224:227], v[156:159]
    v_mfma_f32_16x16x32_bf16 v[160:163], a[248:251], a[224:227], v[160:163]
    v_mfma_f32_16x16x32_bf16 v[164:167], a[252:255], a[224:227], v[164:167]
    v_mfma_f32_16x16x32_bf16 v[168:171], a[236:239], a[228:231], v[168:171]
    v_mfma_f32_16x16x32_bf16 v[172:175], a[240:243], a[228:231], v[172:175]
    v_mfma_f32_16x16x32_bf16 v[176:179], a[244:247], a[228:231], v[176:179]
    s_nop 0
    ds_write_b128 v10, v[148:151] offset:0
    v_mfma_f32_16x16x32_bf16 v[180:183], a[248:251], a[228:231], v[180:183]
    ds_write_b128 v10, v[152:155] offset:1024
    v_mfma_f32_16x16x32_bf16 v[184:187], a[252:255], a[228:231], v[184:187]
    ds_write_b128 v10, v[156:159] offset:2048
    v_mfma_f32_16x16x32_bf16 v[188:191], a[236:239], a[232:235], v[188:191]
    ds_write_b128 v10, v[160:163] offset:3072
    v_mfma_f32_16x16x32_bf16 v[192:195], a[240:243], a[232:235], v[192:195]
    ds_write_b128 v10, v[164:167] offset:4096
    v_mfma_f32_16x16x32_bf16 v[196:199], a[244:247], a[232:235], v[196:199]
    ds_write_b128 v11, v[168:171] offset:0
    v_mfma_f32_16x16x32_bf16 v[200:203], a[248:251], a[232:235], v[200:203]
    ds_write_b128 v11, v[172:175] offset:1024
    v_mfma_f32_16x16x32_bf16 v[204:207], a[252:255], a[232:235], v[204:207]
    ds_write_b128 v11, v[176:179] offset:2048
    v_mfma_f32_16x16x32_bf16 v[128:131], a[236:239], a[220:223], v[128:131]
    ds_write_b128 v11, v[180:183] offset:3072
    v_mfma_f32_16x16x32_bf16 v[132:135], a[240:243], a[220:223], v[132:135]
    ds_write_b128 v11, v[184:187] offset:4096
    v_mfma_f32_16x16x32_bf16 v[136:139], a[244:247], a[220:223], v[136:139]
    ds_write_b128 v12, v[188:191] offset:0
    v_mfma_f32_16x16x32_bf16 v[140:143], a[248:251], a[220:223], v[140:143]
    ds_write_b128 v12, v[192:195] offset:1024
    v_mfma_f32_16x16x32_bf16 v[144:147], a[252:255], a[220:223], v[144:147]
    ds_write_b128 v12, v[196:199] offset:2048
    ds_write_b128 v12, v[200:203] offset:3072
    ds_write_b128 v12, v[204:207] offset:4096
    s_waitcnt lgkmcnt(0)
    s_barrier
    ds_read_b128 v[148:151], v13 offset:0
    ds_read_b128 v[168:171], v13 offset:5120
    ds_read_b128 v[188:191], v13 offset:10240
    ds_read_b128 v[152:155], v13 offset:1024
    ds_read_b128 v[172:175], v13 offset:6144
    ds_read_b128 v[192:195], v13 offset:11264
    ds_read_b128 v[156:159], v13 offset:2048
    ds_read_b128 v[176:179], v13 offset:7168
    ds_read_b128 v[196:199], v13 offset:12288
    ds_read_b128 v[160:163], v13 offset:3072
    ds_read_b128 v[180:183], v13 offset:8192
    ds_read_b128 v[200:203], v13 offset:13312
    ds_read_b128 v[164:167], v13 offset:4096
    ds_read_b128 v[184:187], v13 offset:9216
    ds_read_b128 v[204:207], v13 offset:14336
    s_waitcnt vmcnt(0)
    ds_read_b64 v[96:97], v8 offset:0
    ds_read_b64 v[98:99], v8 offset:32
    ds_read_b64 v[100:101], v8 offset:64
    ds_read_b64 v[102:103], v8 offset:96
    ds_read_b64 v[104:105], v8 offset:128
    s_waitcnt lgkmcnt(15)
    v_add_f32 v128, v128, v148
    v_add_f32 v129, v129, v149
    v_add_f32 v130, v130, v150
    v_add_f32 v131, v131, v151
    v_add_f32 v128, v128, v168
    v_add_f32 v129, v129, v169
    v_add_f32 v130, v130, v170
    v_add_f32 v131, v131, v171
    v_add_f32 v128, v128, v188
    v_add_f32 v129, v129, v189
    v_add_f32 v130, v130, v190
    v_add_f32 v131, v131, v191
    s_waitcnt lgkmcnt(4)
    v_lshlrev_b32 v112, 16, v96
    v_and_b32 v113, 0xffff0000, v96
    v_lshlrev_b32 v114, 16, v97
    v_and_b32 v115, 0xffff0000, v97
    v_add_f32 v128, v128, v112
    v_add_f32 v129, v129, v113
    v_add_f32 v130, v130, v114
    v_add_f32 v131, v131, v115
    v_cvt_pk_bf16_f32 v96, v128, v129
    v_cvt_pk_bf16_f32 v97, v130, v131
    ds_write_b64 v8, v[96:97] offset:0
    v_add_f32 v132, v132, v152
    v_add_f32 v133, v133, v153
    v_add_f32 v134, v134, v154
    v_add_f32 v135, v135, v155
    v_add_f32 v132, v132, v172
    v_add_f32 v133, v133, v173
    v_add_f32 v134, v134, v174
    v_add_f32 v135, v135, v175
    v_add_f32 v132, v132, v192
    v_add_f32 v133, v133, v193
    v_add_f32 v134, v134, v194
    v_add_f32 v135, v135, v195
    s_waitcnt lgkmcnt(4)
    v_lshlrev_b32 v112, 16, v98
    v_and_b32 v113, 0xffff0000, v98
    v_lshlrev_b32 v114, 16, v99
    v_and_b32 v115, 0xffff0000, v99
    v_add_f32 v132, v132, v112
    v_add_f32 v133, v133, v113
    v_add_f32 v134, v134, v114
    v_add_f32 v135, v135, v115
    v_cvt_pk_bf16_f32 v98, v132, v133
    v_cvt_pk_bf16_f32 v99, v134, v135
    ds_write_b64 v8, v[98:99] offset:32
    v_add_f32 v136, v136, v156
    v_add_f32 v137, v137, v157
    v_add_f32 v138, v138, v158
    v_add_f32 v139, v139, v159
    v_add_f32 v136, v136, v176
    v_add_f32 v137, v137, v177
    v_add_f32 v138, v138, v178
    v_add_f32 v139, v139, v179
    v_add_f32 v136, v136, v196
    v_add_f32 v137, v137, v197
    v_add_f32 v138, v138, v198
    v_add_f32 v139, v139, v199
    s_waitcnt lgkmcnt(4)
    v_lshlrev_b32 v112, 16, v100
    v_and_b32 v113, 0xffff0000, v100
    v_lshlrev_b32 v114, 16, v101
    v_and_b32 v115, 0xffff0000, v101
    v_add_f32 v136, v136, v112
    v_add_f32 v137, v137, v113
    v_add_f32 v138, v138, v114
    v_add_f32 v139, v139, v115
    v_cvt_pk_bf16_f32 v100, v136, v137
    v_cvt_pk_bf16_f32 v101, v138, v139
    ds_write_b64 v8, v[100:101] offset:64
    v_add_f32 v140, v140, v160
    v_add_f32 v141, v141, v161
    v_add_f32 v142, v142, v162
    v_add_f32 v143, v143, v163
    v_add_f32 v140, v140, v180
    v_add_f32 v141, v141, v181
    v_add_f32 v142, v142, v182
    v_add_f32 v143, v143, v183
    v_add_f32 v140, v140, v200
    v_add_f32 v141, v141, v201
    v_add_f32 v142, v142, v202
    v_add_f32 v143, v143, v203
    s_waitcnt lgkmcnt(4)
    v_lshlrev_b32 v112, 16, v102
    v_and_b32 v113, 0xffff0000, v102
    v_lshlrev_b32 v114, 16, v103
    v_and_b32 v115, 0xffff0000, v103
    v_add_f32 v140, v140, v112
    v_add_f32 v141, v141, v113
    v_add_f32 v142, v142, v114
    v_add_f32 v143, v143, v115
    v_cvt_pk_bf16_f32 v102, v140, v141
    v_cvt_pk_bf16_f32 v103, v142, v143
    ds_write_b64 v8, v[102:103] offset:96
    v_add_f32 v144, v144, v164
    v_add_f32 v145, v145, v165
    v_add_f32 v146, v146, v166
    v_add_f32 v147, v147, v167
    v_add_f32 v144, v144, v184
    v_add_f32 v145, v145, v185
    v_add_f32 v146, v146, v186
    v_add_f32 v147, v147, v187
    v_add_f32 v144, v144, v204
    v_add_f32 v145, v145, v205
    v_add_f32 v146, v146, v206
    v_add_f32 v147, v147, v207
    s_waitcnt lgkmcnt(4)
    v_lshlrev_b32 v112, 16, v104
    v_and_b32 v113, 0xffff0000, v104
    v_lshlrev_b32 v114, 16, v105
    v_and_b32 v115, 0xffff0000, v105
    v_add_f32 v144, v144, v112
    v_add_f32 v145, v145, v113
    v_add_f32 v146, v146, v114
    v_add_f32 v147, v147, v115
    v_cvt_pk_bf16_f32 v104, v144, v145
    v_cvt_pk_bf16_f32 v105, v146, v147
    ds_write_b64 v8, v[104:105] offset:128
    s_waitcnt lgkmcnt(0)
    ds_read_b128 v[148:151], v9 offset:0
    ds_read_b128 v[152:155], v9 offset:1024
    ds_read_b128 v[156:159], v9 offset:2048
    s_waitcnt lgkmcnt(2)
    buffer_store_dwordx4 v[148:151], v116, s[8:11], s28 offen
    s_waitcnt lgkmcnt(1)
    buffer_store_dwordx4 v[152:155], v117, s[8:11], s28 offen
    s_waitcnt lgkmcnt(0)
    buffer_store_dwordx4 v[156:159], v118, s[8:11], s28 offen
    s_branch parallel_sum__linear_attn_block__dense_activation_relu__prompt_kernel_end
parallel_sum__linear_attn_block__dense_activation_relu__prompt_kernel_B:
    s_mov_b32 s32, s78
    s_mov_b32 s33, s79
    s_mov_b32 s34, 256
    s_mov_b32 s35, 0x20000
    s_mov_b32 s56, 0x358637bd
    s_mov_b32 s57, 0x3fb8aa3b
    s_mov_b32 s60, 0
    s_mov_b32 s61, -1
    s_mov_b32 s62, 0x0000ffff
    s_mov_b32 s63, 0x0000ffff
    v_lshrrev_b32 v16, 5, v2
    v_lshlrev_b32 v16, 3, v16
    v_bfe_u32 v17, v2, 2, 2
    v_add_u32 v16, v16, v17
    v_bfe_u32 v17, v2, 4, 1
    v_lshlrev_b32 v17, 5, v17
    v_and_b32 v18, 3, v2
    v_lshl_add_u32 v17, v18, 3, v17
    v_mul_u32_u24 v18, 320, v16
    v_add_u32 v14, v18, v17
    v_add_u32 v15, 61440, v14
    v_mul_u32_u24 v18, 192, v16
    v_add_u32 v88, v18, v17
    v_add_u32 v89, 61440, v88
    v_bfe_u32 v16, v2, 4, 1
    v_mul_u32_u24 v16, 75776, v16
    v_and_b32 v17, 15, v2
    v_lshl_add_u32 v16, v17, 4, v16
    v_lshrrev_b32 v17, 5, v2
    v_lshl_add_u32 v11, v17, 8, v16
    s_mov_b32 s24, s72
    s_mov_b32 s25, s73
    s_mov_b32 s26, 2211840
    s_mov_b32 s27, 0x20000
    s_mov_b32 s28, s66
    s_mov_b32 s29, s67
    s_mov_b32 s30, 2457600
    s_mov_b32 s31, 0x20000
    s_mul_i32 s36, s14, 55296
    s_mul_i32 s37, s14, 61440
    s_sub_u32 s40, s2, 128
    s_lshl_b32 s40, s40, 2
    s_add_u32 s40, s40, s14
    s_mul_i32 s98, s40, 52429
    s_lshr_b32 s98, s98, 18
    s_mul_i32 s41, s98, 5
    s_sub_u32 s99, s40, s41
    s_lshl_b32 s45, s98, 5
    s_add_u32 s46, s45, 16
    s_mov_b32 s8, s74
    s_mov_b32 s9, s75
    s_mov_b32 s10, 2211840
    s_mov_b32 s11, 0x20000
    s_cmp_lt_u32 s98, 54
    s_cbranch_scc1 parallel_sum__linear_attn_block__dense_activation_relu__prompt_kernel_bB_fmt_rows
    s_mov_b32 s8, s68
    s_mov_b32 s9, s69
    s_mov_b32 s10, 819200
    s_sub_u32 s42, s98, 54
    s_mul_i32 s43, s42, 52429
    s_lshr_b32 s43, s43, 18
    s_mul_i32 s41, s43, 5
    s_sub_u32 s42, s42, s41
    s_mul_i32 s43, s43, 160
    s_mov_b32 s45, 0
    s_mov_b32 s46, 16
    s_cmp_eq_u32 s42, 1
    s_cselect_b32 s45, 32, s45
    s_cselect_b32 s46, 48, s46
    s_cmp_eq_u32 s42, 2
    s_cselect_b32 s45, 64, s45
    s_cselect_b32 s46, 144, s46
    s_cmp_eq_u32 s42, 3
    s_cselect_b32 s45, 80, s45
    s_cselect_b32 s46, 96, s46
    s_cmp_eq_u32 s42, 4
    s_cselect_b32 s45, 112, s45
    s_cselect_b32 s46, 128, s46
    s_add_u32 s45, s45, s43
    s_add_u32 s46, s46, s43
parallel_sum__linear_attn_block__dense_activation_relu__prompt_kernel_bB_fmt_rows:
    s_mul_i32 s41, s99, 256
    s_mul_i32 s42, s45, 1280
    s_add_u32 s96, s42, s41
    s_mul_i32 s42, s46, 1280
    s_add_u32 s97, s42, s41
    s_cmp_ge_u32 s40, 370
    s_cselect_b32 s10, 0, s10
    s_cselect_b32 s100, 0x40000000, 0
    v_lshrrev_b32 v76, 4, v2
    v_mul_u32_u24 v76, 1280, v76
    v_and_b32 v74, 15, v2
    v_lshl_add_u32 v76, v74, 4, v76
    s_lshl_b32 s59, s14, 13
    s_add_u32 s59, s59, 122880
    v_lshrrev_b32 v74, 4, v2
    v_lshrrev_b32 v77, 1, v74
    v_and_b32 v74, 1, v74
    v_lshlrev_b32 v77, 4, v77
    v_lshl_add_u32 v77, v74, 2, v77
    v_bfe_u32 v74, v2, 2, 2
    v_add_u32 v77, v77, v74
    v_lshlrev_b32 v77, 8, v77
    v_and_b32 v74, 3, v2
    v_lshl_add_u32 v77, v74, 3, v77
    v_add_u32 v77, s59, v77
    v_lshlrev_b32 v78, 4, v2
    s_mul_i32 s44, s15, 5
    s_add_u32 s44, s44, 16
    s_cmp_eq_u32 s15, 6
    s_cselect_b32 s44, 45, s44
    s_cmp_eq_u32 s15, 7
    s_cselect_b32 s44, 49, s44
    s_lshl_b32 s40, s44, 6
    s_mul_i32 s41, s15, 160
    v_add_u32 v16, 0, v2
    v_mul_u32_u24 v17, 3277, v16
    v_lshrrev_b32 v17, 16, v17
    v_mul_u32_u24 v18, 20, v17
    v_sub_u32 v18, v16, v18
    v_mul_u32_u24 v17, 3456, v17
    v_lshl_add_u32 v17, v18, 4, v17
    v_add_u32 v3, s40, v17
    v_add_u32 v16, 64, v2
    v_mul_u32_u24 v17, 3277, v16
    v_lshrrev_b32 v17, 16, v17
    v_mul_u32_u24 v18, 20, v17
    v_sub_u32 v18, v16, v18
    v_mul_u32_u24 v17, 3456, v17
    v_lshl_add_u32 v17, v18, 4, v17
    v_add_u32 v4, s40, v17
    v_add_u32 v16, 128, v2
    v_mul_u32_u24 v17, 3277, v16
    v_lshrrev_b32 v17, 16, v17
    v_mul_u32_u24 v18, 20, v17
    v_sub_u32 v18, v16, v18
    v_mul_u32_u24 v17, 3456, v17
    v_lshl_add_u32 v17, v18, 4, v17
    v_add_u32 v5, s40, v17
    v_add_u32 v16, 192, v2
    v_mul_u32_u24 v17, 3277, v16
    v_lshrrev_b32 v17, 16, v17
    v_mul_u32_u24 v18, 20, v17
    v_sub_u32 v18, v16, v18
    v_mul_u32_u24 v17, 3456, v17
    v_lshl_add_u32 v17, v18, 4, v17
    v_add_u32 v6, s40, v17
    v_add_u32 v16, 256, v2
    v_mul_u32_u24 v17, 3277, v16
    v_lshrrev_b32 v17, 16, v17
    v_mul_u32_u24 v18, 20, v17
    v_sub_u32 v18, v16, v18
    v_mul_u32_u24 v17, 3456, v17
    v_lshl_add_u32 v17, v18, 4, v17
    v_add_u32 v7, s40, v17
    v_add_u32 v16, 0, v2
    v_mul_u32_u24 v17, 5462, v16
    v_lshrrev_b32 v17, 16, v17
    v_mul_u32_u24 v18, 12, v17
    v_sub_u32 v18, v16, v18
    v_subrev_u32 v19, 10, v18
    v_cmp_gt_u32 vcc, 10, v18
    s_nop 1
    v_cndmask_b32 v18, v19, v18, vcc
    v_mul_u32_u24 v17, 3840, v17
    v_lshl_add_u32 v17, v18, 4, v17
    v_add_u32 v8, s41, v17
    v_add_u32 v16, 64, v2
    v_mul_u32_u24 v17, 5462, v16
    v_lshrrev_b32 v17, 16, v17
    v_mul_u32_u24 v18, 12, v17
    v_sub_u32 v18, v16, v18
    v_subrev_u32 v19, 10, v18
    v_cmp_gt_u32 vcc, 10, v18
    s_nop 1
    v_cndmask_b32 v18, v19, v18, vcc
    v_mul_u32_u24 v17, 3840, v17
    v_lshl_add_u32 v17, v18, 4, v17
    v_add_u32 v9, s41, v17
    v_add_u32 v16, 128, v2
    v_mul_u32_u24 v17, 5462, v16
    v_lshrrev_b32 v17, 16, v17
    v_mul_u32_u24 v18, 12, v17
    v_sub_u32 v18, v16, v18
    v_subrev_u32 v19, 10, v18
    v_cmp_gt_u32 vcc, 10, v18
    s_nop 1
    v_cndmask_b32 v18, v19, v18, vcc
    v_mul_u32_u24 v17, 3840, v17
    v_lshl_add_u32 v17, v18, 4, v17
    v_add_u32 v10, s41, v17
    s_lshl_b32 s44, s44, 10
    s_add_u32 s48, s44, s38
    s_add_u32 s49, s48, 4096
    s_lshr_b32 s40, s15, 1
    s_mul_i32 s40, s40, 5120
    s_add_u32 s40, s40, 55296
    s_add_u32 s40, s40, s38
    s_bitcmp1_b32 s15, 0
    s_mov_b32 s50, 0
    s_cmov_b32 s50, 3072
    s_mov_b32 s51, 512
    s_cmov_b32 s51, 3584
    s_mov_b32 s52, 1024
    s_cmov_b32 s52, 4096
    s_mov_b32 s53, 1536
    s_cmov_b32 s53, 4608
    s_mov_b32 s54, 2048
    s_cmov_b32 s54, 2560
    s_add_u32 s50, s50, s40
    s_add_u32 s51, s51, s40
    s_add_u32 s52, s52, s40
    s_add_u32 s53, s53, s40
    s_add_u32 s54, s54, s40
    v_and_b32 v24, 31, v2
    v_mul_u32_u24 v24, 336, v24
    v_lshrrev_b32 v25, 5, v2
    v_lshl_add_u32 v24, v25, 4, v24
    v_add_u32 v90, 122880, v24
    v_add_u32 v24, 0, v0
    v_mul_u32_u24 v25, 625, v24
    v_lshrrev_b32 v25, 16, v25
    v_mul_u32_u24 v26, 105, v25
    v_sub_u32 v26, v24, v26
    v_mul_u32_u24 v27, 13108, v26
    v_lshrrev_b32 v27, 16, v27
    v_mul_u32_u24 v28, 5, v27
    v_sub_u32 v28, v26, v28
    v_mul_u32_u24 v29, 5, v25
    v_add_u32 v28, v28, v29
    v_lshlrev_b32 v28, 4, v28
    v_mul_u32_u24 v29, 20, v25
    v_add_u32 v29, v29, v27
    v_add_u32 v30, 80, v25
    v_cmp_eq_u32 vcc, 20, v27
    s_nop 1
    v_cndmask_b32 v29, v29, v30, vcc
    v_mul_u32_u24 v29, 336, v29
    v_add_u32 v29, v29, v28
    v_add_u32 v29, 122880, v29
    v_add_u32 v30, 1344, v29
    v_mov_b32 v31, 155136
    v_cndmask_b32 v30, v31, v30, vcc
    v_cmp_gt_u32 vcc, 420, v24
    s_nop 1
    v_cndmask_b32 v91, v31, v29, vcc
    v_cndmask_b32 v92, v31, v30, vcc
    v_add_u32 v24, 256, v0
    v_mul_u32_u24 v25, 625, v24
    v_lshrrev_b32 v25, 16, v25
    v_mul_u32_u24 v26, 105, v25
    v_sub_u32 v26, v24, v26
    v_mul_u32_u24 v27, 13108, v26
    v_lshrrev_b32 v27, 16, v27
    v_mul_u32_u24 v28, 5, v27
    v_sub_u32 v28, v26, v28
    v_mul_u32_u24 v29, 5, v25
    v_add_u32 v28, v28, v29
    v_lshlrev_b32 v28, 4, v28
    v_mul_u32_u24 v29, 20, v25
    v_add_u32 v29, v29, v27
    v_add_u32 v30, 80, v25
    v_cmp_eq_u32 vcc, 20, v27
    s_nop 1
    v_cndmask_b32 v29, v29, v30, vcc
    v_mul_u32_u24 v29, 336, v29
    v_add_u32 v29, v29, v28
    v_add_u32 v29, 122880, v29
    v_add_u32 v30, 1344, v29
    v_mov_b32 v31, 155136
    v_cndmask_b32 v30, v31, v30, vcc
    v_cmp_gt_u32 vcc, 420, v24
    s_nop 1
    v_cndmask_b32 v93, v31, v29, vcc
    v_cndmask_b32 v94, v31, v30, vcc
    v_and_b32 v40, 31, v2
    v_bfe_u32 v41, v2, 1, 3
    v_lshrrev_b32 v42, 5, v2
    v_lshlrev_b32 v40, 7, v40
    v_add_u32 v40, s39, v40
    v_add_u32 v43, 0, v42
    v_xor_b32 v43, v43, v41
    v_lshl_add_u32 v46, v43, 4, v40
    v_add_u32 v50, 20480, v46
    v_add_u32 v43, 2, v42
    v_xor_b32 v43, v43, v41
    v_lshl_add_u32 v47, v43, 4, v40
    v_add_u32 v51, 20480, v47
    v_add_u32 v43, 4, v42
    v_xor_b32 v43, v43, v41
    v_lshl_add_u32 v48, v43, 4, v40
    v_add_u32 v52, 20480, v48
    v_add_u32 v43, 6, v42
    v_xor_b32 v43, v43, v41
    v_lshl_add_u32 v49, v43, 4, v40
    v_add_u32 v53, 20480, v49
    v_add_u32 v46, 86016, v46
    v_add_u32 v47, 86016, v47
    v_add_u32 v48, 86016, v48
    v_add_u32 v49, 86016, v49
    v_mov_b32 v54, 0
    v_mov_b32 v58, 0
    v_mov_b32 v55, 0
    v_mov_b32 v59, 0
    v_mov_b32 v56, 0
    v_mov_b32 v60, 0
    v_mov_b32 v57, 0
    v_mov_b32 v61, 0
    s_add_u32 m0, s39, 53248
    s_add_u32 s41, s17, 256
    buffer_load_dwordx4 v44, s[4:7], s41 offen lds
    s_add_u32 m0, s39, 54272
    s_add_u32 s41, s17, 10496
    buffer_load_dwordx4 v45, s[4:7], s41 offen lds
    s_add_u32 m0, s39, 55296
    s_add_u32 s41, s17, 20736
    buffer_load_dwordx4 v44, s[4:7], s41 offen lds
    s_add_u32 m0, s39, 56320
    s_add_u32 s41, s17, 30976
    buffer_load_dwordx4 v45, s[4:7], s41 offen lds
    s_add_u32 m0, s39, 69632
    s_add_u32 s41, s17, 384
    buffer_load_dwordx4 v44, s[4:7], s41 offen lds
    s_add_u32 m0, s39, 70656
    s_add_u32 s41, s17, 10624
    buffer_load_dwordx4 v45, s[4:7], s41 offen lds
    s_add_u32 m0, s39, 71680
    s_add_u32 s41, s17, 20864
    buffer_load_dwordx4 v44, s[4:7], s41 offen lds
    s_add_u32 m0, s39, 72704
    s_add_u32 s41, s17, 31104
    buffer_load_dwordx4 v45, s[4:7], s41 offen lds
    s_add_u32 m0, s39, 86016
    s_add_u32 s41, s17, 512
    buffer_load_dwordx4 v44, s[4:7], s41 offen lds
    s_add_u32 m0, s39, 87040
    s_add_u32 s41, s17, 10752
    buffer_load_dwordx4 v45, s[4:7], s41 offen lds
    s_add_u32 m0, s39, 88064
    s_add_u32 s41, s17, 20992
    buffer_load_dwordx4 v44, s[4:7], s41 offen lds
    s_add_u32 m0, s39, 89088
    s_add_u32 s41, s17, 31232
    buffer_load_dwordx4 v45, s[4:7], s41 offen lds
    s_waitcnt vmcnt(21)
    ds_read_b128 v[96:99], v50 offset:0
    ds_read_b128 v[100:103], v51 offset:0
    ds_read_b128 v[104:107], v52 offset:0
    ds_read_b128 v[108:111], v53 offset:0
    s_waitcnt vmcnt(12)
    ds_read_b128 v[112:115], v50 offset:16384
    ds_read_b128 v[116:119], v51 offset:16384
    ds_read_b128 v[120:123], v52 offset:16384
    ds_read_b128 v[124:127], v53 offset:16384
    s_waitcnt lgkmcnt(4)
    s_add_u32 m0, s39, 102400
    s_add_u32 s41, s17, 640
    buffer_load_dwordx4 v44, s[4:7], s41 offen lds
    v_dot2c_f32_bf16 v54, 0x3f803f80, v96
    v_dot2c_f32_bf16 v58, v96, v96
    v_dot2c_f32_bf16 v55, 0x3f803f80, v97
    v_dot2c_f32_bf16 v59, v97, v97
    s_add_u32 m0, s39, 103424
    s_add_u32 s41, s17, 10880
    buffer_load_dwordx4 v45, s[4:7], s41 offen lds
    v_dot2c_f32_bf16 v56, 0x3f803f80, v98
    v_dot2c_f32_bf16 v60, v98, v98
    v_dot2c_f32_bf16 v57, 0x3f803f80, v99
    v_dot2c_f32_bf16 v61, v99, v99
    s_add_u32 m0, s39, 104448
    s_add_u32 s41, s17, 21120
    buffer_load_dwordx4 v44, s[4:7], s41 offen lds
    v_dot2c_f32_bf16 v54, 0x3f803f80, v100
    v_dot2c_f32_bf16 v58, v100, v100
    v_dot2c_f32_bf16 v55, 0x3f803f80, v101
    v_dot2c_f32_bf16 v59, v101, v101
    s_add_u32 m0, s39, 105472
    s_add_u32 s41, s17, 31360
    buffer_load_dwordx4 v45, s[4:7], s41 offen lds
    v_dot2c_f32_bf16 v56, 0x3f803f80, v102
    v_dot2c_f32_bf16 v60, v102, v102
    v_dot2c_f32_bf16 v57, 0x3f803f80, v103
    v_dot2c_f32_bf16 v61, v103, v103
    v_dot2c_f32_bf16 v54, 0x3f803f80, v104
    v_dot2c_f32_bf16 v58, v104, v104
    v_dot2c_f32_bf16 v55, 0x3f803f80, v105
    v_dot2c_f32_bf16 v59, v105, v105
    v_dot2c_f32_bf16 v56, 0x3f803f80, v106
    v_dot2c_f32_bf16 v60, v106, v106
    v_dot2c_f32_bf16 v57, 0x3f803f80, v107
    v_dot2c_f32_bf16 v61, v107, v107
    v_dot2c_f32_bf16 v54, 0x3f803f80, v108
    v_dot2c_f32_bf16 v58, v108, v108
    v_dot2c_f32_bf16 v55, 0x3f803f80, v109
    v_dot2c_f32_bf16 v59, v109, v109
    v_dot2c_f32_bf16 v56, 0x3f803f80, v110
    v_dot2c_f32_bf16 v60, v110, v110
    v_dot2c_f32_bf16 v57, 0x3f803f80, v111
    v_dot2c_f32_bf16 v61, v111, v111
    s_waitcnt vmcnt(12)
    ds_read_b128 v[128:131], v50 offset:32768
    ds_read_b128 v[132:135], v51 offset:32768
    ds_read_b128 v[136:139], v52 offset:32768
    ds_read_b128 v[140:143], v53 offset:32768
    s_waitcnt lgkmcnt(4)
    s_add_u32 m0, s39, 118784
    s_add_u32 s41, s17, 768
    buffer_load_dwordx4 v44, s[4:7], s41 offen lds
    v_dot2c_f32_bf16 v54, 0x3f803f80, v112
    v_dot2c_f32_bf16 v58, v112, v112
    v_dot2c_f32_bf16 v55, 0x3f803f80, v113
    v_dot2c_f32_bf16 v59, v113, v113
    s_add_u32 m0, s39, 119808
    s_add_u32 s41, s17, 11008
    buffer_load_dwordx4 v45, s[4:7], s41 offen lds
    v_dot2c_f32_bf16 v56, 0x3f803f80, v114
    v_dot2c_f32_bf16 v60, v114, v114
    v_dot2c_f32_bf16 v57, 0x3f803f80, v115
    v_dot2c_f32_bf16 v61, v115, v115
    s_add_u32 m0, s39, 120832
    s_add_u32 s41, s17, 21248
    buffer_load_dwordx4 v44, s[4:7], s41 offen lds
    v_dot2c_f32_bf16 v54, 0x3f803f80, v116
    v_dot2c_f32_bf16 v58, v116, v116
    v_dot2c_f32_bf16 v55, 0x3f803f80, v117
    v_dot2c_f32_bf16 v59, v117, v117
    s_add_u32 m0, s39, 121856
    s_add_u32 s41, s17, 31488
    buffer_load_dwordx4 v45, s[4:7], s41 offen lds
    v_dot2c_f32_bf16 v56, 0x3f803f80, v118
    v_dot2c_f32_bf16 v60, v118, v118
    v_dot2c_f32_bf16 v57, 0x3f803f80, v119
    v_dot2c_f32_bf16 v61, v119, v119
    v_dot2c_f32_bf16 v54, 0x3f803f80, v120
    v_dot2c_f32_bf16 v58, v120, v120
    v_dot2c_f32_bf16 v55, 0x3f803f80, v121
    v_dot2c_f32_bf16 v59, v121, v121
    v_dot2c_f32_bf16 v56, 0x3f803f80, v122
    v_dot2c_f32_bf16 v60, v122, v122
    v_dot2c_f32_bf16 v57, 0x3f803f80, v123
    v_dot2c_f32_bf16 v61, v123, v123
    v_dot2c_f32_bf16 v54, 0x3f803f80, v124
    v_dot2c_f32_bf16 v58, v124, v124
    v_dot2c_f32_bf16 v55, 0x3f803f80, v125
    v_dot2c_f32_bf16 v59, v125, v125
    v_dot2c_f32_bf16 v56, 0x3f803f80, v126
    v_dot2c_f32_bf16 v60, v126, v126
    v_dot2c_f32_bf16 v57, 0x3f803f80, v127
    v_dot2c_f32_bf16 v61, v127, v127
    s_waitcnt vmcnt(12)
    ds_read_b128 v[144:147], v50 offset:49152
    ds_read_b128 v[148:151], v51 offset:49152
    ds_read_b128 v[152:155], v52 offset:49152
    ds_read_b128 v[156:159], v53 offset:49152
    s_waitcnt lgkmcnt(4)
    s_add_u32 m0, s39, 135168
    s_add_u32 s41, s17, 896
    buffer_load_dwordx4 v44, s[4:7], s41 offen lds
    v_dot2c_f32_bf16 v54, 0x3f803f80, v128
    v_dot2c_f32_bf16 v58, v128, v128
    v_dot2c_f32_bf16 v55, 0x3f803f80, v129
    v_dot2c_f32_bf16 v59, v129, v129
    s_add_u32 m0, s39, 136192
    s_add_u32 s41, s17, 11136
    buffer_load_dwordx4 v45, s[4:7], s41 offen lds
    v_dot2c_f32_bf16 v56, 0x3f803f80, v130
    v_dot2c_f32_bf16 v60, v130, v130
    v_dot2c_f32_bf16 v57, 0x3f803f80, v131
    v_dot2c_f32_bf16 v61, v131, v131
    s_add_u32 m0, s39, 137216
    s_add_u32 s41, s17, 21376
    buffer_load_dwordx4 v44, s[4:7], s41 offen lds
    v_dot2c_f32_bf16 v54, 0x3f803f80, v132
    v_dot2c_f32_bf16 v58, v132, v132
    v_dot2c_f32_bf16 v55, 0x3f803f80, v133
    v_dot2c_f32_bf16 v59, v133, v133
    s_add_u32 m0, s39, 138240
    s_add_u32 s41, s17, 31616
    buffer_load_dwordx4 v45, s[4:7], s41 offen lds
    v_dot2c_f32_bf16 v56, 0x3f803f80, v134
    v_dot2c_f32_bf16 v60, v134, v134
    v_dot2c_f32_bf16 v57, 0x3f803f80, v135
    v_dot2c_f32_bf16 v61, v135, v135
    v_dot2c_f32_bf16 v54, 0x3f803f80, v136
    v_dot2c_f32_bf16 v58, v136, v136
    v_dot2c_f32_bf16 v55, 0x3f803f80, v137
    v_dot2c_f32_bf16 v59, v137, v137
    v_dot2c_f32_bf16 v56, 0x3f803f80, v138
    v_dot2c_f32_bf16 v60, v138, v138
    v_dot2c_f32_bf16 v57, 0x3f803f80, v139
    v_dot2c_f32_bf16 v61, v139, v139
    v_dot2c_f32_bf16 v54, 0x3f803f80, v140
    v_dot2c_f32_bf16 v58, v140, v140
    v_dot2c_f32_bf16 v55, 0x3f803f80, v141
    v_dot2c_f32_bf16 v59, v141, v141
    v_dot2c_f32_bf16 v56, 0x3f803f80, v142
    v_dot2c_f32_bf16 v60, v142, v142
    v_dot2c_f32_bf16 v57, 0x3f803f80, v143
    v_dot2c_f32_bf16 v61, v143, v143
    s_waitcnt vmcnt(12)
    ds_read_b128 v[160:163], v46 offset:0
    ds_read_b128 v[164:167], v47 offset:0
    ds_read_b128 v[168:171], v48 offset:0
    ds_read_b128 v[172:175], v49 offset:0
    s_waitcnt lgkmcnt(4)
    s_add_u32 m0, s39, 69632
    s_add_u32 s41, s17, 1024
    buffer_load_dwordx4 v44, s[4:7], s41 offen lds
    v_dot2c_f32_bf16 v54, 0x3f803f80, v144
    v_dot2c_f32_bf16 v58, v144, v144
    v_dot2c_f32_bf16 v55, 0x3f803f80, v145
    v_dot2c_f32_bf16 v59, v145, v145
    s_add_u32 m0, s39, 70656
    s_add_u32 s41, s17, 11264
    buffer_load_dwordx4 v45, s[4:7], s41 offen lds
    v_dot2c_f32_bf16 v56, 0x3f803f80, v146
    v_dot2c_f32_bf16 v60, v146, v146
    v_dot2c_f32_bf16 v57, 0x3f803f80, v147
    v_dot2c_f32_bf16 v61, v147, v147
    s_add_u32 m0, s39, 71680
    s_add_u32 s41, s17, 21504
    buffer_load_dwordx4 v44, s[4:7], s41 offen lds
    v_dot2c_f32_bf16 v54, 0x3f803f80, v148
    v_dot2c_f32_bf16 v58, v148, v148
    v_dot2c_f32_bf16 v55, 0x3f803f80, v149
    v_dot2c_f32_bf16 v59, v149, v149
    s_add_u32 m0, s39, 72704
    s_add_u32 s41, s17, 31744
    buffer_load_dwordx4 v45, s[4:7], s41 offen lds
    v_dot2c_f32_bf16 v56, 0x3f803f80, v150
    v_dot2c_f32_bf16 v60, v150, v150
    v_dot2c_f32_bf16 v57, 0x3f803f80, v151
    v_dot2c_f32_bf16 v61, v151, v151
    v_dot2c_f32_bf16 v54, 0x3f803f80, v152
    v_dot2c_f32_bf16 v58, v152, v152
    v_dot2c_f32_bf16 v55, 0x3f803f80, v153
    v_dot2c_f32_bf16 v59, v153, v153
    v_dot2c_f32_bf16 v56, 0x3f803f80, v154
    v_dot2c_f32_bf16 v60, v154, v154
    v_dot2c_f32_bf16 v57, 0x3f803f80, v155
    v_dot2c_f32_bf16 v61, v155, v155
    v_dot2c_f32_bf16 v54, 0x3f803f80, v156
    v_dot2c_f32_bf16 v58, v156, v156
    v_dot2c_f32_bf16 v55, 0x3f803f80, v157
    v_dot2c_f32_bf16 v59, v157, v157
    v_dot2c_f32_bf16 v56, 0x3f803f80, v158
    v_dot2c_f32_bf16 v60, v158, v158
    v_dot2c_f32_bf16 v57, 0x3f803f80, v159
    v_dot2c_f32_bf16 v61, v159, v159
    s_waitcnt vmcnt(12)
    ds_read_b128 v[176:179], v46 offset:16384
    ds_read_b128 v[180:183], v47 offset:16384
    ds_read_b128 v[184:187], v48 offset:16384
    ds_read_b128 v[188:191], v49 offset:16384
    s_waitcnt lgkmcnt(4)
    s_add_u32 m0, s39, 86016
    s_add_u32 s41, s17, 1152
    buffer_load_dwordx4 v44, s[4:7], s41 offen lds
    v_dot2c_f32_bf16 v54, 0x3f803f80, v160
    v_dot2c_f32_bf16 v58, v160, v160
    v_dot2c_f32_bf16 v55, 0x3f803f80, v161
    v_dot2c_f32_bf16 v59, v161, v161
    s_add_u32 m0, s39, 87040
    s_add_u32 s41, s17, 11392
    buffer_load_dwordx4 v45, s[4:7], s41 offen lds
    v_dot2c_f32_bf16 v56, 0x3f803f80, v162
    v_dot2c_f32_bf16 v60, v162, v162
    v_dot2c_f32_bf16 v57, 0x3f803f80, v163
    v_dot2c_f32_bf16 v61, v163, v163
    s_add_u32 m0, s39, 88064
    s_add_u32 s41, s17, 21632
    buffer_load_dwordx4 v44, s[4:7], s41 offen lds
    v_dot2c_f32_bf16 v54, 0x3f803f80, v164
    v_dot2c_f32_bf16 v58, v164, v164
    v_dot2c_f32_bf16 v55, 0x3f803f80, v165
    v_dot2c_f32_bf16 v59, v165, v165
    s_add_u32 m0, s39, 89088
    s_add_u32 s41, s17, 31872
    buffer_load_dwordx4 v45, s[4:7], s41 offen lds
    v_dot2c_f32_bf16 v56, 0x3f803f80, v166
    v_dot2c_f32_bf16 v60, v166, v166
    v_dot2c_f32_bf16 v57, 0x3f803f80, v167
    v_dot2c_f32_bf16 v61, v167, v167
    v_lshlrev_b32 v62, 4, v0
    s_mul_i32 s42, s2, 9600
    s_mul_i32 s43, s2, 8640
    buffer_load_dwordx4 v[64:67], v62, s[28:31], s42 offen
    v_dot2c_f32_bf16 v54, 0x3f803f80, v168
    v_dot2c_f32_bf16 v58, v168, v168
    v_dot2c_f32_bf16 v55, 0x3f803f80, v169
    v_dot2c_f32_bf16 v59, v169, v169
    s_add_u32 s42, s42, 3200
    buffer_load_dwordx4 v[68:71], v62, s[24:27], s43 offen
    v_dot2c_f32_bf16 v56, 0x3f803f80, v170
    v_dot2c_f32_bf16 v60, v170, v170
    v_dot2c_f32_bf16 v57, 0x3f803f80, v171
    v_dot2c_f32_bf16 v61, v171, v171
    v_dot2c_f32_bf16 v54, 0x3f803f80, v172
    v_dot2c_f32_bf16 v58, v172, v172
    v_dot2c_f32_bf16 v55, 0x3f803f80, v173
    v_dot2c_f32_bf16 v59, v173, v173
    v_dot2c_f32_bf16 v56, 0x3f803f80, v174
    v_dot2c_f32_bf16 v60, v174, v174
    v_dot2c_f32_bf16 v57, 0x3f803f80, v175
    v_dot2c_f32_bf16 v61, v175, v175
    s_waitcnt vmcnt(14)
    ds_read_b128 v[192:195], v46 offset:32768
    ds_read_b128 v[196:199], v47 offset:32768
    ds_read_b128 v[200:203], v48 offset:32768
    ds_read_b128 v[204:207], v49 offset:32768
    s_waitcnt lgkmcnt(4)
    s_barrier
    s_add_u32 s43, s43, 2880
    buffer_load_dwordx4 v[64:67], v62, s[28:31], s42 offen
    v_dot2c_f32_bf16 v54, 0x3f803f80, v176
    v_dot2c_f32_bf16 v58, v176, v176
    v_dot2c_f32_bf16 v55, 0x3f803f80, v177
    v_dot2c_f32_bf16 v59, v177, v177
    s_add_u32 s42, s42, 3200
    buffer_load_dwordx4 v[68:71], v62, s[24:27], s43 offen
    v_dot2c_f32_bf16 v56, 0x3f803f80, v178
    v_dot2c_f32_bf16 v60, v178, v178
    v_dot2c_f32_bf16 v57, 0x3f803f80, v179
    v_dot2c_f32_bf16 v61, v179, v179
    s_add_u32 s55, s36, 0
    s_add_u32 m0, s18, 0
    s_nop 0
    buffer_load_dwordx4 v3, s[24:27], s55 offen lds
    v_dot2c_f32_bf16 v54, 0x3f803f80, v180
    v_dot2c_f32_bf16 v58, v180, v180
    v_dot2c_f32_bf16 v55, 0x3f803f80, v181
    v_dot2c_f32_bf16 v59, v181, v181
    s_add_u32 m0, s18, 1024
    s_nop 0
    buffer_load_dwordx4 v4, s[24:27], s55 offen lds
    v_dot2c_f32_bf16 v56, 0x3f803f80, v182
    v_dot2c_f32_bf16 v60, v182, v182
    v_dot2c_f32_bf16 v57, 0x3f803f80, v183
    v_dot2c_f32_bf16 v61, v183, v183
    s_add_u32 m0, s18, 2048
    s_nop 0
    buffer_load_dwordx4 v5, s[24:27], s55 offen lds
    v_dot2c_f32_bf16 v54, 0x3f803f80, v184
    v_dot2c_f32_bf16 v58, v184, v184
    v_dot2c_f32_bf16 v55, 0x3f803f80, v185
    v_dot2c_f32_bf16 v59, v185, v185
    s_add_u32 m0, s18, 3072
    s_nop 0
    buffer_load_dwordx4 v6, s[24:27], s55 offen lds
    v_dot2c_f32_bf16 v56, 0x3f803f80, v186
    v_dot2c_f32_bf16 v60, v186, v186
    v_dot2c_f32_bf16 v57, 0x3f803f80, v187
    v_dot2c_f32_bf16 v61, v187, v187
    s_add_u32 m0, s18, 4096
    s_nop 0
    buffer_load_dwordx4 v7, s[24:27], s55 offen lds
    v_dot2c_f32_bf16 v54, 0x3f803f80, v188
    v_dot2c_f32_bf16 v58, v188, v188
    v_dot2c_f32_bf16 v55, 0x3f803f80, v189
    v_dot2c_f32_bf16 v59, v189, v189
    v_dot2c_f32_bf16 v56, 0x3f803f80, v190
    v_dot2c_f32_bf16 v60, v190, v190
    v_dot2c_f32_bf16 v57, 0x3f803f80, v191
    v_dot2c_f32_bf16 v61, v191, v191
    s_waitcnt vmcnt(17)
    ds_read_b128 v[208:211], v46 offset:49152
    ds_read_b128 v[212:215], v47 offset:49152
    ds_read_b128 v[216:219], v48 offset:49152
    ds_read_b128 v[220:223], v49 offset:49152
    s_waitcnt lgkmcnt(4)
    s_add_u32 s43, s43, 2880
    buffer_load_dwordx4 v[64:67], v62, s[28:31], s42 offen
    v_dot2c_f32_bf16 v54, 0x3f803f80, v192
    v_dot2c_f32_bf16 v58, v192, v192
    v_dot2c_f32_bf16 v55, 0x3f803f80, v193
    v_dot2c_f32_bf16 v59, v193, v193
    s_add_u32 s42, s42, 3200
    buffer_load_dwordx4 v[68:71], v62, s[24:27], s43 offen
    v_dot2c_f32_bf16 v56, 0x3f803f80, v194
    v_dot2c_f32_bf16 v60, v194, v194
    v_dot2c_f32_bf16 v57, 0x3f803f80, v195
    v_dot2c_f32_bf16 v61, v195, v195
    v_dot2c_f32_bf16 v54, 0x3f803f80, v196
    v_dot2c_f32_bf16 v58, v196, v196
    v_dot2c_f32_bf16 v55, 0x3f803f80, v197
    v_dot2c_f32_bf16 v59, v197, v197
    v_dot2c_f32_bf16 v56, 0x3f803f80, v198
    v_dot2c_f32_bf16 v60, v198, v198
    v_dot2c_f32_bf16 v57, 0x3f803f80, v199
    v_dot2c_f32_bf16 v61, v199, v199
    v_dot2c_f32_bf16 v54, 0x3f803f80, v200
    v_dot2c_f32_bf16 v58, v200, v200
    v_dot2c_f32_bf16 v55, 0x3f803f80, v201
    v_dot2c_f32_bf16 v59, v201, v201
    v_dot2c_f32_bf16 v56, 0x3f803f80, v202
    v_dot2c_f32_bf16 v60, v202, v202
    v_dot2c_f32_bf16 v57, 0x3f803f80, v203
    v_dot2c_f32_bf16 v61, v203, v203
    v_dot2c_f32_bf16 v54, 0x3f803f80, v204
    v_dot2c_f32_bf16 v58, v204, v204
    v_dot2c_f32_bf16 v55, 0x3f803f80, v205
    v_dot2c_f32_bf16 v59, v205, v205
    v_dot2c_f32_bf16 v56, 0x3f803f80, v206
    v_dot2c_f32_bf16 v60, v206, v206
    v_dot2c_f32_bf16 v57, 0x3f803f80, v207
    v_dot2c_f32_bf16 v61, v207, v207
    s_waitcnt vmcnt(15)
    ds_read_b128 v[224:227], v50 offset:49152
    ds_read_b128 v[228:231], v51 offset:49152
    ds_read_b128 v[232:235], v52 offset:49152
    ds_read_b128 v[236:239], v53 offset:49152
    s_waitcnt lgkmcnt(4)
    v_dot2c_f32_bf16 v54, 0x3f803f80, v208
    v_dot2c_f32_bf16 v58, v208, v208
    v_dot2c_f32_bf16 v55, 0x3f803f80, v209
    v_dot2c_f32_bf16 v59, v209, v209
    v_dot2c_f32_bf16 v56, 0x3f803f80, v210
    v_dot2c_f32_bf16 v60, v210, v210
    v_dot2c_f32_bf16 v57, 0x3f803f80, v211
    v_dot2c_f32_bf16 v61, v211, v211
    v_dot2c_f32_bf16 v54, 0x3f803f80, v212
    v_dot2c_f32_bf16 v58, v212, v212
    v_dot2c_f32_bf16 v55, 0x3f803f80, v213
    v_dot2c_f32_bf16 v59, v213, v213
    v_dot2c_f32_bf16 v56, 0x3f803f80, v214
    v_dot2c_f32_bf16 v60, v214, v214
    v_dot2c_f32_bf16 v57, 0x3f803f80, v215
    v_dot2c_f32_bf16 v61, v215, v215
    v_dot2c_f32_bf16 v54, 0x3f803f80, v216
    v_dot2c_f32_bf16 v58, v216, v216
    v_dot2c_f32_bf16 v55, 0x3f803f80, v217
    v_dot2c_f32_bf16 v59, v217, v217
    v_dot2c_f32_bf16 v56, 0x3f803f80, v218
    v_dot2c_f32_bf16 v60, v218, v218
    v_dot2c_f32_bf16 v57, 0x3f803f80, v219
    v_dot2c_f32_bf16 v61, v219, v219
    v_dot2c_f32_bf16 v54, 0x3f803f80, v220
    v_dot2c_f32_bf16 v58, v220, v220
    v_dot2c_f32_bf16 v55, 0x3f803f80, v221
    v_dot2c_f32_bf16 v59, v221, v221
    v_dot2c_f32_bf16 v56, 0x3f803f80, v222
    v_dot2c_f32_bf16 v60, v222, v222
    v_dot2c_f32_bf16 v57, 0x3f803f80, v223
    v_dot2c_f32_bf16 v61, v223, v223
    s_waitcnt vmcnt(11)
    ds_read_b128 v[240:243], v46 offset:0
    ds_read_b128 v[244:247], v47 offset:0
    ds_read_b128 v[248:251], v48 offset:0
    ds_read_b128 v[252:255], v49 offset:0
    s_waitcnt lgkmcnt(4)
    v_dot2c_f32_bf16 v54, 0x3f803f80, v224
    v_dot2c_f32_bf16 v58, v224, v224
    v_dot2c_f32_bf16 v55, 0x3f803f80, v225
    v_dot2c_f32_bf16 v59, v225, v225
    v_dot2c_f32_bf16 v56, 0x3f803f80, v226
    v_dot2c_f32_bf16 v60, v226, v226
    v_dot2c_f32_bf16 v57, 0x3f803f80, v227
    v_dot2c_f32_bf16 v61, v227, v227
    v_dot2c_f32_bf16 v54, 0x3f803f80, v228
    v_dot2c_f32_bf16 v58, v228, v228
    v_dot2c_f32_bf16 v55, 0x3f803f80, v229
    v_dot2c_f32_bf16 v59, v229, v229
    v_dot2c_f32_bf16 v56, 0x3f803f80, v230
    v_dot2c_f32_bf16 v60, v230, v230
    v_dot2c_f32_bf16 v57, 0x3f803f80, v231
    v_dot2c_f32_bf16 v61, v231, v231
    v_dot2c_f32_bf16 v54, 0x3f803f80, v232
    v_dot2c_f32_bf16 v58, v232, v232
    v_dot2c_f32_bf16 v55, 0x3f803f80, v233
    v_dot2c_f32_bf16 v59, v233, v233
    v_dot2c_f32_bf16 v56, 0x3f803f80, v234
    v_dot2c_f32_bf16 v60, v234, v234
    v_dot2c_f32_bf16 v57, 0x3f803f80, v235
    v_dot2c_f32_bf16 v61, v235, v235
    v_dot2c_f32_bf16 v54, 0x3f803f80, v236
    v_dot2c_f32_bf16 v58, v236, v236
    v_dot2c_f32_bf16 v55, 0x3f803f80, v237
    v_dot2c_f32_bf16 v59, v237, v237
    v_dot2c_f32_bf16 v56, 0x3f803f80, v238
    v_dot2c_f32_bf16 v60, v238, v238
    v_dot2c_f32_bf16 v57, 0x3f803f80, v239
    v_dot2c_f32_bf16 v61, v239, v239
    s_waitcnt lgkmcnt(0)
    s_add_u32 s55, s36, 221184
    s_add_u32 m0, s18, 20480
    s_nop 0
    buffer_load_dwordx4 v3, s[24:27], s55 offen lds
    v_dot2c_f32_bf16 v54, 0x3f803f80, v240
    v_dot2c_f32_bf16 v58, v240, v240
    v_dot2c_f32_bf16 v55, 0x3f803f80, v241
    v_dot2c_f32_bf16 v59, v241, v241
    s_add_u32 m0, s18, 21504
    s_nop 0
    buffer_load_dwordx4 v4, s[24:27], s55 offen lds
    v_dot2c_f32_bf16 v56, 0x3f803f80, v242
    v_dot2c_f32_bf16 v60, v242, v242
    v_dot2c_f32_bf16 v57, 0x3f803f80, v243
    v_dot2c_f32_bf16 v61, v243, v243
    s_add_u32 m0, s18, 22528
    s_nop 0
    buffer_load_dwordx4 v5, s[24:27], s55 offen lds
    v_dot2c_f32_bf16 v54, 0x3f803f80, v244
    v_dot2c_f32_bf16 v58, v244, v244
    v_dot2c_f32_bf16 v55, 0x3f803f80, v245
    v_dot2c_f32_bf16 v59, v245, v245
    s_add_u32 m0, s18, 23552
    s_nop 0
    buffer_load_dwordx4 v6, s[24:27], s55 offen lds
    v_dot2c_f32_bf16 v56, 0x3f803f80, v246
    v_dot2c_f32_bf16 v60, v246, v246
    v_dot2c_f32_bf16 v57, 0x3f803f80, v247
    v_dot2c_f32_bf16 v61, v247, v247
    s_add_u32 m0, s18, 24576
    s_nop 0
    buffer_load_dwordx4 v7, s[24:27], s55 offen lds
    v_dot2c_f32_bf16 v54, 0x3f803f80, v248
    v_dot2c_f32_bf16 v58, v248, v248
    v_dot2c_f32_bf16 v55, 0x3f803f80, v249
    v_dot2c_f32_bf16 v59, v249, v249
    v_dot2c_f32_bf16 v56, 0x3f803f80, v250
    v_dot2c_f32_bf16 v60, v250, v250
    v_dot2c_f32_bf16 v57, 0x3f803f80, v251
    v_dot2c_f32_bf16 v61, v251, v251
    v_dot2c_f32_bf16 v54, 0x3f803f80, v252
    v_dot2c_f32_bf16 v58, v252, v252
    v_dot2c_f32_bf16 v55, 0x3f803f80, v253
    v_dot2c_f32_bf16 v59, v253, v253
    v_dot2c_f32_bf16 v56, 0x3f803f80, v254
    v_dot2c_f32_bf16 v60, v254, v254
    v_dot2c_f32_bf16 v57, 0x3f803f80, v255
    v_dot2c_f32_bf16 v61, v255, v255
    v_add_f32 v54, v54, v55
    s_nop 0
    v_add_f32 v56, v56, v57
    v_add_f32 v58, v58, v59
    v_add_f32 v60, v60, v61
    v_add_f32 v54, v54, v56
    v_add_f32 v58, v58, v60
    v_mov_b32 v55, v54
    v_mov_b32 v59, v58
    s_nop 0
    v_permlane32_swap_b32 v54, v55
    v_permlane32_swap_b32 v58, v59
    v_add_f32 v54, v54, v55
    v_add_f32 v58, v58, v59
    v_mul_f32 v54, 0x3acccccd, v54
    v_mul_f32 v58, 0x3acccccd, v58
    v_fma_f32 v58, -v54, v54, v58
    v_max_f32 v58, 0, v58
    v_cvt_pk_bf16_f32 v54, v54, v58
    v_and_b32 v58, 0xffff0000, v54
    v_lshlrev_b32 v54, 16, v54
    v_add_f32 v58, 0x3727c5ac, v58
    v_cvt_pk_bf16_f32 v58, v58, v58
    v_lshlrev_b32 v58, 16, v58
    v_sqrt_f32 v58, v58
    s_nop 0
    v_cvt_pk_bf16_f32 v58, v58, v58
    v_lshlrev_b32 v58, 16, v58
    v_rcp_f32 v12, v58
    s_nop 0
    v_mul_f32 v13, v54, v12
    v_sub_f32 v13, 0, v13
    v_lshlrev_b32 v40, 16, v96
    v_and_b32 v41, 0xffff0000, v96
    v_lshlrev_b32 v42, 16, v97
    v_and_b32 v43, 0xffff0000, v97
    v_fma_f32 v40, v40, v12, v13
    v_fma_f32 v41, v41, v12, v13
    v_fma_f32 v42, v42, v12, v13
    v_fma_f32 v43, v43, v12, v13
    v_cvt_pk_bf16_f32 v96, v40, v41
    v_cvt_pk_bf16_f32 v97, v42, v43
    v_lshlrev_b32 v40, 16, v98
    v_and_b32 v41, 0xffff0000, v98
    v_lshlrev_b32 v42, 16, v99
    v_and_b32 v43, 0xffff0000, v99
    v_fma_f32 v40, v40, v12, v13
    v_fma_f32 v41, v41, v12, v13
    v_fma_f32 v42, v42, v12, v13
    v_fma_f32 v43, v43, v12, v13
    v_cvt_pk_bf16_f32 v98, v40, v41
    v_cvt_pk_bf16_f32 v99, v42, v43
    v_lshlrev_b32 v40, 16, v100
    v_and_b32 v41, 0xffff0000, v100
    v_lshlrev_b32 v42, 16, v101
    v_and_b32 v43, 0xffff0000, v101
    v_fma_f32 v40, v40, v12, v13
    v_fma_f32 v41, v41, v12, v13
    v_fma_f32 v42, v42, v12, v13
    v_fma_f32 v43, v43, v12, v13
    v_cvt_pk_bf16_f32 v100, v40, v41
    v_cvt_pk_bf16_f32 v101, v42, v43
    v_lshlrev_b32 v40, 16, v102
    v_and_b32 v41, 0xffff0000, v102
    v_lshlrev_b32 v42, 16, v103
    v_and_b32 v43, 0xffff0000, v103
    v_fma_f32 v40, v40, v12, v13
    v_fma_f32 v41, v41, v12, v13
    v_fma_f32 v42, v42, v12, v13
    v_fma_f32 v43, v43, v12, v13
    v_cvt_pk_bf16_f32 v102, v40, v41
    v_cvt_pk_bf16_f32 v103, v42, v43
    s_waitcnt vmcnt(7)
    s_barrier
    ds_read_b64_tr_b16 v[16:17], v14 offset:0
    ds_read_b64_tr_b16 v[18:19], v14 offset:1280
    ds_read_b64_tr_b16 v[20:21], v14 offset:64
    ds_read_b64_tr_b16 v[22:23], v14 offset:1344
    ds_read_b64_tr_b16 v[24:25], v14 offset:128
    ds_read_b64_tr_b16 v[26:27], v14 offset:1408
    ds_read_b64_tr_b16 v[28:29], v14 offset:192
    ds_read_b64_tr_b16 v[30:31], v14 offset:1472
    s_add_u32 s55, s36, 442368
    s_add_u32 m0, s18, 40960
    s_waitcnt lgkmcnt(6)
    v_mfma_f32_32x32x16_bf16 a[0:15], v[16:19], v[96:99], 0
    buffer_load_dwordx4 v3, s[24:27], s55 offen lds
    ds_read_b64_tr_b16 v[32:33], v14 offset:256
    ds_read_b64_tr_b16 v[34:35], v14 offset:1536
    v_lshlrev_b32 v40, 16, v104
    v_and_b32 v41, 0xffff0000, v104
    v_lshlrev_b32 v42, 16, v105
    v_and_b32 v43, 0xffff0000, v105
    s_waitcnt lgkmcnt(6)
    v_mfma_f32_32x32x16_bf16 a[16:31], v[20:23], v[96:99], 0
    ds_read_b64_tr_b16 v[36:37], v14 offset:5120
    ds_read_b64_tr_b16 v[38:39], v14 offset:6400
    v_fma_f32 v40, v40, v12, v13
    v_fma_f32 v41, v41, v12, v13
    v_fma_f32 v42, v42, v12, v13
    v_fma_f32 v43, v43, v12, v13
    s_add_u32 m0, s18, 41984
    s_waitcnt lgkmcnt(6)
    v_mfma_f32_32x32x16_bf16 a[32:47], v[24:27], v[96:99], 0
    buffer_load_dwordx4 v4, s[24:27], s55 offen lds
    ds_read_b64_tr_b16 v[16:17], v14 offset:5184
    ds_read_b64_tr_b16 v[18:19], v14 offset:6464
    v_cvt_pk_bf16_f32 v104, v40, v41
    v_cvt_pk_bf16_f32 v105, v42, v43
    v_lshlrev_b32 v40, 16, v106
    v_and_b32 v41, 0xffff0000, v106
    s_waitcnt lgkmcnt(6)
    v_mfma_f32_32x32x16_bf16 a[48:63], v[28:31], v[96:99], 0
    ds_read_b64_tr_b16 v[20:21], v14 offset:5248
    ds_read_b64_tr_b16 v[22:23], v14 offset:6528
    v_lshlrev_b32 v42, 16, v107
    v_and_b32 v43, 0xffff0000, v107
    v_fma_f32 v40, v40, v12, v13
    v_fma_f32 v41, v41, v12, v13
    s_add_u32 m0, s18, 43008
    s_waitcnt lgkmcnt(6)
    v_mfma_f32_32x32x16_bf16 a[64:79], v[32:35], v[96:99], 0
    buffer_load_dwordx4 v5, s[24:27], s55 offen lds
    ds_read_b64_tr_b16 v[24:25], v14 offset:5312
    ds_read_b64_tr_b16 v[26:27], v14 offset:6592
    v_fma_f32 v42, v42, v12, v13
    v_fma_f32 v43, v43, v12, v13
    v_cvt_pk_bf16_f32 v106, v40, v41
    v_cvt_pk_bf16_f32 v107, v42, v43
    s_waitcnt lgkmcnt(6)
    v_mfma_f32_32x32x16_bf16 a[0:15], v[36:39], v[100:103], a[0:15]
    ds_read_b64_tr_b16 v[28:29], v14 offset:5376
    ds_read_b64_tr_b16 v[30:31], v14 offset:6656
    v_lshlrev_b32 v40, 16, v108
    v_and_b32 v41, 0xffff0000, v108
    v_lshlrev_b32 v42, 16, v109
    v_and_b32 v43, 0xffff0000, v109
    s_add_u32 m0, s18, 44032
    s_waitcnt lgkmcnt(6)
    v_mfma_f32_32x32x16_bf16 a[16:31], v[16:19], v[100:103], a[16:31]
    buffer_load_dwordx4 v6, s[24:27], s55 offen lds
    ds_read_b64_tr_b16 v[32:33], v14 offset:10240
    ds_read_b64_tr_b16 v[34:35], v14 offset:11520
    v_fma_f32 v40, v40, v12, v13
    v_fma_f32 v41, v41, v12, v13
    v_fma_f32 v42, v42, v12, v13
    v_fma_f32 v43, v43, v12, v13
    s_waitcnt lgkmcnt(6)
    v_mfma_f32_32x32x16_bf16 a[32:47], v[20:23], v[100:103], a[32:47]
    ds_read_b64_tr_b16 v[36:37], v14 offset:10304
    ds_read_b64_tr_b16 v[38:39], v14 offset:11584
    v_cvt_pk_bf16_f32 v108, v40, v41
    v_cvt_pk_bf16_f32 v109, v42, v43
    v_lshlrev_b32 v40, 16, v110
    v_and_b32 v41, 0xffff0000, v110
    s_add_u32 m0, s18, 45056
    s_waitcnt lgkmcnt(6)
    v_mfma_f32_32x32x16_bf16 a[48:63], v[24:27], v[100:103], a[48:63]
    buffer_load_dwordx4 v7, s[24:27], s55 offen lds
    ds_read_b64_tr_b16 v[16:17], v14 offset:10368
    ds_read_b64_tr_b16 v[18:19], v14 offset:11648
    v_lshlrev_b32 v42, 16, v111
    v_and_b32 v43, 0xffff0000, v111
    v_fma_f32 v40, v40, v12, v13
    v_fma_f32 v41, v41, v12, v13
    s_waitcnt lgkmcnt(6)
    v_mfma_f32_32x32x16_bf16 a[64:79], v[28:31], v[100:103], a[64:79]
    ds_read_b64_tr_b16 v[20:21], v14 offset:10432
    ds_read_b64_tr_b16 v[22:23], v14 offset:11712
    v_fma_f32 v42, v42, v12, v13
    v_fma_f32 v43, v43, v12, v13
    v_cvt_pk_bf16_f32 v110, v40, v41
    v_cvt_pk_bf16_f32 v111, v42, v43
    s_add_u32 s55, s36, 663552
    s_add_u32 m0, s18, 61440
    s_waitcnt lgkmcnt(6)
    v_mfma_f32_32x32x16_bf16 a[0:15], v[32:35], v[104:107], a[0:15]
    buffer_load_dwordx4 v3, s[24:27], s55 offen lds
    ds_read_b64_tr_b16 v[24:25], v14 offset:10496
    ds_read_b64_tr_b16 v[26:27], v14 offset:11776
    v_lshlrev_b32 v40, 16, v112
    v_and_b32 v41, 0xffff0000, v112
    v_lshlrev_b32 v42, 16, v113
    v_and_b32 v43, 0xffff0000, v113
    s_waitcnt lgkmcnt(6)
    v_mfma_f32_32x32x16_bf16 a[16:31], v[36:39], v[104:107], a[16:31]
    ds_read_b64_tr_b16 v[28:29], v14 offset:15360
    ds_read_b64_tr_b16 v[30:31], v14 offset:16640
    v_fma_f32 v40, v40, v12, v13
    v_fma_f32 v41, v41, v12, v13
    v_fma_f32 v42, v42, v12, v13
    v_fma_f32 v43, v43, v12, v13
    s_add_u32 m0, s18, 62464
    s_waitcnt lgkmcnt(6)
    v_mfma_f32_32x32x16_bf16 a[32:47], v[16:19], v[104:107], a[32:47]
    buffer_load_dwordx4 v4, s[24:27], s55 offen lds
    ds_read_b64_tr_b16 v[32:33], v14 offset:15424
    ds_read_b64_tr_b16 v[34:35], v14 offset:16704
    v_cvt_pk_bf16_f32 v112, v40, v41
    v_cvt_pk_bf16_f32 v113, v42, v43
    v_lshlrev_b32 v40, 16, v114
    v_and_b32 v41, 0xffff0000, v114
    s_waitcnt lgkmcnt(6)
    v_mfma_f32_32x32x16_bf16 a[48:63], v[20:23], v[104:107], a[48:63]
    ds_read_b64_tr_b16 v[36:37], v14 offset:15488
    ds_read_b64_tr_b16 v[38:39], v14 offset:16768
    v_lshlrev_b32 v42, 16, v115
    v_and_b32 v43, 0xffff0000, v115
    v_fma_f32 v40, v40, v12, v13
    v_fma_f32 v41, v41, v12, v13
    s_add_u32 m0, s18, 63488
    s_waitcnt lgkmcnt(6)
    v_mfma_f32_32x32x16_bf16 a[64:79], v[24:27], v[104:107], a[64:79]
    buffer_load_dwordx4 v5, s[24:27], s55 offen lds
    ds_read_b64_tr_b16 v[16:17], v14 offset:15552
    ds_read_b64_tr_b16 v[18:19], v14 offset:16832
    v_fma_f32 v42, v42, v12, v13
    v_fma_f32 v43, v43, v12, v13
    v_cvt_pk_bf16_f32 v114, v40, v41
    v_cvt_pk_bf16_f32 v115, v42, v43
    s_waitcnt lgkmcnt(6)
    v_mfma_f32_32x32x16_bf16 a[0:15], v[28:31], v[108:111], a[0:15]
    ds_read_b64_tr_b16 v[20:21], v14 offset:15616
    ds_read_b64_tr_b16 v[22:23], v14 offset:16896
    v_lshlrev_b32 v40, 16, v116
    v_and_b32 v41, 0xffff0000, v116
    v_lshlrev_b32 v42, 16, v117
    v_and_b32 v43, 0xffff0000, v117
    s_add_u32 m0, s18, 64512
    s_waitcnt lgkmcnt(6)
    v_mfma_f32_32x32x16_bf16 a[16:31], v[32:35], v[108:111], a[16:31]
    buffer_load_dwordx4 v6, s[24:27], s55 offen lds
    s_waitcnt vmcnt(9)
    s_barrier
    ds_read_b64_tr_b16 v[24:25], v14 offset:20480
    ds_read_b64_tr_b16 v[26:27], v14 offset:21760
    v_fma_f32 v40, v40, v12, v13
    v_fma_f32 v41, v41, v12, v13
    v_fma_f32 v42, v42, v12, v13
    v_fma_f32 v43, v43, v12, v13
    s_waitcnt lgkmcnt(6)
    v_mfma_f32_32x32x16_bf16 a[32:47], v[36:39], v[108:111], a[32:47]
    ds_read_b64_tr_b16 v[28:29], v14 offset:20544
    ds_read_b64_tr_b16 v[30:31], v14 offset:21824
    v_cvt_pk_bf16_f32 v116, v40, v41
    v_cvt_pk_bf16_f32 v117, v42, v43
    v_lshlrev_b32 v40, 16, v118
    v_and_b32 v41, 0xffff0000, v118
    s_add_u32 m0, s18, 65536
    s_waitcnt lgkmcnt(6)
    v_mfma_f32_32x32x16_bf16 a[48:63], v[16:19], v[108:111], a[48:63]
    buffer_load_dwordx4 v7, s[24:27], s55 offen lds
    ds_read_b64_tr_b16 v[32:33], v14 offset:20608
    ds_read_b64_tr_b16 v[34:35], v14 offset:21888
    v_lshlrev_b32 v42, 16, v119
    v_and_b32 v43, 0xffff0000, v119
    v_fma_f32 v40, v40, v12, v13
    v_fma_f32 v41, v41, v12, v13
    s_waitcnt lgkmcnt(6)
    v_mfma_f32_32x32x16_bf16 a[64:79], v[20:23], v[108:111], a[64:79]
    ds_read_b64_tr_b16 v[36:37], v14 offset:20672
    ds_read_b64_tr_b16 v[38:39], v14 offset:21952
    v_fma_f32 v42, v42, v12, v13
    v_fma_f32 v43, v43, v12, v13
    v_cvt_pk_bf16_f32 v118, v40, v41
    v_cvt_pk_bf16_f32 v119, v42, v43
    s_add_u32 s55, s36, 884736
    s_add_u32 m0, s18, 81920
    s_waitcnt lgkmcnt(6)
    v_mfma_f32_32x32x16_bf16 a[0:15], v[24:27], v[112:115], a[0:15]
    buffer_load_dwordx4 v3, s[24:27], s55 offen lds
    ds_read_b64_tr_b16 v[16:17], v14 offset:20736
    ds_read_b64_tr_b16 v[18:19], v14 offset:22016
    v_lshlrev_b32 v40, 16, v120
    v_and_b32 v41, 0xffff0000, v120
    v_lshlrev_b32 v42, 16, v121
    v_and_b32 v43, 0xffff0000, v121
    s_waitcnt lgkmcnt(6)
    v_mfma_f32_32x32x16_bf16 a[16:31], v[28:31], v[112:115], a[16:31]
    ds_read_b64_tr_b16 v[20:21], v14 offset:25600
    ds_read_b64_tr_b16 v[22:23], v14 offset:26880
    v_fma_f32 v40, v40, v12, v13
    v_fma_f32 v41, v41, v12, v13
    v_fma_f32 v42, v42, v12, v13
    v_fma_f32 v43, v43, v12, v13
    s_add_u32 m0, s18, 82944
    s_waitcnt lgkmcnt(6)
    v_mfma_f32_32x32x16_bf16 a[32:47], v[32:35], v[112:115], a[32:47]
    buffer_load_dwordx4 v4, s[24:27], s55 offen lds
    ds_read_b64_tr_b16 v[24:25], v14 offset:25664
    ds_read_b64_tr_b16 v[26:27], v14 offset:26944
    v_cvt_pk_bf16_f32 v120, v40, v41
    v_cvt_pk_bf16_f32 v121, v42, v43
    v_lshlrev_b32 v40, 16, v122
    v_and_b32 v41, 0xffff0000, v122
    s_waitcnt lgkmcnt(6)
    v_mfma_f32_32x32x16_bf16 a[48:63], v[36:39], v[112:115], a[48:63]
    ds_read_b64_tr_b16 v[28:29], v14 offset:25728
    ds_read_b64_tr_b16 v[30:31], v14 offset:27008
    v_lshlrev_b32 v42, 16, v123
    v_and_b32 v43, 0xffff0000, v123
    v_fma_f32 v40, v40, v12, v13
    v_fma_f32 v41, v41, v12, v13
    s_add_u32 m0, s18, 83968
    s_waitcnt lgkmcnt(6)
    v_mfma_f32_32x32x16_bf16 a[64:79], v[16:19], v[112:115], a[64:79]
    buffer_load_dwordx4 v5, s[24:27], s55 offen lds
    ds_read_b64_tr_b16 v[32:33], v14 offset:25792
    ds_read_b64_tr_b16 v[34:35], v14 offset:27072
    v_fma_f32 v42, v42, v12, v13
    v_fma_f32 v43, v43, v12, v13
    v_cvt_pk_bf16_f32 v122, v40, v41
    v_cvt_pk_bf16_f32 v123, v42, v43
    s_waitcnt lgkmcnt(6)
    v_mfma_f32_32x32x16_bf16 a[0:15], v[20:23], v[116:119], a[0:15]
    ds_read_b64_tr_b16 v[36:37], v14 offset:25856
    ds_read_b64_tr_b16 v[38:39], v14 offset:27136
    v_lshlrev_b32 v40, 16, v124
    v_and_b32 v41, 0xffff0000, v124
    v_lshlrev_b32 v42, 16, v125
    v_and_b32 v43, 0xffff0000, v125
    s_add_u32 m0, s18, 84992
    s_waitcnt lgkmcnt(6)
    v_mfma_f32_32x32x16_bf16 a[16:31], v[24:27], v[116:119], a[16:31]
    buffer_load_dwordx4 v6, s[24:27], s55 offen lds
    ds_read_b64_tr_b16 v[16:17], v14 offset:30720
    ds_read_b64_tr_b16 v[18:19], v14 offset:32000
    v_fma_f32 v40, v40, v12, v13
    v_fma_f32 v41, v41, v12, v13
    v_fma_f32 v42, v42, v12, v13
    v_fma_f32 v43, v43, v12, v13
    s_waitcnt lgkmcnt(6)
    v_mfma_f32_32x32x16_bf16 a[32:47], v[28:31], v[116:119], a[32:47]
    ds_read_b64_tr_b16 v[20:21], v14 offset:30784
    ds_read_b64_tr_b16 v[22:23], v14 offset:32064
    v_cvt_pk_bf16_f32 v124, v40, v41
    v_cvt_pk_bf16_f32 v125, v42, v43
    v_lshlrev_b32 v40, 16, v126
    v_and_b32 v41, 0xffff0000, v126
    s_add_u32 m0, s18, 86016
    s_waitcnt lgkmcnt(6)
    v_mfma_f32_32x32x16_bf16 a[48:63], v[32:35], v[116:119], a[48:63]
    buffer_load_dwordx4 v7, s[24:27], s55 offen lds
    ds_read_b64_tr_b16 v[24:25], v14 offset:30848
    ds_read_b64_tr_b16 v[26:27], v14 offset:32128
    v_lshlrev_b32 v42, 16, v127
    v_and_b32 v43, 0xffff0000, v127
    v_fma_f32 v40, v40, v12, v13
    v_fma_f32 v41, v41, v12, v13
    s_waitcnt lgkmcnt(6)
    v_mfma_f32_32x32x16_bf16 a[64:79], v[36:39], v[116:119], a[64:79]
    ds_read_b64_tr_b16 v[28:29], v14 offset:30912
    ds_read_b64_tr_b16 v[30:31], v14 offset:32192
    v_fma_f32 v42, v42, v12, v13
    v_fma_f32 v43, v43, v12, v13
    v_cvt_pk_bf16_f32 v126, v40, v41
    v_cvt_pk_bf16_f32 v127, v42, v43
    s_add_u32 s55, s36, 1105920
    s_add_u32 m0, s18, 102400
    s_waitcnt lgkmcnt(6)
    v_mfma_f32_32x32x16_bf16 a[0:15], v[16:19], v[120:123], a[0:15]
    buffer_load_dwordx4 v3, s[24:27], s55 offen lds
    ds_read_b64_tr_b16 v[32:33], v14 offset:30976
    ds_read_b64_tr_b16 v[34:35], v14 offset:32256
    v_lshlrev_b32 v40, 16, v128
    v_and_b32 v41, 0xffff0000, v128
    v_lshlrev_b32 v42, 16, v129
    v_and_b32 v43, 0xffff0000, v129
    s_waitcnt lgkmcnt(6)
    v_mfma_f32_32x32x16_bf16 a[16:31], v[20:23], v[120:123], a[16:31]
    ds_read_b64_tr_b16 v[36:37], v14 offset:35840
    ds_read_b64_tr_b16 v[38:39], v14 offset:37120
    v_fma_f32 v40, v40, v12, v13
    v_fma_f32 v41, v41, v12, v13
    v_fma_f32 v42, v42, v12, v13
    v_fma_f32 v43, v43, v12, v13
    s_add_u32 m0, s18, 103424
    s_waitcnt lgkmcnt(6)
    v_mfma_f32_32x32x16_bf16 a[32:47], v[24:27], v[120:123], a[32:47]
    buffer_load_dwordx4 v4, s[24:27], s55 offen lds
    ds_read_b64_tr_b16 v[16:17], v14 offset:35904
    ds_read_b64_tr_b16 v[18:19], v14 offset:37184
    v_cvt_pk_bf16_f32 v128, v40, v41
    v_cvt_pk_bf16_f32 v129, v42, v43
    v_lshlrev_b32 v40, 16, v130
    v_and_b32 v41, 0xffff0000, v130
    s_waitcnt lgkmcnt(6)
    v_mfma_f32_32x32x16_bf16 a[48:63], v[28:31], v[120:123], a[48:63]
    ds_read_b64_tr_b16 v[20:21], v14 offset:35968
    ds_read_b64_tr_b16 v[22:23], v14 offset:37248
    v_lshlrev_b32 v42, 16, v131
    v_and_b32 v43, 0xffff0000, v131
    v_fma_f32 v40, v40, v12, v13
    v_fma_f32 v41, v41, v12, v13
    s_add_u32 m0, s18, 104448
    s_waitcnt lgkmcnt(6)
    v_mfma_f32_32x32x16_bf16 a[64:79], v[32:35], v[120:123], a[64:79]
    buffer_load_dwordx4 v5, s[24:27], s55 offen lds
    ds_read_b64_tr_b16 v[24:25], v14 offset:36032
    ds_read_b64_tr_b16 v[26:27], v14 offset:37312
    v_fma_f32 v42, v42, v12, v13
    v_fma_f32 v43, v43, v12, v13
    v_cvt_pk_bf16_f32 v130, v40, v41
    v_cvt_pk_bf16_f32 v131, v42, v43
    s_waitcnt lgkmcnt(6)
    v_mfma_f32_32x32x16_bf16 a[0:15], v[36:39], v[124:127], a[0:15]
    ds_read_b64_tr_b16 v[28:29], v14 offset:36096
    ds_read_b64_tr_b16 v[30:31], v14 offset:37376
    v_lshlrev_b32 v40, 16, v132
    v_and_b32 v41, 0xffff0000, v132
    v_lshlrev_b32 v42, 16, v133
    v_and_b32 v43, 0xffff0000, v133
    s_add_u32 m0, s18, 105472
    s_waitcnt lgkmcnt(6)
    v_mfma_f32_32x32x16_bf16 a[16:31], v[16:19], v[124:127], a[16:31]
    buffer_load_dwordx4 v6, s[24:27], s55 offen lds
    s_waitcnt vmcnt(14)
    s_barrier
    ds_read_b64_tr_b16 v[32:33], v14 offset:40960
    ds_read_b64_tr_b16 v[34:35], v14 offset:42240
    v_fma_f32 v40, v40, v12, v13
    v_fma_f32 v41, v41, v12, v13
    v_fma_f32 v42, v42, v12, v13
    v_fma_f32 v43, v43, v12, v13
    s_add_u32 m0, s59, 0
    s_add_u32 s101, s96, 0
    s_waitcnt lgkmcnt(6)
    v_mfma_f32_32x32x16_bf16 a[32:47], v[20:23], v[124:127], a[32:47]
    buffer_load_dwordx4 v76, s[8:11], s101 offen lds
    ds_read_b64_tr_b16 v[36:37], v14 offset:41024
    ds_read_b64_tr_b16 v[38:39], v14 offset:42304
    v_cvt_pk_bf16_f32 v132, v40, v41
    v_cvt_pk_bf16_f32 v133, v42, v43
    v_lshlrev_b32 v40, 16, v134
    v_and_b32 v41, 0xffff0000, v134
    s_add_u32 m0, s18, 106496
    s_waitcnt lgkmcnt(6)
    v_mfma_f32_32x32x16_bf16 a[48:63], v[24:27], v[124:127], a[48:63]
    buffer_load_dwordx4 v7, s[24:27], s55 offen lds
    ds_read_b64_tr_b16 v[16:17], v14 offset:41088
    ds_read_b64_tr_b16 v[18:19], v14 offset:42368
    v_lshlrev_b32 v42, 16, v135
    v_and_b32 v43, 0xffff0000, v135
    v_fma_f32 v40, v40, v12, v13
    v_fma_f32 v41, v41, v12, v13
    s_waitcnt lgkmcnt(6)
    v_mfma_f32_32x32x16_bf16 a[64:79], v[28:31], v[124:127], a[64:79]
    ds_read_b64_tr_b16 v[20:21], v14 offset:41152
    ds_read_b64_tr_b16 v[22:23], v14 offset:42432
    v_fma_f32 v42, v42, v12, v13
    v_fma_f32 v43, v43, v12, v13
    v_cvt_pk_bf16_f32 v134, v40, v41
    v_cvt_pk_bf16_f32 v135, v42, v43
    s_waitcnt lgkmcnt(6)
    v_mfma_f32_32x32x16_bf16 a[0:15], v[32:35], v[128:131], a[0:15]
    ds_read_b64_tr_b16 v[24:25], v14 offset:41216
    ds_read_b64_tr_b16 v[26:27], v14 offset:42496
    v_lshlrev_b32 v40, 16, v136
    v_and_b32 v41, 0xffff0000, v136
    v_lshlrev_b32 v42, 16, v137
    v_and_b32 v43, 0xffff0000, v137
    s_add_u32 m0, s59, 1024
    s_add_u32 s101, s96, 5120
    s_waitcnt lgkmcnt(6)
    v_mfma_f32_32x32x16_bf16 a[16:31], v[36:39], v[128:131], a[16:31]
    buffer_load_dwordx4 v76, s[8:11], s101 offen lds
    ds_read_b64_tr_b16 v[28:29], v14 offset:46080
    ds_read_b64_tr_b16 v[30:31], v14 offset:47360
    v_fma_f32 v40, v40, v12, v13
    v_fma_f32 v41, v41, v12, v13
    v_fma_f32 v42, v42, v12, v13
    v_fma_f32 v43, v43, v12, v13
    s_add_u32 s55, s36, 1327104
    s_add_u32 m0, s18, 0
    s_waitcnt lgkmcnt(6)
    v_mfma_f32_32x32x16_bf16 a[32:47], v[16:19], v[128:131], a[32:47]
    buffer_load_dwordx4 v3, s[24:27], s55 offen lds
    ds_read_b64_tr_b16 v[32:33], v14 offset:46144
    ds_read_b64_tr_b16 v[34:35], v14 offset:47424
    v_cvt_pk_bf16_f32 v136, v40, v41
    v_cvt_pk_bf16_f32 v137, v42, v43
    v_lshlrev_b32 v40, 16, v138
    v_and_b32 v41, 0xffff0000, v138
    s_waitcnt lgkmcnt(6)
    v_mfma_f32_32x32x16_bf16 a[48:63], v[20:23], v[128:131], a[48:63]
    ds_read_b64_tr_b16 v[36:37], v14 offset:46208
    ds_read_b64_tr_b16 v[38:39], v14 offset:47488
    v_lshlrev_b32 v42, 16, v139
    v_and_b32 v43, 0xffff0000, v139
    v_fma_f32 v40, v40, v12, v13
    v_fma_f32 v41, v41, v12, v13
    s_waitcnt lgkmcnt(6)
    v_mfma_f32_32x32x16_bf16 a[64:79], v[24:27], v[128:131], a[64:79]
    ds_read_b64_tr_b16 v[16:17], v14 offset:46272
    ds_read_b64_tr_b16 v[18:19], v14 offset:47552
    v_fma_f32 v42, v42, v12, v13
    v_fma_f32 v43, v43, v12, v13
    v_cvt_pk_bf16_f32 v138, v40, v41
    v_cvt_pk_bf16_f32 v139, v42, v43
    s_add_u32 m0, s59, 2048
    s_add_u32 s101, s96, 10240
    s_waitcnt lgkmcnt(6)
    v_mfma_f32_32x32x16_bf16 a[0:15], v[28:31], v[132:135], a[0:15]
    buffer_load_dwordx4 v76, s[8:11], s101 offen lds
    ds_read_b64_tr_b16 v[20:21], v14 offset:46336
    ds_read_b64_tr_b16 v[22:23], v14 offset:47616
    v_lshlrev_b32 v40, 16, v140
    v_and_b32 v41, 0xffff0000, v140
    v_lshlrev_b32 v42, 16, v141
    v_and_b32 v43, 0xffff0000, v141
    s_add_u32 m0, s18, 1024
    s_waitcnt lgkmcnt(6)
    v_mfma_f32_32x32x16_bf16 a[16:31], v[32:35], v[132:135], a[16:31]
    buffer_load_dwordx4 v4, s[24:27], s55 offen lds
    ds_read_b64_tr_b16 v[24:25], v14 offset:51200
    ds_read_b64_tr_b16 v[26:27], v14 offset:52480
    v_fma_f32 v40, v40, v12, v13
    v_fma_f32 v41, v41, v12, v13
    v_fma_f32 v42, v42, v12, v13
    v_fma_f32 v43, v43, v12, v13
    s_waitcnt lgkmcnt(6)
    v_mfma_f32_32x32x16_bf16 a[32:47], v[36:39], v[132:135], a[32:47]
    ds_read_b64_tr_b16 v[28:29], v14 offset:51264
    ds_read_b64_tr_b16 v[30:31], v14 offset:52544
    v_cvt_pk_bf16_f32 v140, v40, v41
    v_cvt_pk_bf16_f32 v141, v42, v43
    v_lshlrev_b32 v40, 16, v142
    v_and_b32 v41, 0xffff0000, v142
    s_waitcnt lgkmcnt(6)
    v_mfma_f32_32x32x16_bf16 a[48:63], v[16:19], v[132:135], a[48:63]
    ds_read_b64_tr_b16 v[32:33], v14 offset:51328
    ds_read_b64_tr_b16 v[34:35], v14 offset:52608
    v_lshlrev_b32 v42, 16, v143
    v_and_b32 v43, 0xffff0000, v143
    v_fma_f32 v40, v40, v12, v13
    v_fma_f32 v41, v41, v12, v13
    s_add_u32 m0, s59, 3072
    s_add_u32 s101, s96, 15360
    s_waitcnt lgkmcnt(6)
    v_mfma_f32_32x32x16_bf16 a[64:79], v[20:23], v[132:135], a[64:79]
    buffer_load_dwordx4 v76, s[8:11], s101 offen lds
    ds_read_b64_tr_b16 v[36:37], v14 offset:51392
    ds_read_b64_tr_b16 v[38:39], v14 offset:52672
    v_fma_f32 v42, v42, v12, v13
    v_fma_f32 v43, v43, v12, v13
    v_cvt_pk_bf16_f32 v142, v40, v41
    v_cvt_pk_bf16_f32 v143, v42, v43
    s_add_u32 m0, s18, 2048
    s_waitcnt lgkmcnt(6)
    v_mfma_f32_32x32x16_bf16 a[0:15], v[24:27], v[136:139], a[0:15]
    buffer_load_dwordx4 v5, s[24:27], s55 offen lds
    ds_read_b64_tr_b16 v[16:17], v14 offset:51456
    ds_read_b64_tr_b16 v[18:19], v14 offset:52736
    v_lshlrev_b32 v40, 16, v144
    v_and_b32 v41, 0xffff0000, v144
    v_lshlrev_b32 v42, 16, v145
    v_and_b32 v43, 0xffff0000, v145
    s_waitcnt lgkmcnt(6)
    v_mfma_f32_32x32x16_bf16 a[16:31], v[28:31], v[136:139], a[16:31]
    ds_read_b64_tr_b16 v[20:21], v14 offset:56320
    ds_read_b64_tr_b16 v[22:23], v14 offset:57600
    v_fma_f32 v40, v40, v12, v13
    v_fma_f32 v41, v41, v12, v13
    v_fma_f32 v42, v42, v12, v13
    v_fma_f32 v43, v43, v12, v13
    s_waitcnt lgkmcnt(6)
    v_mfma_f32_32x32x16_bf16 a[32:47], v[32:35], v[136:139], a[32:47]
    ds_read_b64_tr_b16 v[24:25], v14 offset:56384
    ds_read_b64_tr_b16 v[26:27], v14 offset:57664
    v_cvt_pk_bf16_f32 v144, v40, v41
    v_cvt_pk_bf16_f32 v145, v42, v43
    v_lshlrev_b32 v40, 16, v146
    v_and_b32 v41, 0xffff0000, v146
    s_add_u32 m0, s59, 4096
    s_add_u32 s101, s97, 0
    s_waitcnt lgkmcnt(6)
    v_mfma_f32_32x32x16_bf16 a[48:63], v[36:39], v[136:139], a[48:63]
    buffer_load_dwordx4 v76, s[8:11], s101 offen lds
    ds_read_b64_tr_b16 v[28:29], v14 offset:56448
    ds_read_b64_tr_b16 v[30:31], v14 offset:57728
    v_lshlrev_b32 v42, 16, v147
    v_and_b32 v43, 0xffff0000, v147
    v_fma_f32 v40, v40, v12, v13
    v_fma_f32 v41, v41, v12, v13
    s_add_u32 m0, s18, 3072
    s_waitcnt lgkmcnt(6)
    v_mfma_f32_32x32x16_bf16 a[64:79], v[16:19], v[136:139], a[64:79]
    buffer_load_dwordx4 v6, s[24:27], s55 offen lds
    ds_read_b64_tr_b16 v[32:33], v14 offset:56512
    ds_read_b64_tr_b16 v[34:35], v14 offset:57792
    v_fma_f32 v42, v42, v12, v13
    v_fma_f32 v43, v43, v12, v13
    v_cvt_pk_bf16_f32 v146, v40, v41
    v_cvt_pk_bf16_f32 v147, v42, v43
    s_waitcnt lgkmcnt(6)
    v_mfma_f32_32x32x16_bf16 a[0:15], v[20:23], v[140:143], a[0:15]
    ds_read_b64_tr_b16 v[36:37], v14 offset:56576
    ds_read_b64_tr_b16 v[38:39], v14 offset:57856
    v_lshlrev_b32 v40, 16, v148
    v_and_b32 v41, 0xffff0000, v148
    v_lshlrev_b32 v42, 16, v149
    v_and_b32 v43, 0xffff0000, v149
    s_waitcnt lgkmcnt(6)
    v_mfma_f32_32x32x16_bf16 a[16:31], v[24:27], v[140:143], a[16:31]
    s_waitcnt vmcnt(19)
    s_barrier
    ds_read_b64_tr_b16 v[16:17], v15 offset:0
    ds_read_b64_tr_b16 v[18:19], v15 offset:1280
    v_fma_f32 v40, v40, v12, v13
    v_fma_f32 v41, v41, v12, v13
    v_fma_f32 v42, v42, v12, v13
    v_fma_f32 v43, v43, v12, v13
    s_add_u32 m0, s59, 5120
    s_add_u32 s101, s97, 5120
    s_waitcnt lgkmcnt(6)
    v_mfma_f32_32x32x16_bf16 a[32:47], v[28:31], v[140:143], a[32:47]
    buffer_load_dwordx4 v76, s[8:11], s101 offen lds
    ds_read_b64_tr_b16 v[20:21], v15 offset:64
    ds_read_b64_tr_b16 v[22:23], v15 offset:1344
    v_cvt_pk_bf16_f32 v148, v40, v41
    v_cvt_pk_bf16_f32 v149, v42, v43
    v_lshlrev_b32 v40, 16, v150
    v_and_b32 v41, 0xffff0000, v150
    s_add_u32 m0, s18, 4096
    s_waitcnt lgkmcnt(6)
    v_mfma_f32_32x32x16_bf16 a[48:63], v[32:35], v[140:143], a[48:63]
    buffer_load_dwordx4 v7, s[24:27], s55 offen lds
    ds_read_b64_tr_b16 v[24:25], v15 offset:128
    ds_read_b64_tr_b16 v[26:27], v15 offset:1408
    v_lshlrev_b32 v42, 16, v151
    v_and_b32 v43, 0xffff0000, v151
    v_fma_f32 v40, v40, v12, v13
    v_fma_f32 v41, v41, v12, v13
    s_waitcnt lgkmcnt(6)
    v_mfma_f32_32x32x16_bf16 a[64:79], v[36:39], v[140:143], a[64:79]
    ds_read_b64_tr_b16 v[28:29], v15 offset:192
    ds_read_b64_tr_b16 v[30:31], v15 offset:1472
    v_fma_f32 v42, v42, v12, v13
    v_fma_f32 v43, v43, v12, v13
    v_cvt_pk_bf16_f32 v150, v40, v41
    v_cvt_pk_bf16_f32 v151, v42, v43
    s_waitcnt lgkmcnt(6)
    v_mfma_f32_32x32x16_bf16 a[0:15], v[16:19], v[144:147], a[0:15]
    ds_read_b64_tr_b16 v[32:33], v15 offset:256
    ds_read_b64_tr_b16 v[34:35], v15 offset:1536
    v_lshlrev_b32 v40, 16, v152
    v_and_b32 v41, 0xffff0000, v152
    v_lshlrev_b32 v42, 16, v153
    v_and_b32 v43, 0xffff0000, v153
    s_add_u32 m0, s59, 6144
    s_add_u32 s101, s97, 10240
    s_waitcnt lgkmcnt(6)
    v_mfma_f32_32x32x16_bf16 a[16:31], v[20:23], v[144:147], a[16:31]
    buffer_load_dwordx4 v76, s[8:11], s101 offen lds
    ds_read_b64_tr_b16 v[36:37], v15 offset:5120
    ds_read_b64_tr_b16 v[38:39], v15 offset:6400
    v_fma_f32 v40, v40, v12, v13
    v_fma_f32 v41, v41, v12, v13
    v_fma_f32 v42, v42, v12, v13
    v_fma_f32 v43, v43, v12, v13
    s_add_u32 s55, s36, 1548288
    s_add_u32 m0, s18, 20480
    s_waitcnt lgkmcnt(6)
    v_mfma_f32_32x32x16_bf16 a[32:47], v[24:27], v[144:147], a[32:47]
    buffer_load_dwordx4 v3, s[24:27], s55 offen lds
    ds_read_b64_tr_b16 v[16:17], v15 offset:5184
    ds_read_b64_tr_b16 v[18:19], v15 offset:6464
    v_cvt_pk_bf16_f32 v152, v40, v41
    v_cvt_pk_bf16_f32 v153, v42, v43
    v_lshlrev_b32 v40, 16, v154
    v_and_b32 v41, 0xffff0000, v154
    s_waitcnt lgkmcnt(6)
    v_mfma_f32_32x32x16_bf16 a[48:63], v[28:31], v[144:147], a[48:63]
    ds_read_b64_tr_b16 v[20:21], v15 offset:5248
    ds_read_b64_tr_b16 v[22:23], v15 offset:6528
    v_lshlrev_b32 v42, 16, v155
    v_and_b32 v43, 0xffff0000, v155
    v_fma_f32 v40, v40, v12, v13
    v_fma_f32 v41, v41, v12, v13
    s_waitcnt lgkmcnt(6)
    v_mfma_f32_32x32x16_bf16 a[64:79], v[32:35], v[144:147], a[64:79]
    ds_read_b64_tr_b16 v[24:25], v15 offset:5312
    ds_read_b64_tr_b16 v[26:27], v15 offset:6592
    v_fma_f32 v42, v42, v12, v13
    v_fma_f32 v43, v43, v12, v13
    v_cvt_pk_bf16_f32 v154, v40, v41
    v_cvt_pk_bf16_f32 v155, v42, v43
    s_add_u32 m0, s59, 7168
    s_add_u32 s101, s97, 15360
    s_waitcnt lgkmcnt(6)
    v_mfma_f32_32x32x16_bf16 a[0:15], v[36:39], v[148:151], a[0:15]
    buffer_load_dwordx4 v76, s[8:11], s101 offen lds
    ds_read_b64_tr_b16 v[28:29], v15 offset:5376
    ds_read_b64_tr_b16 v[30:31], v15 offset:6656
    v_lshlrev_b32 v40, 16, v156
    v_and_b32 v41, 0xffff0000, v156
    v_lshlrev_b32 v42, 16, v157
    v_and_b32 v43, 0xffff0000, v157
    s_add_u32 m0, s18, 21504
    s_waitcnt lgkmcnt(6)
    v_mfma_f32_32x32x16_bf16 a[16:31], v[16:19], v[148:151], a[16:31]
    buffer_load_dwordx4 v4, s[24:27], s55 offen lds
    ds_read_b64_tr_b16 v[32:33], v15 offset:10240
    ds_read_b64_tr_b16 v[34:35], v15 offset:11520
    v_fma_f32 v40, v40, v12, v13
    v_fma_f32 v41, v41, v12, v13
    v_fma_f32 v42, v42, v12, v13
    v_fma_f32 v43, v43, v12, v13
    s_waitcnt lgkmcnt(6)
    v_mfma_f32_32x32x16_bf16 a[32:47], v[20:23], v[148:151], a[32:47]
    ds_read_b64_tr_b16 v[36:37], v15 offset:10304
    ds_read_b64_tr_b16 v[38:39], v15 offset:11584
    v_cvt_pk_bf16_f32 v156, v40, v41
    v_cvt_pk_bf16_f32 v157, v42, v43
    v_lshlrev_b32 v40, 16, v158
    v_and_b32 v41, 0xffff0000, v158
    s_waitcnt lgkmcnt(6)
    v_mfma_f32_32x32x16_bf16 a[48:63], v[24:27], v[148:151], a[48:63]
    ds_read_b64_tr_b16 v[16:17], v15 offset:10368
    ds_read_b64_tr_b16 v[18:19], v15 offset:11648
    v_lshlrev_b32 v42, 16, v159
    v_and_b32 v43, 0xffff0000, v159
    v_fma_f32 v40, v40, v12, v13
    v_fma_f32 v41, v41, v12, v13
    s_waitcnt lgkmcnt(6)
    v_mfma_f32_32x32x16_bf16 a[64:79], v[28:31], v[148:151], a[64:79]
    ds_read_b64_tr_b16 v[20:21], v15 offset:10432
    ds_read_b64_tr_b16 v[22:23], v15 offset:11712
    v_fma_f32 v42, v42, v12, v13
    v_fma_f32 v43, v43, v12, v13
    v_cvt_pk_bf16_f32 v158, v40, v41
    v_cvt_pk_bf16_f32 v159, v42, v43
    s_add_u32 m0, s18, 22528
    s_waitcnt lgkmcnt(6)
    v_mfma_f32_32x32x16_bf16 a[0:15], v[32:35], v[152:155], a[0:15]
    buffer_load_dwordx4 v5, s[24:27], s55 offen lds
    ds_read_b64_tr_b16 v[24:25], v15 offset:10496
    ds_read_b64_tr_b16 v[26:27], v15 offset:11776
    v_lshlrev_b32 v40, 16, v160
    v_and_b32 v41, 0xffff0000, v160
    v_lshlrev_b32 v42, 16, v161
    v_and_b32 v43, 0xffff0000, v161
    s_waitcnt lgkmcnt(6)
    v_mfma_f32_32x32x16_bf16 a[16:31], v[36:39], v[152:155], a[16:31]
    ds_read_b64_tr_b16 v[28:29], v15 offset:15360
    ds_read_b64_tr_b16 v[30:31], v15 offset:16640
    v_fma_f32 v40, v40, v12, v13
    v_fma_f32 v41, v41, v12, v13
    v_fma_f32 v42, v42, v12, v13
    v_fma_f32 v43, v43, v12, v13
    s_waitcnt lgkmcnt(6)
    v_mfma_f32_32x32x16_bf16 a[32:47], v[16:19], v[152:155], a[32:47]
    ds_read_b64_tr_b16 v[32:33], v15 offset:15424
    ds_read_b64_tr_b16 v[34:35], v15 offset:16704
    v_cvt_pk_bf16_f32 v160, v40, v41
    v_cvt_pk_bf16_f32 v161, v42, v43
    v_lshlrev_b32 v40, 16, v162
    v_and_b32 v41, 0xffff0000, v162
    s_waitcnt lgkmcnt(6)
    v_mfma_f32_32x32x16_bf16 a[48:63], v[20:23], v[152:155], a[48:63]
    ds_read_b64_tr_b16 v[36:37], v15 offset:15488
    ds_read_b64_tr_b16 v[38:39], v15 offset:16768
    v_lshlrev_b32 v42, 16, v163
    v_and_b32 v43, 0xffff0000, v163
    v_fma_f32 v40, v40, v12, v13
    v_fma_f32 v41, v41, v12, v13
    s_add_u32 m0, s18, 23552
    s_waitcnt lgkmcnt(6)
    v_mfma_f32_32x32x16_bf16 a[64:79], v[24:27], v[152:155], a[64:79]
    buffer_load_dwordx4 v6, s[24:27], s55 offen lds
    ds_read_b64_tr_b16 v[16:17], v15 offset:15552
    ds_read_b64_tr_b16 v[18:19], v15 offset:16832
    v_fma_f32 v42, v42, v12, v13
    v_fma_f32 v43, v43, v12, v13
    v_cvt_pk_bf16_f32 v162, v40, v41
    v_cvt_pk_bf16_f32 v163, v42, v43
    s_waitcnt lgkmcnt(6)
    v_mfma_f32_32x32x16_bf16 a[0:15], v[28:31], v[156:159], a[0:15]
    ds_read_b64_tr_b16 v[20:21], v15 offset:15616
    ds_read_b64_tr_b16 v[22:23], v15 offset:16896
    v_lshlrev_b32 v40, 16, v164
    v_and_b32 v41, 0xffff0000, v164
    v_lshlrev_b32 v42, 16, v165
    v_and_b32 v43, 0xffff0000, v165
    s_waitcnt lgkmcnt(6)
    v_mfma_f32_32x32x16_bf16 a[16:31], v[32:35], v[156:159], a[16:31]
    s_waitcnt vmcnt(22)
    s_barrier
    s_cmp_lg_u32 s14, 0
    s_cbranch_scc1 parallel_sum__linear_attn_block__dense_activation_relu__prompt_kernel_b_initp_pre
    s_and_b32 s40, s2, 3
    s_lshl_b32 s40, s40, 6
    v_mov_b32 v1, s40
    s_mov_b64 exec, 1
    buffer_load_dword v95, v1, s[32:35], 0 offen sc0 sc1
    s_mov_b64 exec, -1
parallel_sum__linear_attn_block__dense_activation_relu__prompt_kernel_b_initp_pre:
    ds_read_b64_tr_b16 v[24:25], v15 offset:20480
    ds_read_b64_tr_b16 v[26:27], v15 offset:21760
    v_fma_f32 v40, v40, v12, v13
    v_fma_f32 v41, v41, v12, v13
    v_fma_f32 v42, v42, v12, v13
    v_fma_f32 v43, v43, v12, v13
    s_waitcnt lgkmcnt(6)
    v_mfma_f32_32x32x16_bf16 a[32:47], v[36:39], v[156:159], a[32:47]
    ds_read_b64_tr_b16 v[28:29], v15 offset:20544
    ds_read_b64_tr_b16 v[30:31], v15 offset:21824
    v_cvt_pk_bf16_f32 v164, v40, v41
    v_cvt_pk_bf16_f32 v165, v42, v43
    v_lshlrev_b32 v40, 16, v166
    v_and_b32 v41, 0xffff0000, v166
    s_add_u32 m0, s18, 24576
    s_waitcnt lgkmcnt(6)
    v_mfma_f32_32x32x16_bf16 a[48:63], v[16:19], v[156:159], a[48:63]
    buffer_load_dwordx4 v7, s[24:27], s55 offen lds
    ds_read_b64_tr_b16 v[32:33], v15 offset:20608
    ds_read_b64_tr_b16 v[34:35], v15 offset:21888
    v_lshlrev_b32 v42, 16, v167
    v_and_b32 v43, 0xffff0000, v167
    v_fma_f32 v40, v40, v12, v13
    v_fma_f32 v41, v41, v12, v13
    s_waitcnt lgkmcnt(6)
    v_mfma_f32_32x32x16_bf16 a[64:79], v[20:23], v[156:159], a[64:79]
    ds_read_b64_tr_b16 v[36:37], v15 offset:20672
    ds_read_b64_tr_b16 v[38:39], v15 offset:21952
    v_fma_f32 v42, v42, v12, v13
    v_fma_f32 v43, v43, v12, v13
    v_cvt_pk_bf16_f32 v166, v40, v41
    v_cvt_pk_bf16_f32 v167, v42, v43
    s_waitcnt lgkmcnt(6)
    v_mfma_f32_32x32x16_bf16 a[0:15], v[24:27], v[160:163], a[0:15]
    ds_read_b64_tr_b16 v[16:17], v15 offset:20736
    ds_read_b64_tr_b16 v[18:19], v15 offset:22016
    v_lshlrev_b32 v40, 16, v168
    v_and_b32 v41, 0xffff0000, v168
    v_lshlrev_b32 v42, 16, v169
    v_and_b32 v43, 0xffff0000, v169
    s_waitcnt lgkmcnt(6)
    v_mfma_f32_32x32x16_bf16 a[16:31], v[28:31], v[160:163], a[16:31]
    ds_read_b64_tr_b16 v[20:21], v15 offset:25600
    ds_read_b64_tr_b16 v[22:23], v15 offset:26880
    v_fma_f32 v40, v40, v12, v13
    v_fma_f32 v41, v41, v12, v13
    v_fma_f32 v42, v42, v12, v13
    v_fma_f32 v43, v43, v12, v13
    s_add_u32 s55, s36, 1769472
    s_add_u32 m0, s18, 40960
    s_waitcnt lgkmcnt(6)
    v_mfma_f32_32x32x16_bf16 a[32:47], v[32:35], v[160:163], a[32:47]
    buffer_load_dwordx4 v3, s[24:27], s55 offen lds
    ds_read_b64_tr_b16 v[24:25], v15 offset:25664
    ds_read_b64_tr_b16 v[26:27], v15 offset:26944
    v_cvt_pk_bf16_f32 v168, v40, v41
    v_cvt_pk_bf16_f32 v169, v42, v43
    v_lshlrev_b32 v40, 16, v170
    v_and_b32 v41, 0xffff0000, v170
    s_waitcnt lgkmcnt(6)
    v_mfma_f32_32x32x16_bf16 a[48:63], v[36:39], v[160:163], a[48:63]
    ds_read_b64_tr_b16 v[28:29], v15 offset:25728
    ds_read_b64_tr_b16 v[30:31], v15 offset:27008
    v_lshlrev_b32 v42, 16, v171
    v_and_b32 v43, 0xffff0000, v171
    v_fma_f32 v40, v40, v12, v13
    v_fma_f32 v41, v41, v12, v13
    s_waitcnt lgkmcnt(6)
    v_mfma_f32_32x32x16_bf16 a[64:79], v[16:19], v[160:163], a[64:79]
    ds_read_b64_tr_b16 v[32:33], v15 offset:25792
    ds_read_b64_tr_b16 v[34:35], v15 offset:27072
    v_fma_f32 v42, v42, v12, v13
    v_fma_f32 v43, v43, v12, v13
    v_cvt_pk_bf16_f32 v170, v40, v41
    v_cvt_pk_bf16_f32 v171, v42, v43
    s_waitcnt lgkmcnt(6)
    v_mfma_f32_32x32x16_bf16 a[0:15], v[20:23], v[164:167], a[0:15]
    ds_read_b64_tr_b16 v[36:37], v15 offset:25856
    ds_read_b64_tr_b16 v[38:39], v15 offset:27136
    v_lshlrev_b32 v40, 16, v172
    v_and_b32 v41, 0xffff0000, v172
    v_lshlrev_b32 v42, 16, v173
    v_and_b32 v43, 0xffff0000, v173
    s_add_u32 m0, s18, 41984
    s_waitcnt lgkmcnt(6)
    v_mfma_f32_32x32x16_bf16 a[16:31], v[24:27], v[164:167], a[16:31]
    buffer_load_dwordx4 v4, s[24:27], s55 offen lds
    ds_read_b64_tr_b16 v[16:17], v15 offset:30720
    ds_read_b64_tr_b16 v[18:19], v15 offset:32000
    v_fma_f32 v40, v40, v12, v13
    v_fma_f32 v41, v41, v12, v13
    v_fma_f32 v42, v42, v12, v13
    v_fma_f32 v43, v43, v12, v13
    s_waitcnt lgkmcnt(6)
    v_mfma_f32_32x32x16_bf16 a[32:47], v[28:31], v[164:167], a[32:47]
    ds_read_b64_tr_b16 v[20:21], v15 offset:30784
    ds_read_b64_tr_b16 v[22:23], v15 offset:32064
    v_cvt_pk_bf16_f32 v172, v40, v41
    v_cvt_pk_bf16_f32 v173, v42, v43
    v_lshlrev_b32 v40, 16, v174
    v_and_b32 v41, 0xffff0000, v174
    s_waitcnt lgkmcnt(6)
    v_mfma_f32_32x32x16_bf16 a[48:63], v[32:35], v[164:167], a[48:63]
    ds_read_b64_tr_b16 v[24:25], v15 offset:30848
    ds_read_b64_tr_b16 v[26:27], v15 offset:32128
    v_lshlrev_b32 v42, 16, v175
    v_and_b32 v43, 0xffff0000, v175
    v_fma_f32 v40, v40, v12, v13
    v_fma_f32 v41, v41, v12, v13
    s_waitcnt lgkmcnt(6)
    v_mfma_f32_32x32x16_bf16 a[64:79], v[36:39], v[164:167], a[64:79]
    ds_read_b64_tr_b16 v[28:29], v15 offset:30912
    ds_read_b64_tr_b16 v[30:31], v15 offset:32192
    v_fma_f32 v42, v42, v12, v13
    v_fma_f32 v43, v43, v12, v13
    v_cvt_pk_bf16_f32 v174, v40, v41
    v_cvt_pk_bf16_f32 v175, v42, v43
    s_add_u32 m0, s18, 43008
    s_waitcnt lgkmcnt(6)
    v_mfma_f32_32x32x16_bf16 a[0:15], v[16:19], v[168:171], a[0:15]
    buffer_load_dwordx4 v5, s[24:27], s55 offen lds
    ds_read_b64_tr_b16 v[32:33], v15 offset:30976
    ds_read_b64_tr_b16 v[34:35], v15 offset:32256
    v_lshlrev_b32 v40, 16, v176
    v_and_b32 v41, 0xffff0000, v176
    v_lshlrev_b32 v42, 16, v177
    v_and_b32 v43, 0xffff0000, v177
    s_waitcnt lgkmcnt(6)
    v_mfma_f32_32x32x16_bf16 a[16:31], v[20:23], v[168:171], a[16:31]
    ds_read_b64_tr_b16 v[36:37], v15 offset:35840
    ds_read_b64_tr_b16 v[38:39], v15 offset:37120
    v_fma_f32 v40, v40, v12, v13
    v_fma_f32 v41, v41, v12, v13
    v_fma_f32 v42, v42, v12, v13
    v_fma_f32 v43, v43, v12, v13
    s_waitcnt lgkmcnt(6)
    v_mfma_f32_32x32x16_bf16 a[32:47], v[24:27], v[168:171], a[32:47]
    ds_read_b64_tr_b16 v[16:17], v15 offset:35904
    ds_read_b64_tr_b16 v[18:19], v15 offset:37184
    v_cvt_pk_bf16_f32 v176, v40, v41
    v_cvt_pk_bf16_f32 v177, v42, v43
    v_lshlrev_b32 v40, 16, v178
    v_and_b32 v41, 0xffff0000, v178
    s_waitcnt lgkmcnt(6)
    v_mfma_f32_32x32x16_bf16 a[48:63], v[28:31], v[168:171], a[48:63]
    ds_read_b64_tr_b16 v[20:21], v15 offset:35968
    ds_read_b64_tr_b16 v[22:23], v15 offset:37248
    v_lshlrev_b32 v42, 16, v179
    v_and_b32 v43, 0xffff0000, v179
    v_fma_f32 v40, v40, v12, v13
    v_fma_f32 v41, v41, v12, v13
    s_add_u32 m0, s18, 44032
    s_waitcnt lgkmcnt(6)
    v_mfma_f32_32x32x16_bf16 a[64:79], v[32:35], v[168:171], a[64:79]
    buffer_load_dwordx4 v6, s[24:27], s55 offen lds
    ds_read_b64_tr_b16 v[24:25], v15 offset:36032
    ds_read_b64_tr_b16 v[26:27], v15 offset:37312
    v_fma_f32 v42, v42, v12, v13
    v_fma_f32 v43, v43, v12, v13
    v_cvt_pk_bf16_f32 v178, v40, v41
    v_cvt_pk_bf16_f32 v179, v42, v43
    s_waitcnt lgkmcnt(6)
    v_mfma_f32_32x32x16_bf16 a[0:15], v[36:39], v[172:175], a[0:15]
    ds_read_b64_tr_b16 v[28:29], v15 offset:36096
    ds_read_b64_tr_b16 v[30:31], v15 offset:37376
    v_lshlrev_b32 v40, 16, v180
    v_and_b32 v41, 0xffff0000, v180
    v_lshlrev_b32 v42, 16, v181
    v_and_b32 v43, 0xffff0000, v181
    s_waitcnt lgkmcnt(6)
    v_mfma_f32_32x32x16_bf16 a[16:31], v[16:19], v[172:175], a[16:31]
    s_waitcnt vmcnt(21)
    s_barrier
    ds_read_b64_tr_b16 v[32:33], v15 offset:40960
    ds_read_b64_tr_b16 v[34:35], v15 offset:42240
    v_fma_f32 v40, v40, v12, v13
    v_fma_f32 v41, v41, v12, v13
    v_fma_f32 v42, v42, v12, v13
    v_fma_f32 v43, v43, v12, v13
    s_waitcnt lgkmcnt(6)
    v_mfma_f32_32x32x16_bf16 a[32:47], v[20:23], v[172:175], a[32:47]
    ds_read_b64_tr_b16 v[36:37], v15 offset:41024
    ds_read_b64_tr_b16 v[38:39], v15 offset:42304
    v_cvt_pk_bf16_f32 v180, v40, v41
    v_cvt_pk_bf16_f32 v181, v42, v43
    v_lshlrev_b32 v40, 16, v182
    v_and_b32 v41, 0xffff0000, v182
    s_add_u32 m0, s18, 45056
    s_waitcnt lgkmcnt(6)
    v_mfma_f32_32x32x16_bf16 a[48:63], v[24:27], v[172:175], a[48:63]
    buffer_load_dwordx4 v7, s[24:27], s55 offen lds
    ds_read_b64_tr_b16 v[16:17], v15 offset:41088
    ds_read_b64_tr_b16 v[18:19], v15 offset:42368
    v_lshlrev_b32 v42, 16, v183
    v_and_b32 v43, 0xffff0000, v183
    v_fma_f32 v40, v40, v12, v13
    v_fma_f32 v41, v41, v12, v13
    s_waitcnt lgkmcnt(6)
    v_mfma_f32_32x32x16_bf16 a[64:79], v[28:31], v[172:175], a[64:79]
    ds_read_b64_tr_b16 v[20:21], v15 offset:41152
    ds_read_b64_tr_b16 v[22:23], v15 offset:42432
    v_fma_f32 v42, v42, v12, v13
    v_fma_f32 v43, v43, v12, v13
    v_cvt_pk_bf16_f32 v182, v40, v41
    v_cvt_pk_bf16_f32 v183, v42, v43
    s_waitcnt lgkmcnt(6)
    v_mfma_f32_32x32x16_bf16 a[0:15], v[32:35], v[176:179], a[0:15]
    ds_read_b64_tr_b16 v[24:25], v15 offset:41216
    ds_read_b64_tr_b16 v[26:27], v15 offset:42496
    v_lshlrev_b32 v40, 16, v184
    v_and_b32 v41, 0xffff0000, v184
    v_lshlrev_b32 v42, 16, v185
    v_and_b32 v43, 0xffff0000, v185
    s_waitcnt lgkmcnt(6)
    v_mfma_f32_32x32x16_bf16 a[16:31], v[36:39], v[176:179], a[16:31]
    ds_read_b64_tr_b16 v[28:29], v15 offset:46080
    ds_read_b64_tr_b16 v[30:31], v15 offset:47360
    v_fma_f32 v40, v40, v12, v13
    v_fma_f32 v41, v41, v12, v13
    v_fma_f32 v42, v42, v12, v13
    v_fma_f32 v43, v43, v12, v13
    s_add_u32 s55, s36, 1990656
    s_add_u32 m0, s18, 61440
    s_waitcnt lgkmcnt(6)
    v_mfma_f32_32x32x16_bf16 a[32:47], v[16:19], v[176:179], a[32:47]
    buffer_load_dwordx4 v3, s[24:27], s55 offen lds
    ds_read_b64_tr_b16 v[32:33], v15 offset:46144
    ds_read_b64_tr_b16 v[34:35], v15 offset:47424
    v_cvt_pk_bf16_f32 v184, v40, v41
    v_cvt_pk_bf16_f32 v185, v42, v43
    v_lshlrev_b32 v40, 16, v186
    v_and_b32 v41, 0xffff0000, v186
    s_waitcnt lgkmcnt(6)
    v_mfma_f32_32x32x16_bf16 a[48:63], v[20:23], v[176:179], a[48:63]
    ds_read_b64_tr_b16 v[36:37], v15 offset:46208
    ds_read_b64_tr_b16 v[38:39], v15 offset:47488
    v_lshlrev_b32 v42, 16, v187
    v_and_b32 v43, 0xffff0000, v187
    v_fma_f32 v40, v40, v12, v13
    v_fma_f32 v41, v41, v12, v13
    s_waitcnt lgkmcnt(6)
    v_mfma_f32_32x32x16_bf16 a[64:79], v[24:27], v[176:179], a[64:79]
    ds_read_b64_tr_b16 v[16:17], v15 offset:46272
    ds_read_b64_tr_b16 v[18:19], v15 offset:47552
    v_fma_f32 v42, v42, v12, v13
    v_fma_f32 v43, v43, v12, v13
    v_cvt_pk_bf16_f32 v186, v40, v41
    v_cvt_pk_bf16_f32 v187, v42, v43
    s_waitcnt lgkmcnt(6)
    v_mfma_f32_32x32x16_bf16 a[0:15], v[28:31], v[180:183], a[0:15]
    ds_read_b64_tr_b16 v[20:21], v15 offset:46336
    ds_read_b64_tr_b16 v[22:23], v15 offset:47616
    v_lshlrev_b32 v40, 16, v188
    v_and_b32 v41, 0xffff0000, v188
    v_lshlrev_b32 v42, 16, v189
    v_and_b32 v43, 0xffff0000, v189
    s_add_u32 m0, s18, 62464
    s_waitcnt lgkmcnt(6)
    v_mfma_f32_32x32x16_bf16 a[16:31], v[32:35], v[180:183], a[16:31]
    buffer_load_dwordx4 v4, s[24:27], s55 offen lds
    ds_read_b64_tr_b16 v[24:25], v15 offset:51200
    ds_read_b64_tr_b16 v[26:27], v15 offset:52480
    v_fma_f32 v40, v40, v12, v13
    v_fma_f32 v41, v41, v12, v13
    v_fma_f32 v42, v42, v12, v13
    v_fma_f32 v43, v43, v12, v13
    s_waitcnt lgkmcnt(6)
    v_mfma_f32_32x32x16_bf16 a[32:47], v[36:39], v[180:183], a[32:47]
    ds_read_b64_tr_b16 v[28:29], v15 offset:51264
    ds_read_b64_tr_b16 v[30:31], v15 offset:52544
    v_cvt_pk_bf16_f32 v188, v40, v41
    v_cvt_pk_bf16_f32 v189, v42, v43
    v_lshlrev_b32 v40, 16, v190
    v_and_b32 v41, 0xffff0000, v190
    s_waitcnt lgkmcnt(6)
    v_mfma_f32_32x32x16_bf16 a[48:63], v[16:19], v[180:183], a[48:63]
    ds_read_b64_tr_b16 v[32:33], v15 offset:51328
    ds_read_b64_tr_b16 v[34:35], v15 offset:52608
    v_lshlrev_b32 v42, 16, v191
    v_and_b32 v43, 0xffff0000, v191
    v_fma_f32 v40, v40, v12, v13
    v_fma_f32 v41, v41, v12, v13
    s_waitcnt lgkmcnt(6)
    v_mfma_f32_32x32x16_bf16 a[64:79], v[20:23], v[180:183], a[64:79]
    ds_read_b64_tr_b16 v[36:37], v15 offset:51392
    ds_read_b64_tr_b16 v[38:39], v15 offset:52672
    v_fma_f32 v42, v42, v12, v13
    v_fma_f32 v43, v43, v12, v13
    v_cvt_pk_bf16_f32 v190, v40, v41
    v_cvt_pk_bf16_f32 v191, v42, v43
    s_add_u32 m0, s18, 63488
    s_waitcnt lgkmcnt(6)
    v_mfma_f32_32x32x16_bf16 a[0:15], v[24:27], v[184:187], a[0:15]
    buffer_load_dwordx4 v5, s[24:27], s55 offen lds
    ds_read_b64_tr_b16 v[16:17], v15 offset:51456
    ds_read_b64_tr_b16 v[18:19], v15 offset:52736
    v_lshlrev_b32 v40, 16, v192
    v_and_b32 v41, 0xffff0000, v192
    v_lshlrev_b32 v42, 16, v193
    v_and_b32 v43, 0xffff0000, v193
    s_waitcnt lgkmcnt(6)
    v_mfma_f32_32x32x16_bf16 a[16:31], v[28:31], v[184:187], a[16:31]
    ds_read_b64_tr_b16 v[20:21], v15 offset:56320
    ds_read_b64_tr_b16 v[22:23], v15 offset:57600
    v_fma_f32 v40, v40, v12, v13
    v_fma_f32 v41, v41, v12, v13
    v_fma_f32 v42, v42, v12, v13
    v_fma_f32 v43, v43, v12, v13
    s_waitcnt lgkmcnt(6)
    v_mfma_f32_32x32x16_bf16 a[32:47], v[32:35], v[184:187], a[32:47]
    ds_read_b64_tr_b16 v[24:25], v15 offset:56384
    ds_read_b64_tr_b16 v[26:27], v15 offset:57664
    v_cvt_pk_bf16_f32 v192, v40, v41
    v_cvt_pk_bf16_f32 v193, v42, v43
    v_lshlrev_b32 v40, 16, v194
    v_and_b32 v41, 0xffff0000, v194
    s_waitcnt lgkmcnt(6)
    v_mfma_f32_32x32x16_bf16 a[48:63], v[36:39], v[184:187], a[48:63]
    ds_read_b64_tr_b16 v[28:29], v15 offset:56448
    ds_read_b64_tr_b16 v[30:31], v15 offset:57728
    v_lshlrev_b32 v42, 16, v195
    v_and_b32 v43, 0xffff0000, v195
    v_fma_f32 v40, v40, v12, v13
    v_fma_f32 v41, v41, v12, v13
    s_add_u32 m0, s18, 64512
    s_waitcnt lgkmcnt(6)
    v_mfma_f32_32x32x16_bf16 a[64:79], v[16:19], v[184:187], a[64:79]
    buffer_load_dwordx4 v6, s[24:27], s55 offen lds
    ds_read_b64_tr_b16 v[32:33], v15 offset:56512
    ds_read_b64_tr_b16 v[34:35], v15 offset:57792
    v_fma_f32 v42, v42, v12, v13
    v_fma_f32 v43, v43, v12, v13
    v_cvt_pk_bf16_f32 v194, v40, v41
    v_cvt_pk_bf16_f32 v195, v42, v43
    s_waitcnt lgkmcnt(6)
    v_mfma_f32_32x32x16_bf16 a[0:15], v[20:23], v[188:191], a[0:15]
    ds_read_b64_tr_b16 v[36:37], v15 offset:56576
    ds_read_b64_tr_b16 v[38:39], v15 offset:57856
    v_lshlrev_b32 v40, 16, v196
    v_and_b32 v41, 0xffff0000, v196
    v_lshlrev_b32 v42, 16, v197
    v_and_b32 v43, 0xffff0000, v197
    s_waitcnt lgkmcnt(6)
    v_mfma_f32_32x32x16_bf16 a[16:31], v[24:27], v[188:191], a[16:31]
    s_waitcnt vmcnt(16)
    s_barrier
    s_cmp_lg_u32 s14, 0
    s_cbranch_scc1 parallel_sum__linear_attn_block__dense_activation_relu__prompt_kernel_b_init_ok
    v_mov_b32 v68, 8
    s_mov_b64 exec, 1
    s_waitcnt vmcnt(10)
    v_cmp_ge_u32 vcc, v95, v68
    s_nop 3
    s_cmp_eq_u64 vcc, 1
    s_cbranch_scc1 parallel_sum__linear_attn_block__dense_activation_relu__prompt_kernel_b_init_done
    s_mov_b32 s42, 0
parallel_sum__linear_attn_block__dense_activation_relu__prompt_kernel_b_init_spin:
    buffer_load_dword v95, v1, s[32:35], 0 offen sc0 sc1
    s_waitcnt vmcnt(0)
    v_cmp_ge_u32 vcc, v95, v68
    s_add_u32 s42, s42, 1
    s_cmp_ge_u32 s42, 0x40000
    s_cbranch_scc1 parallel_sum__linear_attn_block__dense_activation_relu__prompt_kernel_b_init_done
    s_nop 0
    s_cmp_eq_u64 vcc, 1
    s_cbranch_scc0 parallel_sum__linear_attn_block__dense_activation_relu__prompt_kernel_b_init_spin
parallel_sum__linear_attn_block__dense_activation_relu__prompt_kernel_b_init_done:
    s_mov_b64 exec, -1
parallel_sum__linear_attn_block__dense_activation_relu__prompt_kernel_b_init_ok:
    ds_read_b64_tr_b16 v[16:17], v14 offset:0
    ds_read_b64_tr_b16 v[18:19], v14 offset:1280
    v_fma_f32 v40, v40, v12, v13
    v_fma_f32 v41, v41, v12, v13
    v_fma_f32 v42, v42, v12, v13
    v_fma_f32 v43, v43, v12, v13
    s_waitcnt lgkmcnt(6)
    v_mfma_f32_32x32x16_bf16 a[32:47], v[28:31], v[188:191], a[32:47]
    ds_read_b64_tr_b16 v[20:21], v14 offset:64
    ds_read_b64_tr_b16 v[22:23], v14 offset:1344
    v_cvt_pk_bf16_f32 v196, v40, v41
    v_cvt_pk_bf16_f32 v197, v42, v43
    v_lshlrev_b32 v40, 16, v198
    v_and_b32 v41, 0xffff0000, v198
    s_add_u32 m0, s18, 65536
    s_waitcnt lgkmcnt(6)
    v_mfma_f32_32x32x16_bf16 a[48:63], v[32:35], v[188:191], a[48:63]
    buffer_load_dwordx4 v7, s[24:27], s55 offen lds
    ds_read_b64_tr_b16 v[24:25], v14 offset:128
    ds_read_b64_tr_b16 v[26:27], v14 offset:1408
    v_lshlrev_b32 v42, 16, v199
    v_and_b32 v43, 0xffff0000, v199
    v_fma_f32 v40, v40, v12, v13
    v_fma_f32 v41, v41, v12, v13
    s_waitcnt lgkmcnt(6)
    v_mfma_f32_32x32x16_bf16 a[64:79], v[36:39], v[188:191], a[64:79]
    ds_read_b64_tr_b16 v[28:29], v14 offset:192
    ds_read_b64_tr_b16 v[30:31], v14 offset:1472
    v_fma_f32 v42, v42, v12, v13
    v_fma_f32 v43, v43, v12, v13
    v_cvt_pk_bf16_f32 v198, v40, v41
    v_cvt_pk_bf16_f32 v199, v42, v43
    s_waitcnt lgkmcnt(6)
    v_mfma_f32_32x32x16_bf16 a[0:15], v[16:19], v[192:195], a[0:15]
    ds_read_b64_tr_b16 v[32:33], v14 offset:256
    ds_read_b64_tr_b16 v[34:35], v14 offset:1536
    v_lshlrev_b32 v40, 16, v200
    v_and_b32 v41, 0xffff0000, v200
    v_lshlrev_b32 v42, 16, v201
    v_and_b32 v43, 0xffff0000, v201
    s_waitcnt lgkmcnt(6)
    v_mfma_f32_32x32x16_bf16 a[16:31], v[20:23], v[192:195], a[16:31]
    ds_read_b64_tr_b16 v[36:37], v14 offset:5120
    ds_read_b64_tr_b16 v[38:39], v14 offset:6400
    v_fma_f32 v40, v40, v12, v13
    v_fma_f32 v41, v41, v12, v13
    v_fma_f32 v42, v42, v12, v13
    v_fma_f32 v43, v43, v12, v13
    s_add_u32 s55, s37, 0
    s_add_u32 m0, s19, 81920
    s_waitcnt lgkmcnt(6)
    v_mfma_f32_32x32x16_bf16 a[32:47], v[24:27], v[192:195], a[32:47]
    buffer_load_dwordx4 v8, s[28:31], s55 offen lds
    ds_read_b64_tr_b16 v[16:17], v14 offset:5184
    ds_read_b64_tr_b16 v[18:19], v14 offset:6464
    v_cvt_pk_bf16_f32 v200, v40, v41
    v_cvt_pk_bf16_f32 v201, v42, v43
    v_lshlrev_b32 v40, 16, v202
    v_and_b32 v41, 0xffff0000, v202
    s_waitcnt lgkmcnt(6)
    v_mfma_f32_32x32x16_bf16 a[48:63], v[28:31], v[192:195], a[48:63]
    ds_read_b64_tr_b16 v[20:21], v14 offset:5248
    ds_read_b64_tr_b16 v[22:23], v14 offset:6528
    v_lshlrev_b32 v42, 16, v203
    v_and_b32 v43, 0xffff0000, v203
    v_fma_f32 v40, v40, v12, v13
    v_fma_f32 v41, v41, v12, v13
    s_waitcnt lgkmcnt(6)
    v_mfma_f32_32x32x16_bf16 a[64:79], v[32:35], v[192:195], a[64:79]
    ds_read_b64_tr_b16 v[24:25], v14 offset:5312
    ds_read_b64_tr_b16 v[26:27], v14 offset:6592
    v_fma_f32 v42, v42, v12, v13
    v_fma_f32 v43, v43, v12, v13
    v_cvt_pk_bf16_f32 v202, v40, v41
    v_cvt_pk_bf16_f32 v203, v42, v43
    s_waitcnt lgkmcnt(6)
    v_mfma_f32_32x32x16_bf16 a[0:15], v[36:39], v[196:199], a[0:15]
    ds_read_b64_tr_b16 v[28:29], v14 offset:5376
    ds_read_b64_tr_b16 v[30:31], v14 offset:6656
    v_lshlrev_b32 v40, 16, v204
    v_and_b32 v41, 0xffff0000, v204
    v_lshlrev_b32 v42, 16, v205
    v_and_b32 v43, 0xffff0000, v205
    s_add_u32 m0, s19, 82944
    s_waitcnt lgkmcnt(6)
    v_mfma_f32_32x32x16_bf16 a[16:31], v[16:19], v[196:199], a[16:31]
    buffer_load_dwordx4 v9, s[28:31], s55 offen lds
    ds_read_b64_tr_b16 v[32:33], v14 offset:10240
    ds_read_b64_tr_b16 v[34:35], v14 offset:11520
    v_fma_f32 v40, v40, v12, v13
    v_fma_f32 v41, v41, v12, v13
    v_fma_f32 v42, v42, v12, v13
    v_fma_f32 v43, v43, v12, v13
    s_waitcnt lgkmcnt(6)
    v_mfma_f32_32x32x16_bf16 a[32:47], v[20:23], v[196:199], a[32:47]
    ds_read_b64_tr_b16 v[36:37], v14 offset:10304
    ds_read_b64_tr_b16 v[38:39], v14 offset:11584
    v_cvt_pk_bf16_f32 v204, v40, v41
    v_cvt_pk_bf16_f32 v205, v42, v43
    v_lshlrev_b32 v40, 16, v206
    v_and_b32 v41, 0xffff0000, v206
    s_waitcnt lgkmcnt(6)
    v_mfma_f32_32x32x16_bf16 a[48:63], v[24:27], v[196:199], a[48:63]
    ds_read_b64_tr_b16 v[16:17], v14 offset:10368
    ds_read_b64_tr_b16 v[18:19], v14 offset:11648
    v_lshlrev_b32 v42, 16, v207
    v_and_b32 v43, 0xffff0000, v207
    v_fma_f32 v40, v40, v12, v13
    v_fma_f32 v41, v41, v12, v13
    s_waitcnt lgkmcnt(6)
    v_mfma_f32_32x32x16_bf16 a[64:79], v[28:31], v[196:199], a[64:79]
    ds_read_b64_tr_b16 v[20:21], v14 offset:10432
    ds_read_b64_tr_b16 v[22:23], v14 offset:11712
    v_fma_f32 v42, v42, v12, v13
    v_fma_f32 v43, v43, v12, v13
    v_cvt_pk_bf16_f32 v206, v40, v41
    v_cvt_pk_bf16_f32 v207, v42, v43
    s_add_u32 m0, s19, 83968
    s_waitcnt lgkmcnt(6)
    v_mfma_f32_32x32x16_bf16 a[0:15], v[32:35], v[200:203], a[0:15]
    buffer_load_dwordx4 v10, s[28:31], s55 offen lds
    ds_read_b64_tr_b16 v[24:25], v14 offset:10496
    ds_read_b64_tr_b16 v[26:27], v14 offset:11776
    s_waitcnt vmcnt(17)
    ds_read_b64_tr_b16 v[48:49], v77 offset:0
    ds_read_b64_tr_b16 v[50:51], v77 offset:2048
    v_lshlrev_b32 v40, 16, v208
    v_and_b32 v41, 0xffff0000, v208
    v_lshlrev_b32 v42, 16, v209
    v_and_b32 v43, 0xffff0000, v209
    s_waitcnt lgkmcnt(8)
    v_mfma_f32_32x32x16_bf16 a[16:31], v[36:39], v[200:203], a[16:31]
    ds_read_b64_tr_b16 v[28:29], v14 offset:15360
    ds_read_b64_tr_b16 v[30:31], v14 offset:16640
    ds_read_b64_tr_b16 v[52:53], v77 offset:32
    ds_read_b64_tr_b16 v[54:55], v77 offset:2080
    v_fma_f32 v40, v40, v12, v13
    v_fma_f32 v41, v41, v12, v13
    v_fma_f32 v42, v42, v12, v13
    v_fma_f32 v43, v43, v12, v13
    s_waitcnt lgkmcnt(10)
    v_mfma_f32_32x32x16_bf16 a[32:47], v[16:19], v[200:203], a[32:47]
    ds_read_b64_tr_b16 v[32:33], v14 offset:15424
    ds_read_b64_tr_b16 v[34:35], v14 offset:16704
    ds_read_b64_tr_b16 v[56:57], v77 offset:64
    ds_read_b64_tr_b16 v[58:59], v77 offset:2112
    v_cvt_pk_bf16_f32 v208, v40, v41
    v_cvt_pk_bf16_f32 v209, v42, v43
    v_lshlrev_b32 v40, 16, v210
    v_and_b32 v41, 0xffff0000, v210
    s_waitcnt lgkmcnt(12)
    v_mfma_f32_32x32x16_bf16 a[48:63], v[20:23], v[200:203], a[48:63]
    ds_read_b64_tr_b16 v[36:37], v14 offset:15488
    ds_read_b64_tr_b16 v[38:39], v14 offset:16768
    ds_read_b64_tr_b16 v[60:61], v77 offset:96
    ds_read_b64_tr_b16 v[62:63], v77 offset:2144
    v_lshlrev_b32 v42, 16, v211
    v_and_b32 v43, 0xffff0000, v211
    v_fma_f32 v40, v40, v12, v13
    v_fma_f32 v41, v41, v12, v13
    s_waitcnt lgkmcnt(14)
    v_mfma_f32_32x32x16_bf16 a[64:79], v[24:27], v[200:203], a[64:79]
    ds_read_b64_tr_b16 v[16:17], v14 offset:15552
    ds_read_b64_tr_b16 v[18:19], v14 offset:16832
    v_fma_f32 v42, v42, v12, v13
    v_fma_f32 v43, v43, v12, v13
    v_cvt_pk_bf16_f32 v210, v40, v41
    v_cvt_pk_bf16_f32 v211, v42, v43
    s_waitcnt lgkmcnt(12)
    v_mfma_f32_32x32x16_bf16 a[0:15], v[28:31], v[204:207], a[0:15]
    ds_read_b64_tr_b16 v[20:21], v14 offset:15616
    ds_read_b64_tr_b16 v[22:23], v14 offset:16896
    v_lshlrev_b32 v40, 16, v212
    v_and_b32 v41, 0xffff0000, v212
    v_lshlrev_b32 v42, 16, v213
    v_and_b32 v43, 0xffff0000, v213
    s_waitcnt lgkmcnt(10)
    v_mfma_f32_32x32x16_bf16 a[16:31], v[32:35], v[204:207], a[16:31]
    s_waitcnt vmcnt(13)
    s_barrier
    ds_read_b64_tr_b16 v[24:25], v14 offset:20480
    ds_read_b64_tr_b16 v[26:27], v14 offset:21760
    v_fma_f32 v40, v40, v12, v13
    v_fma_f32 v41, v41, v12, v13
    v_fma_f32 v42, v42, v12, v13
    v_fma_f32 v43, v43, v12, v13
    s_add_u32 s55, s37, 245760
    s_add_u32 m0, s19, 102400
    s_waitcnt lgkmcnt(8)
    v_mfma_f32_32x32x16_bf16 a[32:47], v[36:39], v[204:207], a[32:47]
    buffer_load_dwordx4 v8, s[28:31], s55 offen lds
    ds_read_b64_tr_b16 v[28:29], v14 offset:20544
    ds_read_b64_tr_b16 v[30:31], v14 offset:21824
    v_cvt_pk_bf16_f32 v212, v40, v41
    v_cvt_pk_bf16_f32 v213, v42, v43
    v_lshlrev_b32 v40, 16, v214
    v_and_b32 v41, 0xffff0000, v214
    s_waitcnt lgkmcnt(6)
    v_mfma_f32_32x32x16_bf16 a[48:63], v[16:19], v[204:207], a[48:63]
    ds_read_b64_tr_b16 v[32:33], v14 offset:20608
    ds_read_b64_tr_b16 v[34:35], v14 offset:21888
    s_mul_i32 s43, s99, 8
    s_add_u32 s43, s43, 0
    s_mul_i32 s47, s43, 52429
    s_lshr_b32 s47, s47, 18
    s_mul_i32 s101, s47, 5
    s_sub_u32 s43, s43, s101
    s_mul_i32 s47, s47, 74
    s_add_u32 s47, s47, s98
    s_mul_i32 s47, s47, 5
    s_add_u32 s47, s47, s43
    s_lshl_b32 s47, s47, 10
    s_add_u32 s47, s47, s100
    s_add_u32 s47, s47, 12320768
    buffer_store_dwordx4 v[48:51], v78, s[20:23], s47 offen sc1
    v_lshlrev_b32 v42, 16, v215
    v_and_b32 v43, 0xffff0000, v215
    v_fma_f32 v40, v40, v12, v13
    v_fma_f32 v41, v41, v12, v13
    s_waitcnt lgkmcnt(6)
    v_mfma_f32_32x32x16_bf16 a[64:79], v[20:23], v[204:207], a[64:79]
    ds_read_b64_tr_b16 v[36:37], v14 offset:20672
    ds_read_b64_tr_b16 v[38:39], v14 offset:21952
    v_fma_f32 v42, v42, v12, v13
    v_fma_f32 v43, v43, v12, v13
    v_cvt_pk_bf16_f32 v214, v40, v41
    v_cvt_pk_bf16_f32 v215, v42, v43
    s_waitcnt lgkmcnt(6)
    v_mfma_f32_32x32x16_bf16 a[0:15], v[24:27], v[208:211], a[0:15]
    ds_read_b64_tr_b16 v[16:17], v14 offset:20736
    ds_read_b64_tr_b16 v[18:19], v14 offset:22016
    v_lshlrev_b32 v40, 16, v216
    v_and_b32 v41, 0xffff0000, v216
    v_lshlrev_b32 v42, 16, v217
    v_and_b32 v43, 0xffff0000, v217
    s_add_u32 m0, s19, 103424
    s_waitcnt lgkmcnt(6)
    v_mfma_f32_32x32x16_bf16 a[16:31], v[28:31], v[208:211], a[16:31]
    buffer_load_dwordx4 v9, s[28:31], s55 offen lds
    ds_read_b64_tr_b16 v[20:21], v14 offset:25600
    ds_read_b64_tr_b16 v[22:23], v14 offset:26880
    v_fma_f32 v40, v40, v12, v13
    v_fma_f32 v41, v41, v12, v13
    v_fma_f32 v42, v42, v12, v13
    v_fma_f32 v43, v43, v12, v13
    s_waitcnt lgkmcnt(6)
    v_mfma_f32_32x32x16_bf16 a[32:47], v[32:35], v[208:211], a[32:47]
    ds_read_b64_tr_b16 v[24:25], v14 offset:25664
    ds_read_b64_tr_b16 v[26:27], v14 offset:26944
    s_mul_i32 s43, s99, 8
    s_add_u32 s43, s43, 1
    s_mul_i32 s47, s43, 52429
    s_lshr_b32 s47, s47, 18
    s_mul_i32 s101, s47, 5
    s_sub_u32 s43, s43, s101
    s_mul_i32 s47, s47, 74
    s_add_u32 s47, s47, s98
    s_mul_i32 s47, s47, 5
    s_add_u32 s47, s47, s43
    s_lshl_b32 s47, s47, 10
    s_add_u32 s47, s47, s100
    s_add_u32 s47, s47, 12320768
    buffer_store_dwordx4 v[52:55], v78, s[20:23], s47 offen sc1
    v_cvt_pk_bf16_f32 v216, v40, v41
    v_cvt_pk_bf16_f32 v217, v42, v43
    v_lshlrev_b32 v40, 16, v218
    v_and_b32 v41, 0xffff0000, v218
    s_waitcnt lgkmcnt(6)
    v_mfma_f32_32x32x16_bf16 a[48:63], v[36:39], v[208:211], a[48:63]
    ds_read_b64_tr_b16 v[28:29], v14 offset:25728
    ds_read_b64_tr_b16 v[30:31], v14 offset:27008
    v_lshlrev_b32 v42, 16, v219
    v_and_b32 v43, 0xffff0000, v219
    v_fma_f32 v40, v40, v12, v13
    v_fma_f32 v41, v41, v12, v13
    s_waitcnt lgkmcnt(6)
    v_mfma_f32_32x32x16_bf16 a[64:79], v[16:19], v[208:211], a[64:79]
    ds_read_b64_tr_b16 v[32:33], v14 offset:25792
    ds_read_b64_tr_b16 v[34:35], v14 offset:27072
    v_fma_f32 v42, v42, v12, v13
    v_fma_f32 v43, v43, v12, v13
    v_cvt_pk_bf16_f32 v218, v40, v41
    v_cvt_pk_bf16_f32 v219, v42, v43
    s_add_u32 m0, s19, 104448
    s_waitcnt lgkmcnt(6)
    v_mfma_f32_32x32x16_bf16 a[0:15], v[20:23], v[212:215], a[0:15]
    buffer_load_dwordx4 v10, s[28:31], s55 offen lds
    ds_read_b64_tr_b16 v[36:37], v14 offset:25856
    ds_read_b64_tr_b16 v[38:39], v14 offset:27136
    v_lshlrev_b32 v40, 16, v220
    v_and_b32 v41, 0xffff0000, v220
    v_lshlrev_b32 v42, 16, v221
    v_and_b32 v43, 0xffff0000, v221
    s_waitcnt lgkmcnt(6)
    v_mfma_f32_32x32x16_bf16 a[16:31], v[24:27], v[212:215], a[16:31]
    ds_read_b64_tr_b16 v[16:17], v14 offset:30720
    ds_read_b64_tr_b16 v[18:19], v14 offset:32000
    s_mul_i32 s43, s99, 8
    s_add_u32 s43, s43, 2
    s_mul_i32 s47, s43, 52429
    s_lshr_b32 s47, s47, 18
    s_mul_i32 s101, s47, 5
    s_sub_u32 s43, s43, s101
    s_mul_i32 s47, s47, 74
    s_add_u32 s47, s47, s98
    s_mul_i32 s47, s47, 5
    s_add_u32 s47, s47, s43
    s_lshl_b32 s47, s47, 10
    s_add_u32 s47, s47, s100
    s_add_u32 s47, s47, 12320768
    buffer_store_dwordx4 v[56:59], v78, s[20:23], s47 offen sc1
    v_fma_f32 v40, v40, v12, v13
    v_fma_f32 v41, v41, v12, v13
    v_fma_f32 v42, v42, v12, v13
    v_fma_f32 v43, v43, v12, v13
    s_waitcnt lgkmcnt(6)
    v_mfma_f32_32x32x16_bf16 a[32:47], v[28:31], v[212:215], a[32:47]
    ds_read_b64_tr_b16 v[20:21], v14 offset:30784
    ds_read_b64_tr_b16 v[22:23], v14 offset:32064
    v_cvt_pk_bf16_f32 v220, v40, v41
    v_cvt_pk_bf16_f32 v221, v42, v43
    v_lshlrev_b32 v40, 16, v222
    v_and_b32 v41, 0xffff0000, v222
    s_waitcnt lgkmcnt(6)
    v_mfma_f32_32x32x16_bf16 a[48:63], v[32:35], v[212:215], a[48:63]
    ds_read_b64_tr_b16 v[24:25], v14 offset:30848
    ds_read_b64_tr_b16 v[26:27], v14 offset:32128
    v_lshlrev_b32 v42, 16, v223
    v_and_b32 v43, 0xffff0000, v223
    v_fma_f32 v40, v40, v12, v13
    v_fma_f32 v41, v41, v12, v13
    s_waitcnt lgkmcnt(6)
    v_mfma_f32_32x32x16_bf16 a[64:79], v[36:39], v[212:215], a[64:79]
    ds_read_b64_tr_b16 v[28:29], v14 offset:30912
    ds_read_b64_tr_b16 v[30:31], v14 offset:32192
    v_fma_f32 v42, v42, v12, v13
    v_fma_f32 v43, v43, v12, v13
    v_cvt_pk_bf16_f32 v222, v40, v41
    v_cvt_pk_bf16_f32 v223, v42, v43
    s_waitcnt lgkmcnt(6)
    v_mfma_f32_32x32x16_bf16 a[0:15], v[16:19], v[216:219], a[0:15]
    ds_read_b64_tr_b16 v[32:33], v14 offset:30976
    ds_read_b64_tr_b16 v[34:35], v14 offset:32256
    s_mul_i32 s43, s99, 8
    s_add_u32 s43, s43, 3
    s_mul_i32 s47, s43, 52429
    s_lshr_b32 s47, s47, 18
    s_mul_i32 s101, s47, 5
    s_sub_u32 s43, s43, s101
    s_mul_i32 s47, s47, 74
    s_add_u32 s47, s47, s98
    s_mul_i32 s47, s47, 5
    s_add_u32 s47, s47, s43
    s_lshl_b32 s47, s47, 10
    s_add_u32 s47, s47, s100
    s_add_u32 s47, s47, 12320768
    buffer_store_dwordx4 v[60:63], v78, s[20:23], s47 offen sc1
    v_lshlrev_b32 v40, 16, v224
    v_and_b32 v41, 0xffff0000, v224
    v_lshlrev_b32 v42, 16, v225
    v_and_b32 v43, 0xffff0000, v225
    s_waitcnt lgkmcnt(6)
    v_mfma_f32_32x32x16_bf16 a[16:31], v[20:23], v[216:219], a[16:31]
    ds_read_b64_tr_b16 v[36:37], v14 offset:35840
    ds_read_b64_tr_b16 v[38:39], v14 offset:37120
    v_fma_f32 v40, v40, v12, v13
    v_fma_f32 v41, v41, v12, v13
    v_fma_f32 v42, v42, v12, v13
    v_fma_f32 v43, v43, v12, v13
    s_waitcnt lgkmcnt(6)
    v_mfma_f32_32x32x16_bf16 a[32:47], v[24:27], v[216:219], a[32:47]
    ds_read_b64_tr_b16 v[16:17], v14 offset:35904
    ds_read_b64_tr_b16 v[18:19], v14 offset:37184
    v_cvt_pk_bf16_f32 v224, v40, v41
    v_cvt_pk_bf16_f32 v225, v42, v43
    v_lshlrev_b32 v40, 16, v226
    v_and_b32 v41, 0xffff0000, v226
    s_waitcnt lgkmcnt(6)
    v_mfma_f32_32x32x16_bf16 a[48:63], v[28:31], v[216:219], a[48:63]
    ds_read_b64_tr_b16 v[20:21], v14 offset:35968
    ds_read_b64_tr_b16 v[22:23], v14 offset:37248
    v_lshlrev_b32 v42, 16, v227
    v_and_b32 v43, 0xffff0000, v227
    v_fma_f32 v40, v40, v12, v13
    v_fma_f32 v41, v41, v12, v13
    s_waitcnt lgkmcnt(6)
    v_mfma_f32_32x32x16_bf16 a[64:79], v[32:35], v[216:219], a[64:79]
    ds_read_b64_tr_b16 v[24:25], v14 offset:36032
    ds_read_b64_tr_b16 v[26:27], v14 offset:37312
    v_fma_f32 v42, v42, v12, v13
    v_fma_f32 v43, v43, v12, v13
    v_cvt_pk_bf16_f32 v226, v40, v41
    v_cvt_pk_bf16_f32 v227, v42, v43
    s_waitcnt lgkmcnt(6)
    v_mfma_f32_32x32x16_bf16 a[0:15], v[36:39], v[220:223], a[0:15]
    ds_read_b64_tr_b16 v[28:29], v14 offset:36096
    ds_read_b64_tr_b16 v[30:31], v14 offset:37376
    v_lshlrev_b32 v40, 16, v228
    v_and_b32 v41, 0xffff0000, v228
    v_lshlrev_b32 v42, 16, v229
    v_and_b32 v43, 0xffff0000, v229
    s_waitcnt lgkmcnt(6)
    v_mfma_f32_32x32x16_bf16 a[16:31], v[16:19], v[220:223], a[16:31]
    s_waitcnt vmcnt(15)
    s_barrier
    ds_read_b64_tr_b16 v[32:33], v14 offset:40960
    ds_read_b64_tr_b16 v[34:35], v14 offset:42240
    ds_read_b64_tr_b16 v[48:49], v77 offset:128
    ds_read_b64_tr_b16 v[50:51], v77 offset:2176
    v_fma_f32 v40, v40, v12, v13
    v_fma_f32 v41, v41, v12, v13
    v_fma_f32 v42, v42, v12, v13
    v_fma_f32 v43, v43, v12, v13
    s_add_u32 s55, s37, 491520
    s_add_u32 m0, s19, 0
    s_waitcnt lgkmcnt(8)
    v_mfma_f32_32x32x16_bf16 a[32:47], v[20:23], v[220:223], a[32:47]
    buffer_load_dwordx4 v8, s[28:31], s55 offen lds
    ds_read_b64_tr_b16 v[36:37], v14 offset:41024
    ds_read_b64_tr_b16 v[38:39], v14 offset:42304
    ds_read_b64_tr_b16 v[52:53], v77 offset:160
    ds_read_b64_tr_b16 v[54:55], v77 offset:2208
    v_cvt_pk_bf16_f32 v228, v40, v41
    v_cvt_pk_bf16_f32 v229, v42, v43
    v_lshlrev_b32 v40, 16, v230
    v_and_b32 v41, 0xffff0000, v230
    s_waitcnt lgkmcnt(10)
    v_mfma_f32_32x32x16_bf16 a[48:63], v[24:27], v[220:223], a[48:63]
    ds_read_b64_tr_b16 v[16:17], v14 offset:41088
    ds_read_b64_tr_b16 v[18:19], v14 offset:42368
    ds_read_b64_tr_b16 v[56:57], v77 offset:192
    ds_read_b64_tr_b16 v[58:59], v77 offset:2240
    v_lshlrev_b32 v42, 16, v231
    v_and_b32 v43, 0xffff0000, v231
    v_fma_f32 v40, v40, v12, v13
    v_fma_f32 v41, v41, v12, v13
    s_waitcnt lgkmcnt(12)
    v_mfma_f32_32x32x16_bf16 a[64:79], v[28:31], v[220:223], a[64:79]
    ds_read_b64_tr_b16 v[20:21], v14 offset:41152
    ds_read_b64_tr_b16 v[22:23], v14 offset:42432
    ds_read_b64_tr_b16 v[60:61], v77 offset:224
    ds_read_b64_tr_b16 v[62:63], v77 offset:2272
    v_fma_f32 v42, v42, v12, v13
    v_fma_f32 v43, v43, v12, v13
    v_cvt_pk_bf16_f32 v230, v40, v41
    v_cvt_pk_bf16_f32 v231, v42, v43
    s_waitcnt lgkmcnt(14)
    v_mfma_f32_32x32x16_bf16 a[0:15], v[32:35], v[224:227], a[0:15]
    ds_read_b64_tr_b16 v[24:25], v14 offset:41216
    ds_read_b64_tr_b16 v[26:27], v14 offset:42496
    v_lshlrev_b32 v40, 16, v232
    v_and_b32 v41, 0xffff0000, v232
    v_lshlrev_b32 v42, 16, v233
    v_and_b32 v43, 0xffff0000, v233
    s_add_u32 m0, s19, 1024
    s_waitcnt lgkmcnt(12)
    v_mfma_f32_32x32x16_bf16 a[16:31], v[36:39], v[224:227], a[16:31]
    buffer_load_dwordx4 v9, s[28:31], s55 offen lds
    ds_read_b64_tr_b16 v[28:29], v14 offset:46080
    ds_read_b64_tr_b16 v[30:31], v14 offset:47360
    v_fma_f32 v40, v40, v12, v13
    v_fma_f32 v41, v41, v12, v13
    v_fma_f32 v42, v42, v12, v13
    v_fma_f32 v43, v43, v12, v13
    s_waitcnt lgkmcnt(10)
    v_mfma_f32_32x32x16_bf16 a[32:47], v[16:19], v[224:227], a[32:47]
    ds_read_b64_tr_b16 v[32:33], v14 offset:46144
    ds_read_b64_tr_b16 v[34:35], v14 offset:47424
    s_mul_i32 s43, s99, 8
    s_add_u32 s43, s43, 4
    s_mul_i32 s47, s43, 52429
    s_lshr_b32 s47, s47, 18
    s_mul_i32 s101, s47, 5
    s_sub_u32 s43, s43, s101
    s_mul_i32 s47, s47, 74
    s_add_u32 s47, s47, s98
    s_mul_i32 s47, s47, 5
    s_add_u32 s47, s47, s43
    s_lshl_b32 s47, s47, 10
    s_add_u32 s47, s47, s100
    s_add_u32 s47, s47, 12320768
    buffer_store_dwordx4 v[48:51], v78, s[20:23], s47 offen sc1
    v_cvt_pk_bf16_f32 v232, v40, v41
    v_cvt_pk_bf16_f32 v233, v42, v43
    v_lshlrev_b32 v40, 16, v234
    v_and_b32 v41, 0xffff0000, v234
    s_waitcnt lgkmcnt(8)
    v_mfma_f32_32x32x16_bf16 a[48:63], v[20:23], v[224:227], a[48:63]
    ds_read_b64_tr_b16 v[36:37], v14 offset:46208
    ds_read_b64_tr_b16 v[38:39], v14 offset:47488
    v_lshlrev_b32 v42, 16, v235
    v_and_b32 v43, 0xffff0000, v235
    v_fma_f32 v40, v40, v12, v13
    v_fma_f32 v41, v41, v12, v13
    s_waitcnt lgkmcnt(6)
    v_mfma_f32_32x32x16_bf16 a[64:79], v[24:27], v[224:227], a[64:79]
    ds_read_b64_tr_b16 v[16:17], v14 offset:46272
    ds_read_b64_tr_b16 v[18:19], v14 offset:47552
    v_fma_f32 v42, v42, v12, v13
    v_fma_f32 v43, v43, v12, v13
    v_cvt_pk_bf16_f32 v234, v40, v41
    v_cvt_pk_bf16_f32 v235, v42, v43
    s_add_u32 m0, s19, 2048
    s_waitcnt lgkmcnt(6)
    v_mfma_f32_32x32x16_bf16 a[0:15], v[28:31], v[228:231], a[0:15]
    buffer_load_dwordx4 v10, s[28:31], s55 offen lds
    ds_read_b64_tr_b16 v[20:21], v14 offset:46336
    ds_read_b64_tr_b16 v[22:23], v14 offset:47616
    v_lshlrev_b32 v40, 16, v236
    v_and_b32 v41, 0xffff0000, v236
    v_lshlrev_b32 v42, 16, v237
    v_and_b32 v43, 0xffff0000, v237
    s_waitcnt lgkmcnt(6)
    v_mfma_f32_32x32x16_bf16 a[16:31], v[32:35], v[228:231], a[16:31]
    ds_read_b64_tr_b16 v[24:25], v14 offset:51200
    ds_read_b64_tr_b16 v[26:27], v14 offset:52480
    s_mul_i32 s43, s99, 8
    s_add_u32 s43, s43, 5
    s_mul_i32 s47, s43, 52429
    s_lshr_b32 s47, s47, 18
    s_mul_i32 s101, s47, 5
    s_sub_u32 s43, s43, s101
    s_mul_i32 s47, s47, 74
    s_add_u32 s47, s47, s98
    s_mul_i32 s47, s47, 5
    s_add_u32 s47, s47, s43
    s_lshl_b32 s47, s47, 10
    s_add_u32 s47, s47, s100
    s_add_u32 s47, s47, 12320768
    buffer_store_dwordx4 v[52:55], v78, s[20:23], s47 offen sc1
    v_fma_f32 v40, v40, v12, v13
    v_fma_f32 v41, v41, v12, v13
    v_fma_f32 v42, v42, v12, v13
    v_fma_f32 v43, v43, v12, v13
    s_waitcnt lgkmcnt(6)
    v_mfma_f32_32x32x16_bf16 a[32:47], v[36:39], v[228:231], a[32:47]
    ds_read_b64_tr_b16 v[28:29], v14 offset:51264
    ds_read_b64_tr_b16 v[30:31], v14 offset:52544
    v_cvt_pk_bf16_f32 v236, v40, v41
    v_cvt_pk_bf16_f32 v237, v42, v43
    v_lshlrev_b32 v40, 16, v238
    v_and_b32 v41, 0xffff0000, v238
    s_waitcnt lgkmcnt(6)
    v_mfma_f32_32x32x16_bf16 a[48:63], v[16:19], v[228:231], a[48:63]
    ds_read_b64_tr_b16 v[32:33], v14 offset:51328
    ds_read_b64_tr_b16 v[34:35], v14 offset:52608
    v_lshlrev_b32 v42, 16, v239
    v_and_b32 v43, 0xffff0000, v239
    v_fma_f32 v40, v40, v12, v13
    v_fma_f32 v41, v41, v12, v13
    s_waitcnt lgkmcnt(6)
    v_mfma_f32_32x32x16_bf16 a[64:79], v[20:23], v[228:231], a[64:79]
    ds_read_b64_tr_b16 v[36:37], v14 offset:51392
    ds_read_b64_tr_b16 v[38:39], v14 offset:52672
    v_fma_f32 v42, v42, v12, v13
    v_fma_f32 v43, v43, v12, v13
    v_cvt_pk_bf16_f32 v238, v40, v41
    v_cvt_pk_bf16_f32 v239, v42, v43
    s_waitcnt lgkmcnt(6)
    v_mfma_f32_32x32x16_bf16 a[0:15], v[24:27], v[232:235], a[0:15]
    ds_read_b64_tr_b16 v[16:17], v14 offset:51456
    ds_read_b64_tr_b16 v[18:19], v14 offset:52736
    s_mul_i32 s43, s99, 8
    s_add_u32 s43, s43, 6
    s_mul_i32 s47, s43, 52429
    s_lshr_b32 s47, s47, 18
    s_mul_i32 s101, s47, 5
    s_sub_u32 s43, s43, s101
    s_mul_i32 s47, s47, 74
    s_add_u32 s47, s47, s98
    s_mul_i32 s47, s47, 5
    s_add_u32 s47, s47, s43
    s_lshl_b32 s47, s47, 10
    s_add_u32 s47, s47, s100
    s_add_u32 s47, s47, 12320768
    buffer_store_dwordx4 v[56:59], v78, s[20:23], s47 offen sc1
    v_lshlrev_b32 v40, 16, v240
    v_and_b32 v41, 0xffff0000, v240
    v_lshlrev_b32 v42, 16, v241
    v_and_b32 v43, 0xffff0000, v241
    s_waitcnt lgkmcnt(6)
    v_mfma_f32_32x32x16_bf16 a[16:31], v[28:31], v[232:235], a[16:31]
    ds_read_b64_tr_b16 v[20:21], v14 offset:56320
    ds_read_b64_tr_b16 v[22:23], v14 offset:57600
    v_fma_f32 v40, v40, v12, v13
    v_fma_f32 v41, v41, v12, v13
    v_fma_f32 v42, v42, v12, v13
    v_fma_f32 v43, v43, v12, v13
    s_waitcnt lgkmcnt(6)
    v_mfma_f32_32x32x16_bf16 a[32:47], v[32:35], v[232:235], a[32:47]
    ds_read_b64_tr_b16 v[24:25], v14 offset:56384
    ds_read_b64_tr_b16 v[26:27], v14 offset:57664
    v_cvt_pk_bf16_f32 v240, v40, v41
    v_cvt_pk_bf16_f32 v241, v42, v43
    v_lshlrev_b32 v40, 16, v242
    v_and_b32 v41, 0xffff0000, v242
    s_waitcnt lgkmcnt(6)
    v_mfma_f32_32x32x16_bf16 a[48:63], v[36:39], v[232:235], a[48:63]
    ds_read_b64_tr_b16 v[28:29], v14 offset:56448
    ds_read_b64_tr_b16 v[30:31], v14 offset:57728
    v_lshlrev_b32 v42, 16, v243
    v_and_b32 v43, 0xffff0000, v243
    v_fma_f32 v40, v40, v12, v13
    v_fma_f32 v41, v41, v12, v13
    s_waitcnt lgkmcnt(6)
    v_mfma_f32_32x32x16_bf16 a[64:79], v[16:19], v[232:235], a[64:79]
    ds_read_b64_tr_b16 v[32:33], v14 offset:56512
    ds_read_b64_tr_b16 v[34:35], v14 offset:57792
    s_mul_i32 s43, s99, 8
    s_add_u32 s43, s43, 7
    s_mul_i32 s47, s43, 52429
    s_lshr_b32 s47, s47, 18
    s_mul_i32 s101, s47, 5
    s_sub_u32 s43, s43, s101
    s_mul_i32 s47, s47, 74
    s_add_u32 s47, s47, s98
    s_mul_i32 s47, s47, 5
    s_add_u32 s47, s47, s43
    s_lshl_b32 s47, s47, 10
    s_add_u32 s47, s47, s100
    s_add_u32 s47, s47, 12320768
    buffer_store_dwordx4 v[60:63], v78, s[20:23], s47 offen sc1
    v_fma_f32 v42, v42, v12, v13
    v_fma_f32 v43, v43, v12, v13
    v_cvt_pk_bf16_f32 v242, v40, v41
    v_cvt_pk_bf16_f32 v243, v42, v43
    s_waitcnt lgkmcnt(6)
    v_mfma_f32_32x32x16_bf16 a[0:15], v[20:23], v[236:239], a[0:15]
    ds_read_b64_tr_b16 v[36:37], v14 offset:56576
    ds_read_b64_tr_b16 v[38:39], v14 offset:57856
    v_lshlrev_b32 v40, 16, v244
    v_and_b32 v41, 0xffff0000, v244
    v_lshlrev_b32 v42, 16, v245
    v_and_b32 v43, 0xffff0000, v245
    s_waitcnt lgkmcnt(6)
    v_mfma_f32_32x32x16_bf16 a[16:31], v[24:27], v[236:239], a[16:31]
    s_waitcnt vmcnt(17)
    s_barrier
    ds_read_b64_tr_b16 v[16:17], v15 offset:0
    ds_read_b64_tr_b16 v[18:19], v15 offset:1280
    v_fma_f32 v40, v40, v12, v13
    v_fma_f32 v41, v41, v12, v13
    v_fma_f32 v42, v42, v12, v13
    v_fma_f32 v43, v43, v12, v13
    s_add_u32 s55, s37, 737280
    s_add_u32 m0, s19, 20480
    s_waitcnt lgkmcnt(6)
    v_mfma_f32_32x32x16_bf16 a[32:47], v[28:31], v[236:239], a[32:47]
    buffer_load_dwordx4 v8, s[28:31], s55 offen lds
    ds_read_b64_tr_b16 v[20:21], v15 offset:64
    ds_read_b64_tr_b16 v[22:23], v15 offset:1344
    v_cvt_pk_bf16_f32 v244, v40, v41
    v_cvt_pk_bf16_f32 v245, v42, v43
    v_lshlrev_b32 v40, 16, v246
    v_and_b32 v41, 0xffff0000, v246
    s_waitcnt lgkmcnt(6)
    v_mfma_f32_32x32x16_bf16 a[48:63], v[32:35], v[236:239], a[48:63]
    ds_read_b64_tr_b16 v[24:25], v15 offset:128
    ds_read_b64_tr_b16 v[26:27], v15 offset:1408
    v_lshlrev_b32 v42, 16, v247
    v_and_b32 v43, 0xffff0000, v247
    v_fma_f32 v40, v40, v12, v13
    v_fma_f32 v41, v41, v12, v13
    s_waitcnt lgkmcnt(6)
    v_mfma_f32_32x32x16_bf16 a[64:79], v[36:39], v[236:239], a[64:79]
    ds_read_b64_tr_b16 v[28:29], v15 offset:192
    ds_read_b64_tr_b16 v[30:31], v15 offset:1472
    v_fma_f32 v42, v42, v12, v13
    v_fma_f32 v43, v43, v12, v13
    v_cvt_pk_bf16_f32 v246, v40, v41
    v_cvt_pk_bf16_f32 v247, v42, v43
    s_waitcnt lgkmcnt(6)
    v_mfma_f32_32x32x16_bf16 a[0:15], v[16:19], v[240:243], a[0:15]
    ds_read_b64_tr_b16 v[32:33], v15 offset:256
    ds_read_b64_tr_b16 v[34:35], v15 offset:1536
    v_lshlrev_b32 v40, 16, v248
    v_and_b32 v41, 0xffff0000, v248
    v_lshlrev_b32 v42, 16, v249
    v_and_b32 v43, 0xffff0000, v249
    s_add_u32 m0, s19, 21504
    s_waitcnt lgkmcnt(6)
    v_mfma_f32_32x32x16_bf16 a[16:31], v[20:23], v[240:243], a[16:31]
    buffer_load_dwordx4 v9, s[28:31], s55 offen lds
    ds_read_b64_tr_b16 v[36:37], v15 offset:5120
    ds_read_b64_tr_b16 v[38:39], v15 offset:6400
    v_fma_f32 v40, v40, v12, v13
    v_fma_f32 v41, v41, v12, v13
    v_fma_f32 v42, v42, v12, v13
    v_fma_f32 v43, v43, v12, v13
    s_waitcnt lgkmcnt(6)
    v_mfma_f32_32x32x16_bf16 a[32:47], v[24:27], v[240:243], a[32:47]
    ds_read_b64_tr_b16 v[16:17], v15 offset:5184
    ds_read_b64_tr_b16 v[18:19], v15 offset:6464
    v_cvt_pk_bf16_f32 v248, v40, v41
    v_cvt_pk_bf16_f32 v249, v42, v43
    v_lshlrev_b32 v40, 16, v250
    v_and_b32 v41, 0xffff0000, v250
    s_waitcnt lgkmcnt(6)
    v_mfma_f32_32x32x16_bf16 a[48:63], v[28:31], v[240:243], a[48:63]
    ds_read_b64_tr_b16 v[20:21], v15 offset:5248
    ds_read_b64_tr_b16 v[22:23], v15 offset:6528
    v_lshlrev_b32 v42, 16, v251
    v_and_b32 v43, 0xffff0000, v251
    v_fma_f32 v40, v40, v12, v13
    v_fma_f32 v41, v41, v12, v13
    s_waitcnt lgkmcnt(6)
    v_mfma_f32_32x32x16_bf16 a[64:79], v[32:35], v[240:243], a[64:79]
    ds_read_b64_tr_b16 v[24:25], v15 offset:5312
    ds_read_b64_tr_b16 v[26:27], v15 offset:6592
    v_fma_f32 v42, v42, v12, v13
    v_fma_f32 v43, v43, v12, v13
    v_cvt_pk_bf16_f32 v250, v40, v41
    v_cvt_pk_bf16_f32 v251, v42, v43
    s_add_u32 m0, s19, 22528
    s_waitcnt lgkmcnt(6)
    v_mfma_f32_32x32x16_bf16 a[0:15], v[36:39], v[244:247], a[0:15]
    buffer_load_dwordx4 v10, s[28:31], s55 offen lds
    ds_read_b64_tr_b16 v[28:29], v15 offset:5376
    ds_read_b64_tr_b16 v[30:31], v15 offset:6656
    v_lshlrev_b32 v40, 16, v252
    v_and_b32 v41, 0xffff0000, v252
    v_lshlrev_b32 v42, 16, v253
    v_and_b32 v43, 0xffff0000, v253
    s_waitcnt lgkmcnt(6)
    v_mfma_f32_32x32x16_bf16 a[16:31], v[16:19], v[244:247], a[16:31]
    ds_read_b64_tr_b16 v[32:33], v15 offset:10240
    ds_read_b64_tr_b16 v[34:35], v15 offset:11520
    v_fma_f32 v40, v40, v12, v13
    v_fma_f32 v41, v41, v12, v13
    v_fma_f32 v42, v42, v12, v13
    v_fma_f32 v43, v43, v12, v13
    s_waitcnt lgkmcnt(6)
    v_mfma_f32_32x32x16_bf16 a[32:47], v[20:23], v[244:247], a[32:47]
    ds_read_b64_tr_b16 v[36:37], v15 offset:10304
    ds_read_b64_tr_b16 v[38:39], v15 offset:11584
    v_cvt_pk_bf16_f32 v252, v40, v41
    v_cvt_pk_bf16_f32 v253, v42, v43
    v_lshlrev_b32 v40, 16, v254
    v_and_b32 v41, 0xffff0000, v254
    s_waitcnt lgkmcnt(6)
    v_mfma_f32_32x32x16_bf16 a[48:63], v[24:27], v[244:247], a[48:63]
    ds_read_b64_tr_b16 v[16:17], v15 offset:10368
    ds_read_b64_tr_b16 v[18:19], v15 offset:11648
    v_lshlrev_b32 v42, 16, v255
    v_and_b32 v43, 0xffff0000, v255
    v_fma_f32 v40, v40, v12, v13
    v_fma_f32 v41, v41, v12, v13
    s_waitcnt lgkmcnt(6)
    v_mfma_f32_32x32x16_bf16 a[64:79], v[28:31], v[244:247], a[64:79]
    ds_read_b64_tr_b16 v[20:21], v15 offset:10432
    ds_read_b64_tr_b16 v[22:23], v15 offset:11712
    v_fma_f32 v42, v42, v12, v13
    v_fma_f32 v43, v43, v12, v13
    v_cvt_pk_bf16_f32 v254, v40, v41
    v_cvt_pk_bf16_f32 v255, v42, v43
    s_waitcnt lgkmcnt(6)
    v_mfma_f32_32x32x16_bf16 a[0:15], v[32:35], v[248:251], a[0:15]
    ds_read_b64_tr_b16 v[24:25], v15 offset:10496
    ds_read_b64_tr_b16 v[26:27], v15 offset:11776
    s_waitcnt lgkmcnt(6)
    v_mfma_f32_32x32x16_bf16 a[16:31], v[36:39], v[248:251], a[16:31]
    ds_read_b64_tr_b16 v[28:29], v15 offset:15360
    ds_read_b64_tr_b16 v[30:31], v15 offset:16640
    s_waitcnt lgkmcnt(6)
    v_mfma_f32_32x32x16_bf16 a[32:47], v[16:19], v[248:251], a[32:47]
    ds_read_b64_tr_b16 v[32:33], v15 offset:15424
    ds_read_b64_tr_b16 v[34:35], v15 offset:16704
    s_waitcnt lgkmcnt(6)
    v_mfma_f32_32x32x16_bf16 a[48:63], v[20:23], v[248:251], a[48:63]
    ds_read_b64_tr_b16 v[36:37], v15 offset:15488
    ds_read_b64_tr_b16 v[38:39], v15 offset:16768
    s_waitcnt lgkmcnt(6)
    v_mfma_f32_32x32x16_bf16 a[64:79], v[24:27], v[248:251], a[64:79]
    ds_read_b64_tr_b16 v[16:17], v15 offset:15552
    ds_read_b64_tr_b16 v[18:19], v15 offset:16832
    s_waitcnt lgkmcnt(6)
    v_mfma_f32_32x32x16_bf16 a[0:15], v[28:31], v[252:255], a[0:15]
    ds_read_b64_tr_b16 v[20:21], v15 offset:15616
    ds_read_b64_tr_b16 v[22:23], v15 offset:16896
    s_waitcnt lgkmcnt(6)
    v_mfma_f32_32x32x16_bf16 a[16:31], v[32:35], v[252:255], a[16:31]
    s_waitcnt vmcnt(17)
    s_waitcnt vmcnt(3)
    s_barrier
    s_cmp_lg_u32 s14, 0
    s_cbranch_scc1 parallel_sum__linear_attn_block__dense_activation_relu__prompt_kernel_b_w2_sig
    v_mov_b32 v44, 1
    s_and_b32 s40, s2, 7
    s_lshl_b32 s40, s40, 7
    s_add_u32 s40, s40, 15571968
    v_mov_b32 v45, s40
    s_mov_b64 exec, 1
    buffer_atomic_add v44, v45, s[20:23], 0 offen
    s_mov_b64 exec, -1
parallel_sum__linear_attn_block__dense_activation_relu__prompt_kernel_b_w2_sig:
    ds_read_b64_tr_b16 v[24:25], v89 offset:20480
    ds_read_b64_tr_b16 v[26:27], v89 offset:21248
    s_add_u32 s55, s37, 983040
    s_add_u32 m0, s19, 40960
    s_waitcnt lgkmcnt(6)
    v_mfma_f32_32x32x16_bf16 a[32:47], v[36:39], v[252:255], a[32:47]
    buffer_load_dwordx4 v8, s[28:31], s55 offen lds
    ds_read_b64_tr_b16 v[28:29], v89 offset:20544
    ds_read_b64_tr_b16 v[30:31], v89 offset:21312
    s_waitcnt lgkmcnt(6)
    v_mfma_f32_32x32x16_bf16 a[48:63], v[16:19], v[252:255], a[48:63]
    ds_read_b64_tr_b16 v[32:33], v89 offset:20608
    ds_read_b64_tr_b16 v[34:35], v89 offset:21376
    s_waitcnt lgkmcnt(6)
    v_mfma_f32_32x32x16_bf16 a[64:79], v[20:23], v[252:255], a[64:79]
    ds_read_b64_tr_b16 v[36:37], v89 offset:23552
    ds_read_b64_tr_b16 v[38:39], v89 offset:24320
    s_waitcnt lgkmcnt(6)
    v_mfma_f32_32x32x16_bf16 a[80:95], v[24:27], v[96:99], 0
    ds_read_b64_tr_b16 v[16:17], v89 offset:23616
    ds_read_b64_tr_b16 v[18:19], v89 offset:24384
    s_add_u32 m0, s19, 41984
    s_waitcnt lgkmcnt(6)
    v_mfma_f32_32x32x16_bf16 a[96:111], v[28:31], v[96:99], 0
    buffer_load_dwordx4 v9, s[28:31], s55 offen lds
    ds_read_b64_tr_b16 v[20:21], v89 offset:23680
    ds_read_b64_tr_b16 v[22:23], v89 offset:24448
    s_waitcnt lgkmcnt(6)
    v_mfma_f32_32x32x16_bf16 a[112:127], v[32:35], v[96:99], 0
    ds_read_b64_tr_b16 v[24:25], v89 offset:26624
    ds_read_b64_tr_b16 v[26:27], v89 offset:27392
    s_waitcnt lgkmcnt(6)
    v_mfma_f32_32x32x16_bf16 a[80:95], v[36:39], v[100:103], a[80:95]
    ds_read_b64_tr_b16 v[28:29], v89 offset:26688
    ds_read_b64_tr_b16 v[30:31], v89 offset:27456
    s_waitcnt lgkmcnt(6)
    v_mfma_f32_32x32x16_bf16 a[96:111], v[16:19], v[100:103], a[96:111]
    ds_read_b64_tr_b16 v[32:33], v89 offset:26752
    ds_read_b64_tr_b16 v[34:35], v89 offset:27520
    v_accvgpr_read_b32 v40, a0
    v_accvgpr_read_b32 v41, a1
    v_cvt_pk_bf16_f32 v48, v40, v41
    v_pk_max_i16 v48, v48, 0
    s_add_u32 m0, s19, 43008
    s_waitcnt lgkmcnt(6)
    v_mfma_f32_32x32x16_bf16 a[112:127], v[20:23], v[100:103], a[112:127]
    buffer_load_dwordx4 v10, s[28:31], s55 offen lds
    ds_read_b64_tr_b16 v[36:37], v89 offset:29696
    ds_read_b64_tr_b16 v[38:39], v89 offset:30464
    v_accvgpr_read_b32 v42, a2
    v_accvgpr_read_b32 v43, a3
    v_cvt_pk_bf16_f32 v49, v42, v43
    s_waitcnt lgkmcnt(6)
    v_mfma_f32_32x32x16_bf16 a[80:95], v[24:27], v[104:107], a[80:95]
    ds_read_b64_tr_b16 v[16:17], v89 offset:29760
    ds_read_b64_tr_b16 v[18:19], v89 offset:30528
    v_pk_max_i16 v49, v49, 0
    v_accvgpr_read_b32 v40, a4
    v_accvgpr_read_b32 v41, a5
    v_cvt_pk_bf16_f32 v50, v40, v41
    s_waitcnt lgkmcnt(6)
    v_mfma_f32_32x32x16_bf16 a[96:111], v[28:31], v[104:107], a[96:111]
    ds_read_b64_tr_b16 v[20:21], v89 offset:29824
    ds_read_b64_tr_b16 v[22:23], v89 offset:30592
    v_pk_max_i16 v50, v50, 0
    v_accvgpr_read_b32 v42, a6
    v_accvgpr_read_b32 v43, a7
    v_cvt_pk_bf16_f32 v51, v42, v43
    s_waitcnt lgkmcnt(6)
    v_mfma_f32_32x32x16_bf16 a[112:127], v[32:35], v[104:107], a[112:127]
    s_barrier
    ds_read_b64_tr_b16 v[24:25], v89 offset:40960
    ds_read_b64_tr_b16 v[26:27], v89 offset:41728
    v_pk_max_i16 v51, v51, 0
    v_accvgpr_read_b32 v40, a8
    v_accvgpr_read_b32 v41, a9
    v_cvt_pk_bf16_f32 v52, v40, v41
    s_add_u32 s55, s37, 1228800
    s_add_u32 m0, s19, 61440
    s_waitcnt lgkmcnt(6)
    v_mfma_f32_32x32x16_bf16 a[80:95], v[36:39], v[108:111], a[80:95]
    buffer_load_dwordx4 v8, s[28:31], s55 offen lds
    ds_read_b64_tr_b16 v[28:29], v89 offset:41024
    ds_read_b64_tr_b16 v[30:31], v89 offset:41792
    v_pk_max_i16 v52, v52, 0
    v_accvgpr_read_b32 v42, a10
    v_accvgpr_read_b32 v43, a11
    s_waitcnt lgkmcnt(6)
    v_mfma_f32_32x32x16_bf16 a[96:111], v[16:19], v[108:111], a[96:111]
    ds_read_b64_tr_b16 v[32:33], v89 offset:41088
    ds_read_b64_tr_b16 v[34:35], v89 offset:41856
    v_cvt_pk_bf16_f32 v53, v42, v43
    v_pk_max_i16 v53, v53, 0
    v_accvgpr_read_b32 v40, a12
    v_accvgpr_read_b32 v41, a13
    s_waitcnt lgkmcnt(6)
    v_mfma_f32_32x32x16_bf16 a[112:127], v[20:23], v[108:111], a[112:127]
    ds_read_b64_tr_b16 v[36:37], v89 offset:44032
    ds_read_b64_tr_b16 v[38:39], v89 offset:44800
    v_cvt_pk_bf16_f32 v54, v40, v41
    v_pk_max_i16 v54, v54, 0
    v_accvgpr_read_b32 v42, a14
    v_accvgpr_read_b32 v43, a15
    s_waitcnt lgkmcnt(6)
    v_mfma_f32_32x32x16_bf16 a[80:95], v[24:27], v[112:115], a[80:95]
    ds_read_b64_tr_b16 v[16:17], v89 offset:44096
    ds_read_b64_tr_b16 v[18:19], v89 offset:44864
    v_cvt_pk_bf16_f32 v55, v42, v43
    v_pk_max_i16 v55, v55, 0
    buffer_store_dwordx4 v[48:51], v11, s[20:23], s48 offen offset:0 sc1
    buffer_store_dwordx4 v[52:55], v11, s[20:23], s48 offen offset:512 sc1
    s_add_u32 m0, s19, 62464
    s_waitcnt lgkmcnt(6)
    v_mfma_f32_32x32x16_bf16 a[96:111], v[28:31], v[112:115], a[96:111]
    buffer_load_dwordx4 v9, s[28:31], s55 offen lds
    ds_read_b64_tr_b16 v[20:21], v89 offset:44160
    ds_read_b64_tr_b16 v[22:23], v89 offset:44928
    v_accvgpr_read_b32 v40, a16
    v_accvgpr_read_b32 v41, a17
    v_cvt_pk_bf16_f32 v56, v40, v41
    s_waitcnt lgkmcnt(6)
    v_mfma_f32_32x32x16_bf16 a[112:127], v[32:35], v[112:115], a[112:127]
    ds_read_b64_tr_b16 v[24:25], v89 offset:47104
    ds_read_b64_tr_b16 v[26:27], v89 offset:47872
    v_pk_max_i16 v56, v56, 0
    v_accvgpr_read_b32 v42, a18
    v_accvgpr_read_b32 v43, a19
    v_cvt_pk_bf16_f32 v57, v42, v43
    s_waitcnt lgkmcnt(6)
    v_mfma_f32_32x32x16_bf16 a[80:95], v[36:39], v[116:119], a[80:95]
    ds_read_b64_tr_b16 v[28:29], v89 offset:47168
    ds_read_b64_tr_b16 v[30:31], v89 offset:47936
    v_pk_max_i16 v57, v57, 0
    v_accvgpr_read_b32 v40, a20
    v_accvgpr_read_b32 v41, a21
    v_cvt_pk_bf16_f32 v58, v40, v41
    s_waitcnt lgkmcnt(6)
    v_mfma_f32_32x32x16_bf16 a[96:111], v[16:19], v[116:119], a[96:111]
    ds_read_b64_tr_b16 v[32:33], v89 offset:47232
    ds_read_b64_tr_b16 v[34:35], v89 offset:48000
    v_pk_max_i16 v58, v58, 0
    v_accvgpr_read_b32 v42, a22
    v_accvgpr_read_b32 v43, a23
    v_cvt_pk_bf16_f32 v59, v42, v43
    s_add_u32 m0, s19, 63488
    s_waitcnt lgkmcnt(6)
    v_mfma_f32_32x32x16_bf16 a[112:127], v[20:23], v[116:119], a[112:127]
    buffer_load_dwordx4 v10, s[28:31], s55 offen lds
    ds_read_b64_tr_b16 v[36:37], v89 offset:50176
    ds_read_b64_tr_b16 v[38:39], v89 offset:50944
    v_pk_max_i16 v59, v59, 0
    v_accvgpr_read_b32 v40, a24
    v_accvgpr_read_b32 v41, a25
    s_waitcnt lgkmcnt(6)
    v_mfma_f32_32x32x16_bf16 a[80:95], v[24:27], v[120:123], a[80:95]
    ds_read_b64_tr_b16 v[16:17], v89 offset:50240
    ds_read_b64_tr_b16 v[18:19], v89 offset:51008
    v_cvt_pk_bf16_f32 v60, v40, v41
    v_pk_max_i16 v60, v60, 0
    v_accvgpr_read_b32 v42, a26
    v_accvgpr_read_b32 v43, a27
    s_waitcnt lgkmcnt(6)
    v_mfma_f32_32x32x16_bf16 a[96:111], v[28:31], v[120:123], a[96:111]
    ds_read_b64_tr_b16 v[20:21], v89 offset:50304
    ds_read_b64_tr_b16 v[22:23], v89 offset:51072
    v_cvt_pk_bf16_f32 v61, v42, v43
    v_pk_max_i16 v61, v61, 0
    v_accvgpr_read_b32 v40, a28
    v_accvgpr_read_b32 v41, a29
    s_waitcnt lgkmcnt(6)
    v_mfma_f32_32x32x16_bf16 a[112:127], v[32:35], v[120:123], a[112:127]
    s_barrier
    ds_read_b64_tr_b16 v[24:25], v88 offset:0
    ds_read_b64_tr_b16 v[26:27], v88 offset:768
    v_cvt_pk_bf16_f32 v62, v40, v41
    v_pk_max_i16 v62, v62, 0
    v_accvgpr_read_b32 v42, a30
    v_accvgpr_read_b32 v43, a31
    s_add_u32 s55, s37, 1474560
    s_add_u32 m0, s19, 81920
    s_waitcnt lgkmcnt(6)
    v_mfma_f32_32x32x16_bf16 a[80:95], v[36:39], v[124:127], a[80:95]
    buffer_load_dwordx4 v8, s[28:31], s55 offen lds
    ds_read_b64_tr_b16 v[28:29], v88 offset:64
    ds_read_b64_tr_b16 v[30:31], v88 offset:832
    v_cvt_pk_bf16_f32 v63, v42, v43
    v_pk_max_i16 v63, v63, 0
    buffer_store_dwordx4 v[56:59], v11, s[20:23], s48 offen offset:1024 sc1
    s_waitcnt lgkmcnt(6)
    v_mfma_f32_32x32x16_bf16 a[96:111], v[16:19], v[124:127], a[96:111]
    ds_read_b64_tr_b16 v[32:33], v88 offset:128
    ds_read_b64_tr_b16 v[34:35], v88 offset:896
    buffer_store_dwordx4 v[60:63], v11, s[20:23], s48 offen offset:1536 sc1
    v_accvgpr_read_b32 v40, a32
    v_accvgpr_read_b32 v41, a33
    v_cvt_pk_bf16_f32 v48, v40, v41
    s_waitcnt lgkmcnt(6)
    v_mfma_f32_32x32x16_bf16 a[112:127], v[20:23], v[124:127], a[112:127]
    ds_read_b64_tr_b16 v[36:37], v88 offset:3072
    ds_read_b64_tr_b16 v[38:39], v88 offset:3840
    v_pk_max_i16 v48, v48, 0
    v_accvgpr_read_b32 v42, a34
    v_accvgpr_read_b32 v43, a35
    v_cvt_pk_bf16_f32 v49, v42, v43
    s_waitcnt lgkmcnt(6)
    v_mfma_f32_32x32x16_bf16 a[80:95], v[24:27], v[128:131], a[80:95]
    ds_read_b64_tr_b16 v[16:17], v88 offset:3136
    ds_read_b64_tr_b16 v[18:19], v88 offset:3904
    v_pk_max_i16 v49, v49, 0
    v_accvgpr_read_b32 v40, a36
    v_accvgpr_read_b32 v41, a37
    v_cvt_pk_bf16_f32 v50, v40, v41
    s_add_u32 m0, s19, 82944
    s_waitcnt lgkmcnt(6)
    v_mfma_f32_32x32x16_bf16 a[96:111], v[28:31], v[128:131], a[96:111]
    buffer_load_dwordx4 v9, s[28:31], s55 offen lds
    ds_read_b64_tr_b16 v[20:21], v88 offset:3200
    ds_read_b64_tr_b16 v[22:23], v88 offset:3968
    v_pk_max_i16 v50, v50, 0
    v_accvgpr_read_b32 v42, a38
    v_accvgpr_read_b32 v43, a39
    s_waitcnt lgkmcnt(6)
    v_mfma_f32_32x32x16_bf16 a[112:127], v[32:35], v[128:131], a[112:127]
    ds_read_b64_tr_b16 v[24:25], v88 offset:6144
    ds_read_b64_tr_b16 v[26:27], v88 offset:6912
    v_cvt_pk_bf16_f32 v51, v42, v43
    v_pk_max_i16 v51, v51, 0
    v_accvgpr_read_b32 v40, a40
    v_accvgpr_read_b32 v41, a41
    s_waitcnt lgkmcnt(6)
    v_mfma_f32_32x32x16_bf16 a[80:95], v[36:39], v[132:135], a[80:95]
    ds_read_b64_tr_b16 v[28:29], v88 offset:6208
    ds_read_b64_tr_b16 v[30:31], v88 offset:6976
    v_cvt_pk_bf16_f32 v52, v40, v41
    v_pk_max_i16 v52, v52, 0
    v_accvgpr_read_b32 v42, a42
    v_accvgpr_read_b32 v43, a43
    s_waitcnt lgkmcnt(6)
    v_mfma_f32_32x32x16_bf16 a[96:111], v[16:19], v[132:135], a[96:111]
    ds_read_b64_tr_b16 v[32:33], v88 offset:6272
    ds_read_b64_tr_b16 v[34:35], v88 offset:7040
    v_cvt_pk_bf16_f32 v53, v42, v43
    v_pk_max_i16 v53, v53, 0
    v_accvgpr_read_b32 v40, a44
    v_accvgpr_read_b32 v41, a45
    s_add_u32 m0, s19, 83968
    s_waitcnt lgkmcnt(6)
    v_mfma_f32_32x32x16_bf16 a[112:127], v[20:23], v[132:135], a[112:127]
    buffer_load_dwordx4 v10, s[28:31], s55 offen lds
    ds_read_b64_tr_b16 v[36:37], v88 offset:9216
    ds_read_b64_tr_b16 v[38:39], v88 offset:9984
    v_cvt_pk_bf16_f32 v54, v40, v41
    v_pk_max_i16 v54, v54, 0
    v_accvgpr_read_b32 v42, a46
    s_waitcnt lgkmcnt(6)
    v_mfma_f32_32x32x16_bf16 a[80:95], v[24:27], v[136:139], a[80:95]
    ds_read_b64_tr_b16 v[16:17], v88 offset:9280
    ds_read_b64_tr_b16 v[18:19], v88 offset:10048
    v_accvgpr_read_b32 v43, a47
    v_cvt_pk_bf16_f32 v55, v42, v43
    v_pk_max_i16 v55, v55, 0
    buffer_store_dwordx4 v[48:51], v11, s[20:23], s48 offen offset:2048 sc1
    s_waitcnt lgkmcnt(6)
    v_mfma_f32_32x32x16_bf16 a[96:111], v[28:31], v[136:139], a[96:111]
    ds_read_b64_tr_b16 v[20:21], v88 offset:9344
    ds_read_b64_tr_b16 v[22:23], v88 offset:10112
    buffer_store_dwordx4 v[52:55], v11, s[20:23], s48 offen offset:2560 sc1
    v_accvgpr_read_b32 v40, a48
    v_accvgpr_read_b32 v41, a49
    v_cvt_pk_bf16_f32 v56, v40, v41
    s_waitcnt lgkmcnt(6)
    v_mfma_f32_32x32x16_bf16 a[112:127], v[32:35], v[136:139], a[112:127]
    s_waitcnt vmcnt(15)
    s_barrier
    ds_read_b64_tr_b16 v[24:25], v88 offset:20480
    ds_read_b64_tr_b16 v[26:27], v88 offset:21248
    v_pk_max_i16 v56, v56, 0
    v_accvgpr_read_b32 v42, a50
    v_accvgpr_read_b32 v43, a51
    v_cvt_pk_bf16_f32 v57, v42, v43
    s_add_u32 s55, s37, 1720320
    s_add_u32 m0, s19, 102400
    s_waitcnt lgkmcnt(6)
    v_mfma_f32_32x32x16_bf16 a[80:95], v[36:39], v[140:143], a[80:95]
    buffer_load_dwordx4 v8, s[28:31], s55 offen lds
    ds_read_b64_tr_b16 v[28:29], v88 offset:20544
    ds_read_b64_tr_b16 v[30:31], v88 offset:21312
    v_pk_max_i16 v57, v57, 0
    v_accvgpr_read_b32 v40, a52
    v_accvgpr_read_b32 v41, a53
    s_waitcnt lgkmcnt(6)
    v_mfma_f32_32x32x16_bf16 a[96:111], v[16:19], v[140:143], a[96:111]
    ds_read_b64_tr_b16 v[32:33], v88 offset:20608
    ds_read_b64_tr_b16 v[34:35], v88 offset:21376
    v_cvt_pk_bf16_f32 v58, v40, v41
    v_pk_max_i16 v58, v58, 0
    v_accvgpr_read_b32 v42, a54
    v_accvgpr_read_b32 v43, a55
    s_waitcnt lgkmcnt(6)
    v_mfma_f32_32x32x16_bf16 a[112:127], v[20:23], v[140:143], a[112:127]
    ds_read_b64_tr_b16 v[36:37], v88 offset:23552
    ds_read_b64_tr_b16 v[38:39], v88 offset:24320
    v_cvt_pk_bf16_f32 v59, v42, v43
    v_pk_max_i16 v59, v59, 0
    v_accvgpr_read_b32 v40, a56
    v_accvgpr_read_b32 v41, a57
    s_waitcnt lgkmcnt(6)
    v_mfma_f32_32x32x16_bf16 a[80:95], v[24:27], v[144:147], a[80:95]
    ds_read_b64_tr_b16 v[16:17], v88 offset:23616
    ds_read_b64_tr_b16 v[18:19], v88 offset:24384
    v_cvt_pk_bf16_f32 v60, v40, v41
    v_pk_max_i16 v60, v60, 0
    v_accvgpr_read_b32 v42, a58
    v_accvgpr_read_b32 v43, a59
    s_add_u32 m0, s19, 103424
    s_waitcnt lgkmcnt(6)
    v_mfma_f32_32x32x16_bf16 a[96:111], v[28:31], v[144:147], a[96:111]
    buffer_load_dwordx4 v9, s[28:31], s55 offen lds
    ds_read_b64_tr_b16 v[20:21], v88 offset:23680
    ds_read_b64_tr_b16 v[22:23], v88 offset:24448
    v_cvt_pk_bf16_f32 v61, v42, v43
    v_pk_max_i16 v61, v61, 0
    v_accvgpr_read_b32 v40, a60
    s_waitcnt lgkmcnt(6)
    v_mfma_f32_32x32x16_bf16 a[112:127], v[32:35], v[144:147], a[112:127]
    ds_read_b64_tr_b16 v[24:25], v88 offset:26624
    ds_read_b64_tr_b16 v[26:27], v88 offset:27392
    v_accvgpr_read_b32 v41, a61
    v_cvt_pk_bf16_f32 v62, v40, v41
    v_pk_max_i16 v62, v62, 0
    v_accvgpr_read_b32 v42, a62
    s_waitcnt lgkmcnt(6)
    v_mfma_f32_32x32x16_bf16 a[80:95], v[36:39], v[148:151], a[80:95]
    ds_read_b64_tr_b16 v[28:29], v88 offset:26688
    ds_read_b64_tr_b16 v[30:31], v88 offset:27456
    v_accvgpr_read_b32 v43, a63
    v_cvt_pk_bf16_f32 v63, v42, v43
    v_pk_max_i16 v63, v63, 0
    buffer_store_dwordx4 v[56:59], v11, s[20:23], s48 offen offset:3072 sc1
    s_waitcnt lgkmcnt(6)
    v_mfma_f32_32x32x16_bf16 a[96:111], v[16:19], v[148:151], a[96:111]
    ds_read_b64_tr_b16 v[32:33], v88 offset:26752
    ds_read_b64_tr_b16 v[34:35], v88 offset:27520
    buffer_store_dwordx4 v[60:63], v11, s[20:23], s48 offen offset:3584 sc1
    v_accvgpr_read_b32 v40, a64
    v_accvgpr_read_b32 v41, a65
    v_cvt_pk_bf16_f32 v48, v40, v41
    s_add_u32 m0, s19, 104448
    s_waitcnt lgkmcnt(6)
    v_mfma_f32_32x32x16_bf16 a[112:127], v[20:23], v[148:151], a[112:127]
    buffer_load_dwordx4 v10, s[28:31], s55 offen lds
    ds_read_b64_tr_b16 v[36:37], v88 offset:29696
    ds_read_b64_tr_b16 v[38:39], v88 offset:30464
    v_pk_max_i16 v48, v48, 0
    v_accvgpr_read_b32 v42, a66
    v_accvgpr_read_b32 v43, a67
    s_waitcnt lgkmcnt(6)
    v_mfma_f32_32x32x16_bf16 a[80:95], v[24:27], v[152:155], a[80:95]
    ds_read_b64_tr_b16 v[16:17], v88 offset:29760
    ds_read_b64_tr_b16 v[18:19], v88 offset:30528
    v_cvt_pk_bf16_f32 v49, v42, v43
    v_pk_max_i16 v49, v49, 0
    v_accvgpr_read_b32 v40, a68
    v_accvgpr_read_b32 v41, a69
    s_waitcnt lgkmcnt(6)
    v_mfma_f32_32x32x16_bf16 a[96:111], v[28:31], v[152:155], a[96:111]
    ds_read_b64_tr_b16 v[20:21], v88 offset:29824
    ds_read_b64_tr_b16 v[22:23], v88 offset:30592
    v_cvt_pk_bf16_f32 v50, v40, v41
    v_pk_max_i16 v50, v50, 0
    v_accvgpr_read_b32 v42, a70
    v_accvgpr_read_b32 v43, a71
    s_waitcnt lgkmcnt(6)
    v_mfma_f32_32x32x16_bf16 a[112:127], v[32:35], v[152:155], a[112:127]
    s_waitcnt vmcnt(17)
    s_barrier
    ds_read_b64_tr_b16 v[24:25], v88 offset:40960
    ds_read_b64_tr_b16 v[26:27], v88 offset:41728
    v_cvt_pk_bf16_f32 v51, v42, v43
    v_pk_max_i16 v51, v51, 0
    v_accvgpr_read_b32 v40, a72
    v_accvgpr_read_b32 v41, a73
    s_add_u32 s55, s37, 1966080
    s_add_u32 m0, s19, 0
    s_waitcnt lgkmcnt(6)
    v_mfma_f32_32x32x16_bf16 a[80:95], v[36:39], v[156:159], a[80:95]
    buffer_load_dwordx4 v8, s[28:31], s55 offen lds
    ds_read_b64_tr_b16 v[28:29], v88 offset:41024
    ds_read_b64_tr_b16 v[30:31], v88 offset:41792
    v_cvt_pk_bf16_f32 v52, v40, v41
    v_pk_max_i16 v52, v52, 0
    v_accvgpr_read_b32 v42, a74
    s_waitcnt lgkmcnt(6)
    v_mfma_f32_32x32x16_bf16 a[96:111], v[16:19], v[156:159], a[96:111]
    ds_read_b64_tr_b16 v[32:33], v88 offset:41088
    ds_read_b64_tr_b16 v[34:35], v88 offset:41856
    v_accvgpr_read_b32 v43, a75
    v_cvt_pk_bf16_f32 v53, v42, v43
    v_pk_max_i16 v53, v53, 0
    v_accvgpr_read_b32 v40, a76
    s_waitcnt lgkmcnt(6)
    v_mfma_f32_32x32x16_bf16 a[112:127], v[20:23], v[156:159], a[112:127]
    ds_read_b64_tr_b16 v[36:37], v88 offset:44032
    ds_read_b64_tr_b16 v[38:39], v88 offset:44800
    v_accvgpr_read_b32 v41, a77
    v_cvt_pk_bf16_f32 v54, v40, v41
    v_pk_max_i16 v54, v54, 0
    v_accvgpr_read_b32 v42, a78
    s_waitcnt lgkmcnt(6)
    v_mfma_f32_32x32x16_bf16 a[80:95], v[24:27], v[160:163], a[80:95]
    ds_read_b64_tr_b16 v[16:17], v88 offset:44096
    ds_read_b64_tr_b16 v[18:19], v88 offset:44864
    v_accvgpr_read_b32 v43, a79
    v_cvt_pk_bf16_f32 v55, v42, v43
    v_pk_max_i16 v55, v55, 0
    buffer_store_dwordx4 v[48:51], v11, s[20:23], s49 offen offset:0 sc1
    s_add_u32 m0, s19, 1024
    s_waitcnt lgkmcnt(6)
    v_mfma_f32_32x32x16_bf16 a[96:111], v[28:31], v[160:163], a[96:111]
    buffer_load_dwordx4 v9, s[28:31], s55 offen lds
    ds_read_b64_tr_b16 v[20:21], v88 offset:44160
    ds_read_b64_tr_b16 v[22:23], v88 offset:44928
    buffer_store_dwordx4 v[52:55], v11, s[20:23], s49 offen offset:512 sc1
    s_waitcnt lgkmcnt(6)
    v_mfma_f32_32x32x16_bf16 a[112:127], v[32:35], v[160:163], a[112:127]
    ds_read_b64_tr_b16 v[24:25], v88 offset:47104
    ds_read_b64_tr_b16 v[26:27], v88 offset:47872
    s_waitcnt lgkmcnt(6)
    v_mfma_f32_32x32x16_bf16 a[80:95], v[36:39], v[164:167], a[80:95]
    ds_read_b64_tr_b16 v[28:29], v88 offset:47168
    ds_read_b64_tr_b16 v[30:31], v88 offset:47936
    s_waitcnt lgkmcnt(6)
    v_mfma_f32_32x32x16_bf16 a[96:111], v[16:19], v[164:167], a[96:111]
    ds_read_b64_tr_b16 v[32:33], v88 offset:47232
    ds_read_b64_tr_b16 v[34:35], v88 offset:48000
    s_add_u32 m0, s19, 2048
    s_waitcnt lgkmcnt(6)
    v_mfma_f32_32x32x16_bf16 a[112:127], v[20:23], v[164:167], a[112:127]
    buffer_load_dwordx4 v10, s[28:31], s55 offen lds
    ds_read_b64_tr_b16 v[36:37], v88 offset:50176
    ds_read_b64_tr_b16 v[38:39], v88 offset:50944
    s_waitcnt lgkmcnt(6)
    v_mfma_f32_32x32x16_bf16 a[80:95], v[24:27], v[168:171], a[80:95]
    ds_read_b64_tr_b16 v[16:17], v88 offset:50240
    ds_read_b64_tr_b16 v[18:19], v88 offset:51008
    s_waitcnt lgkmcnt(6)
    v_mfma_f32_32x32x16_bf16 a[96:111], v[28:31], v[168:171], a[96:111]
    ds_read_b64_tr_b16 v[20:21], v88 offset:50304
    ds_read_b64_tr_b16 v[22:23], v88 offset:51072
    s_cmp_lg_u32 s14, 0
    s_cbranch_scc1 parallel_sum__linear_attn_block__dense_activation_relu__prompt_kernel_b_w2cp_pre
    s_mov_b32 s40, 15571968
    v_mul_u32_u24 v1, 128, v2
    v_add_u32 v1, s40, v1
    s_mov_b64 exec, 255
    buffer_load_dword v95, v1, s[20:23], 0 offen sc0 sc1
    s_mov_b64 exec, -1
parallel_sum__linear_attn_block__dense_activation_relu__prompt_kernel_b_w2cp_pre:
    s_lshl_b32 s98, s16, 1
    s_add_u32 s98, s98, 1
    s_and_b32 s99, s98, 7
    s_and_b32 s40, s15, 3
    s_lshl_b32 s40, s40, 1
    s_add_u32 s99, s99, s40
    s_add_u32 s44, s14, 0
    s_and_b32 s44, s44, 3
    s_lshl_b32 s45, s98, 2
    s_add_u32 s44, s44, s45
    s_mul_i32 s44, s44, 75776
    s_add_u32 s24, s44, 2621440
    s_add_u32 s44, s14, 1
    s_and_b32 s44, s44, 3
    s_lshl_b32 s45, s98, 2
    s_add_u32 s44, s44, s45
    s_mul_i32 s44, s44, 75776
    s_add_u32 s25, s44, 2621440
    s_add_u32 s44, s14, 2
    s_and_b32 s44, s44, 3
    s_lshl_b32 s45, s98, 2
    s_add_u32 s44, s44, s45
    s_mul_i32 s44, s44, 75776
    s_add_u32 s26, s44, 2621440
    s_add_u32 s44, s14, 3
    s_and_b32 s44, s44, 3
    s_lshl_b32 s45, s98, 2
    s_add_u32 s44, s44, s45
    s_mul_i32 s44, s44, 75776
    s_add_u32 s27, s44, 2621440
    s_mul_i32 s96, s15, 378880
    s_add_u32 s96, s96, 12320768
    s_add_u32 s97, s96, 4096
    v_lshlrev_b32 v5, 4, v2
    s_lshl_b32 s44, s14, 10
    v_add_u32 v6, s44, v5
    s_mul_i32 s44, s14, 5120
    v_add_u32 v7, s44, v5
    s_cmp_ge_u32 s14, 2
    s_cselect_b32 s46, 0x40000000, 0
    s_mul_i32 s44, s99, 6554
    s_lshr_b32 s44, s44, 16
    s_mul_i32 s44, s44, 10
    s_sub_u32 s100, s99, s44
    s_lshl_b32 s44, s100, 2
    s_add_u32 s44, s44, 16
    s_mul_i32 s45, s44, 5120
    s_lshl_b32 s44, s44, 10
    s_cmp_eq_u32 s100, 9
    s_cselect_b32 s101, s46, 0
    s_add_u32 s44, s44, s101
    s_add_u32 s45, s45, s101
    v_add_u32 v70, s44, v6
    v_add_u32 v73, s45, v7
    s_add_u32 s100, s100, 1
    s_cmp_eq_u32 s100, 10
    s_cselect_b32 s100, 0, s100
    s_lshl_b32 s44, s100, 2
    s_add_u32 s44, s44, 16
    s_mul_i32 s45, s44, 5120
    s_lshl_b32 s44, s44, 10
    s_cmp_eq_u32 s100, 9
    s_cselect_b32 s101, s46, 0
    s_add_u32 s44, s44, s101
    s_add_u32 s45, s45, s101
    v_add_u32 v71, s44, v6
    v_add_u32 v74, s45, v7
    s_add_u32 s100, s100, 1
    s_cmp_eq_u32 s100, 10
    s_cselect_b32 s100, 0, s100
    s_lshl_b32 s44, s100, 2
    s_add_u32 s44, s44, 16
    s_mul_i32 s45, s44, 5120
    s_lshl_b32 s44, s44, 10
    s_cmp_eq_u32 s100, 9
    s_cselect_b32 s101, s46, 0
    s_add_u32 s44, s44, s101
    s_add_u32 s45, s45, s101
    v_add_u32 v72, s44, v6
    v_add_u32 v75, s45, v7
    s_waitcnt lgkmcnt(6)
    v_mfma_f32_32x32x16_bf16 a[112:127], v[32:35], v[168:171], a[112:127]
    s_waitcnt vmcnt(17)
    s_barrier
    ds_read_b64_tr_b16 v[24:25], v89 offset:0
    ds_read_b64_tr_b16 v[26:27], v89 offset:768
    s_add_u32 s55, s37, 2211840
    s_add_u32 m0, s19, 20480
    s_waitcnt lgkmcnt(6)
    v_mfma_f32_32x32x16_bf16 a[80:95], v[36:39], v[172:175], a[80:95]
    buffer_load_dwordx4 v8, s[28:31], s55 offen lds
    ds_read_b64_tr_b16 v[28:29], v89 offset:64
    ds_read_b64_tr_b16 v[30:31], v89 offset:832
    s_waitcnt lgkmcnt(6)
    v_mfma_f32_32x32x16_bf16 a[96:111], v[16:19], v[172:175], a[96:111]
    ds_read_b64_tr_b16 v[32:33], v89 offset:128
    ds_read_b64_tr_b16 v[34:35], v89 offset:896
    s_waitcnt lgkmcnt(6)
    v_mfma_f32_32x32x16_bf16 a[112:127], v[20:23], v[172:175], a[112:127]
    ds_read_b64_tr_b16 v[36:37], v89 offset:3072
    ds_read_b64_tr_b16 v[38:39], v89 offset:3840
    s_waitcnt lgkmcnt(6)
    v_mfma_f32_32x32x16_bf16 a[80:95], v[24:27], v[176:179], a[80:95]
    ds_read_b64_tr_b16 v[16:17], v89 offset:3136
    ds_read_b64_tr_b16 v[18:19], v89 offset:3904
    s_add_u32 m0, s19, 21504
    s_waitcnt lgkmcnt(6)
    v_mfma_f32_32x32x16_bf16 a[96:111], v[28:31], v[176:179], a[96:111]
    buffer_load_dwordx4 v9, s[28:31], s55 offen lds
    ds_read_b64_tr_b16 v[20:21], v89 offset:3200
    ds_read_b64_tr_b16 v[22:23], v89 offset:3968
    s_waitcnt lgkmcnt(6)
    v_mfma_f32_32x32x16_bf16 a[112:127], v[32:35], v[176:179], a[112:127]
    ds_read_b64_tr_b16 v[24:25], v89 offset:6144
    ds_read_b64_tr_b16 v[26:27], v89 offset:6912
    s_waitcnt lgkmcnt(6)
    v_mfma_f32_32x32x16_bf16 a[80:95], v[36:39], v[180:183], a[80:95]
    ds_read_b64_tr_b16 v[28:29], v89 offset:6208
    ds_read_b64_tr_b16 v[30:31], v89 offset:6976
    s_add_u32 m0, s19, 22528
    s_nop 0
    buffer_load_dwordx4 v10, s[28:31], s55 offen lds
    s_cmp_lg_u32 s14, 0
    s_cbranch_scc1 parallel_sum__linear_attn_block__dense_activation_relu__prompt_kernel_b_w2c_ok
    v_mov_b32 v68, 16
    s_mov_b64 exec, 255
    s_waitcnt vmcnt(3)
    v_cmp_ge_u32 vcc, v95, v68
    s_nop 3
    s_cmp_eq_u64 vcc, 255
    s_cbranch_scc1 parallel_sum__linear_attn_block__dense_activation_relu__prompt_kernel_b_w2c_done
    s_mov_b32 s42, 0
parallel_sum__linear_attn_block__dense_activation_relu__prompt_kernel_b_w2c_spin:
    buffer_load_dword v95, v1, s[20:23], 0 offen sc0 sc1
    s_waitcnt vmcnt(0)
    v_cmp_ge_u32 vcc, v95, v68
    s_add_u32 s42, s42, 1
    s_cmp_ge_u32 s42, 0x40000
    s_cbranch_scc1 parallel_sum__linear_attn_block__dense_activation_relu__prompt_kernel_b_w2c_done
    s_nop 0
    s_cmp_eq_u64 vcc, 255
    s_cbranch_scc0 parallel_sum__linear_attn_block__dense_activation_relu__prompt_kernel_b_w2c_spin
parallel_sum__linear_attn_block__dense_activation_relu__prompt_kernel_b_w2c_done:
    s_mov_b64 exec, -1
parallel_sum__linear_attn_block__dense_activation_relu__prompt_kernel_b_w2c_ok:
    s_barrier
    s_waitcnt lgkmcnt(6)
    v_mfma_f32_32x32x16_bf16 a[96:111], v[16:19], v[180:183], a[96:111]
    buffer_load_dwordx4 a[164:167], v73, s[20:23], s96 offen offset:0 sc1
    ds_read_b64_tr_b16 v[32:33], v89 offset:6272
    ds_read_b64_tr_b16 v[34:35], v89 offset:7040
    s_waitcnt lgkmcnt(6)
    v_mfma_f32_32x32x16_bf16 a[112:127], v[20:23], v[180:183], a[112:127]
    ds_read_b64_tr_b16 v[36:37], v89 offset:9216
    ds_read_b64_tr_b16 v[38:39], v89 offset:9984
    v_mov_b32 v48, 0
    s_waitcnt lgkmcnt(6)
    v_mfma_f32_32x32x16_bf16 a[80:95], v[24:27], v[184:187], a[80:95]
    ds_read_b64_tr_b16 v[16:17], v89 offset:9280
    ds_read_b64_tr_b16 v[18:19], v89 offset:10048
    v_mov_b32 v49, 0
    s_waitcnt lgkmcnt(6)
    v_mfma_f32_32x32x16_bf16 a[96:111], v[28:31], v[184:187], a[96:111]
    ds_read_b64_tr_b16 v[20:21], v89 offset:9344
    ds_read_b64_tr_b16 v[22:23], v89 offset:10112
    v_mov_b32 v50, 0
    s_waitcnt lgkmcnt(6)
    v_mfma_f32_32x32x16_bf16 a[112:127], v[32:35], v[184:187], a[112:127]
    buffer_load_dwordx4 a[168:171], v73, s[20:23], s96 offen offset:1024 sc1
    s_waitcnt vmcnt(17)
    s_waitcnt vmcnt(6)
    s_barrier
    s_cmp_lg_u32 s14, 0
    s_cbranch_scc1 parallel_sum__linear_attn_block__dense_activation_relu__prompt_kernel_b_hb_sig
    v_mov_b32 v44, 1
    s_lshl_b32 s40, s16, 7
    s_add_u32 s40, s40, 15565824
    v_mov_b32 v45, s40
    s_mov_b64 exec, 1
    buffer_atomic_add v44, v45, s[20:23], 0 offen
    s_mov_b64 exec, -1
parallel_sum__linear_attn_block__dense_activation_relu__prompt_kernel_b_hb_sig:
    ds_read_b64_tr_b16 v[24:25], v89 offset:20480
    ds_read_b64_tr_b16 v[26:27], v89 offset:21248
    s_waitcnt lgkmcnt(6)
    v_mfma_f32_32x32x16_bf16 a[80:95], v[36:39], v[188:191], a[80:95]
    ds_read_b64_tr_b16 v[28:29], v89 offset:20544
    ds_read_b64_tr_b16 v[30:31], v89 offset:21312
    v_mov_b32 v51, 0
    s_waitcnt lgkmcnt(6)
    v_mfma_f32_32x32x16_bf16 a[96:111], v[16:19], v[188:191], a[96:111]
    ds_read_b64_tr_b16 v[32:33], v89 offset:20608
    ds_read_b64_tr_b16 v[34:35], v89 offset:21376
    v_lshlrev_b32 v52, 4, v0
    s_waitcnt lgkmcnt(6)
    v_mfma_f32_32x32x16_bf16 a[112:127], v[20:23], v[188:191], a[112:127]
    ds_read_b64_tr_b16 v[36:37], v89 offset:23552
    ds_read_b64_tr_b16 v[38:39], v89 offset:24320
    v_add_u32 v52, 122880, v52
    s_waitcnt lgkmcnt(6)
    v_mfma_f32_32x32x16_bf16 a[80:95], v[24:27], v[192:195], a[80:95]
    buffer_load_dwordx4 a[172:175], v73, s[20:23], s96 offen offset:2048 sc1
    ds_read_b64_tr_b16 v[16:17], v89 offset:23616
    ds_read_b64_tr_b16 v[18:19], v89 offset:24384
    s_waitcnt lgkmcnt(6)
    v_mfma_f32_32x32x16_bf16 a[96:111], v[28:31], v[192:195], a[96:111]
    ds_read_b64_tr_b16 v[20:21], v89 offset:23680
    ds_read_b64_tr_b16 v[22:23], v89 offset:24448
    ds_write_b128 v52, v[48:51] offset:0
    s_waitcnt lgkmcnt(7)
    v_mfma_f32_32x32x16_bf16 a[112:127], v[32:35], v[192:195], a[112:127]
    ds_read_b64_tr_b16 v[24:25], v89 offset:26624
    ds_read_b64_tr_b16 v[26:27], v89 offset:27392
    ds_write_b128 v52, v[48:51] offset:4096
    s_waitcnt lgkmcnt(8)
    v_mfma_f32_32x32x16_bf16 a[80:95], v[36:39], v[196:199], a[80:95]
    ds_read_b64_tr_b16 v[28:29], v89 offset:26688
    ds_read_b64_tr_b16 v[30:31], v89 offset:27456
    ds_write_b128 v52, v[48:51] offset:8192
    s_waitcnt lgkmcnt(9)
    v_mfma_f32_32x32x16_bf16 a[96:111], v[16:19], v[196:199], a[96:111]
    buffer_load_dwordx4 a[176:179], v73, s[20:23], s96 offen offset:3072 sc1
    ds_read_b64_tr_b16 v[32:33], v89 offset:26752
    ds_read_b64_tr_b16 v[34:35], v89 offset:27520
    s_waitcnt lgkmcnt(9)
    v_mfma_f32_32x32x16_bf16 a[112:127], v[20:23], v[196:199], a[112:127]
    ds_read_b64_tr_b16 v[36:37], v89 offset:29696
    ds_read_b64_tr_b16 v[38:39], v89 offset:30464
    ds_write_b128 v52, v[48:51] offset:12288
    s_waitcnt lgkmcnt(9)
    v_mfma_f32_32x32x16_bf16 a[80:95], v[24:27], v[200:203], a[80:95]
    ds_read_b64_tr_b16 v[16:17], v89 offset:29760
    ds_read_b64_tr_b16 v[18:19], v89 offset:30528
    ds_write_b128 v52, v[48:51] offset:16384
    s_waitcnt lgkmcnt(9)
    v_mfma_f32_32x32x16_bf16 a[96:111], v[28:31], v[200:203], a[96:111]
    ds_read_b64_tr_b16 v[20:21], v89 offset:29824
    ds_read_b64_tr_b16 v[22:23], v89 offset:30592
    ds_write_b128 v52, v[48:51] offset:20480
    s_waitcnt lgkmcnt(9)
    v_mfma_f32_32x32x16_bf16 a[112:127], v[32:35], v[200:203], a[112:127]
    buffer_load_dwordx4 a[180:183], v73, s[20:23], s97 offen offset:0 sc1
    s_barrier
    ds_read_b64_tr_b16 v[24:25], v89 offset:40960
    ds_read_b64_tr_b16 v[26:27], v89 offset:41728
    s_waitcnt lgkmcnt(9)
    v_mfma_f32_32x32x16_bf16 a[80:95], v[36:39], v[204:207], a[80:95]
    ds_read_b64_tr_b16 v[28:29], v89 offset:41024
    ds_read_b64_tr_b16 v[30:31], v89 offset:41792
    ds_write_b128 v52, v[48:51] offset:24576
    s_waitcnt lgkmcnt(9)
    v_mfma_f32_32x32x16_bf16 a[96:111], v[16:19], v[204:207], a[96:111]
    ds_read_b64_tr_b16 v[32:33], v89 offset:41088
    ds_read_b64_tr_b16 v[34:35], v89 offset:41856
    ds_write_b128 v52, v[48:51] offset:28672
    s_waitcnt lgkmcnt(9)
    v_mfma_f32_32x32x16_bf16 a[112:127], v[20:23], v[204:207], a[112:127]
    ds_read_b64_tr_b16 v[36:37], v89 offset:44032
    ds_read_b64_tr_b16 v[38:39], v89 offset:44800
    s_waitcnt lgkmcnt(8)
    v_mfma_f32_32x32x16_bf16 a[80:95], v[24:27], v[208:211], a[80:95]
    buffer_load_dwordx4 a[200:203], v74, s[20:23], s96 offen offset:0 sc1
    ds_read_b64_tr_b16 v[16:17], v89 offset:44096
    ds_read_b64_tr_b16 v[18:19], v89 offset:44864
    s_waitcnt lgkmcnt(8)
    v_mfma_f32_32x32x16_bf16 a[96:111], v[28:31], v[208:211], a[96:111]
    ds_read_b64_tr_b16 v[20:21], v89 offset:44160
    ds_read_b64_tr_b16 v[22:23], v89 offset:44928
    s_waitcnt lgkmcnt(7)
    v_mfma_f32_32x32x16_bf16 a[112:127], v[32:35], v[208:211], a[112:127]
    ds_read_b64_tr_b16 v[24:25], v89 offset:47104
    ds_read_b64_tr_b16 v[26:27], v89 offset:47872
    s_waitcnt lgkmcnt(6)
    v_mfma_f32_32x32x16_bf16 a[80:95], v[36:39], v[212:215], a[80:95]
    ds_read_b64_tr_b16 v[28:29], v89 offset:47168
    ds_read_b64_tr_b16 v[30:31], v89 offset:47936
    s_waitcnt lgkmcnt(6)
    v_mfma_f32_32x32x16_bf16 a[96:111], v[16:19], v[212:215], a[96:111]
    buffer_load_dwordx4 a[204:207], v74, s[20:23], s96 offen offset:1024 sc1
    ds_read_b64_tr_b16 v[32:33], v89 offset:47232
    ds_read_b64_tr_b16 v[34:35], v89 offset:48000
    s_waitcnt lgkmcnt(6)
    v_mfma_f32_32x32x16_bf16 a[112:127], v[20:23], v[212:215], a[112:127]
    ds_read_b64_tr_b16 v[36:37], v89 offset:50176
    ds_read_b64_tr_b16 v[38:39], v89 offset:50944
    s_waitcnt lgkmcnt(6)
    v_mfma_f32_32x32x16_bf16 a[80:95], v[24:27], v[216:219], a[80:95]
    ds_read_b64_tr_b16 v[16:17], v89 offset:50240
    ds_read_b64_tr_b16 v[18:19], v89 offset:51008
    s_waitcnt lgkmcnt(6)
    v_mfma_f32_32x32x16_bf16 a[96:111], v[28:31], v[216:219], a[96:111]
    ds_read_b64_tr_b16 v[20:21], v89 offset:50304
    ds_read_b64_tr_b16 v[22:23], v89 offset:51072
    s_waitcnt lgkmcnt(6)
    v_mfma_f32_32x32x16_bf16 a[112:127], v[32:35], v[216:219], a[112:127]
    buffer_load_dwordx4 a[208:211], v74, s[20:23], s96 offen offset:2048 sc1
    s_waitcnt vmcnt(11)
    s_barrier
    ds_read_b64_tr_b16 v[24:25], v88 offset:0
    ds_read_b64_tr_b16 v[26:27], v88 offset:768
    s_waitcnt lgkmcnt(6)
    v_mfma_f32_32x32x16_bf16 a[80:95], v[36:39], v[220:223], a[80:95]
    ds_read_b64_tr_b16 v[28:29], v88 offset:64
    ds_read_b64_tr_b16 v[30:31], v88 offset:832
    s_waitcnt lgkmcnt(6)
    v_mfma_f32_32x32x16_bf16 a[96:111], v[16:19], v[220:223], a[96:111]
    ds_read_b64_tr_b16 v[32:33], v88 offset:128
    ds_read_b64_tr_b16 v[34:35], v88 offset:896
    s_waitcnt lgkmcnt(6)
    v_mfma_f32_32x32x16_bf16 a[112:127], v[20:23], v[220:223], a[112:127]
    ds_read_b64_tr_b16 v[36:37], v88 offset:3072
    ds_read_b64_tr_b16 v[38:39], v88 offset:3840
    s_waitcnt lgkmcnt(6)
    v_mfma_f32_32x32x16_bf16 a[80:95], v[24:27], v[224:227], a[80:95]
    buffer_load_dwordx4 a[212:215], v74, s[20:23], s96 offen offset:3072 sc1
    ds_read_b64_tr_b16 v[16:17], v88 offset:3136
    ds_read_b64_tr_b16 v[18:19], v88 offset:3904
    s_waitcnt lgkmcnt(6)
    v_mfma_f32_32x32x16_bf16 a[96:111], v[28:31], v[224:227], a[96:111]
    ds_read_b64_tr_b16 v[20:21], v88 offset:3200
    ds_read_b64_tr_b16 v[22:23], v88 offset:3968
    s_waitcnt lgkmcnt(6)
    v_mfma_f32_32x32x16_bf16 a[112:127], v[32:35], v[224:227], a[112:127]
    ds_read_b64_tr_b16 v[24:25], v88 offset:6144
    ds_read_b64_tr_b16 v[26:27], v88 offset:6912
    s_waitcnt lgkmcnt(6)
    v_mfma_f32_32x32x16_bf16 a[80:95], v[36:39], v[228:231], a[80:95]
    ds_read_b64_tr_b16 v[28:29], v88 offset:6208
    ds_read_b64_tr_b16 v[30:31], v88 offset:6976
    s_waitcnt lgkmcnt(6)
    v_mfma_f32_32x32x16_bf16 a[96:111], v[16:19], v[228:231], a[96:111]
    buffer_load_dwordx4 a[216:219], v74, s[20:23], s97 offen offset:0 sc1
    ds_read_b64_tr_b16 v[32:33], v88 offset:6272
    ds_read_b64_tr_b16 v[34:35], v88 offset:7040
    s_waitcnt lgkmcnt(6)
    v_mfma_f32_32x32x16_bf16 a[112:127], v[20:23], v[228:231], a[112:127]
    ds_read_b64_tr_b16 v[36:37], v88 offset:9216
    ds_read_b64_tr_b16 v[38:39], v88 offset:9984
    s_waitcnt lgkmcnt(6)
    v_mfma_f32_32x32x16_bf16 a[80:95], v[24:27], v[232:235], a[80:95]
    ds_read_b64_tr_b16 v[16:17], v88 offset:9280
    ds_read_b64_tr_b16 v[18:19], v88 offset:10048
    s_waitcnt lgkmcnt(6)
    v_mfma_f32_32x32x16_bf16 a[96:111], v[28:31], v[232:235], a[96:111]
    ds_read_b64_tr_b16 v[20:21], v88 offset:9344
    ds_read_b64_tr_b16 v[22:23], v88 offset:10112
    s_waitcnt lgkmcnt(6)
    v_mfma_f32_32x32x16_bf16 a[112:127], v[32:35], v[232:235], a[112:127]
    buffer_load_dwordx4 a[236:239], v75, s[20:23], s96 offen offset:0 sc1
    s_waitcnt vmcnt(11)
    s_barrier
    ds_read_b64_tr_b16 v[24:25], v88 offset:20480
    ds_read_b64_tr_b16 v[26:27], v88 offset:21248
    s_waitcnt lgkmcnt(6)
    v_mfma_f32_32x32x16_bf16 a[80:95], v[36:39], v[236:239], a[80:95]
    ds_read_b64_tr_b16 v[28:29], v88 offset:20544
    ds_read_b64_tr_b16 v[30:31], v88 offset:21312
    s_waitcnt lgkmcnt(6)
    v_mfma_f32_32x32x16_bf16 a[96:111], v[16:19], v[236:239], a[96:111]
    ds_read_b64_tr_b16 v[32:33], v88 offset:20608
    ds_read_b64_tr_b16 v[34:35], v88 offset:21376
    s_waitcnt lgkmcnt(6)
    v_mfma_f32_32x32x16_bf16 a[112:127], v[20:23], v[236:239], a[112:127]
    ds_read_b64_tr_b16 v[36:37], v88 offset:23552
    ds_read_b64_tr_b16 v[38:39], v88 offset:24320
    s_cmp_lg_u32 s14, 0
    s_cbranch_scc1 parallel_sum__linear_attn_block__dense_activation_relu__prompt_kernel_b_hbp_pre
    s_lshl_b32 s40, s16, 7
    s_add_u32 s40, s40, 15565824
    v_mov_b32 v1, s40
    s_mov_b64 exec, 1
    buffer_load_dword v95, v1, s[20:23], 0 offen sc0 sc1
    s_mov_b64 exec, -1
parallel_sum__linear_attn_block__dense_activation_relu__prompt_kernel_b_hbp_pre:
    s_waitcnt lgkmcnt(6)
    v_mfma_f32_32x32x16_bf16 a[80:95], v[24:27], v[240:243], a[80:95]
    buffer_load_dwordx4 a[240:243], v75, s[20:23], s96 offen offset:1024 sc1
    ds_read_b64_tr_b16 v[16:17], v88 offset:23616
    ds_read_b64_tr_b16 v[18:19], v88 offset:24384
    s_waitcnt lgkmcnt(6)
    v_mfma_f32_32x32x16_bf16 a[96:111], v[28:31], v[240:243], a[96:111]
    ds_read_b64_tr_b16 v[20:21], v88 offset:23680
    ds_read_b64_tr_b16 v[22:23], v88 offset:24448
    s_waitcnt lgkmcnt(6)
    v_mfma_f32_32x32x16_bf16 a[112:127], v[32:35], v[240:243], a[112:127]
    ds_read_b64_tr_b16 v[24:25], v88 offset:26624
    ds_read_b64_tr_b16 v[26:27], v88 offset:27392
    s_waitcnt lgkmcnt(6)
    v_mfma_f32_32x32x16_bf16 a[80:95], v[36:39], v[244:247], a[80:95]
    ds_read_b64_tr_b16 v[28:29], v88 offset:26688
    ds_read_b64_tr_b16 v[30:31], v88 offset:27456
    s_waitcnt lgkmcnt(6)
    v_mfma_f32_32x32x16_bf16 a[96:111], v[16:19], v[244:247], a[96:111]
    buffer_load_dwordx4 a[244:247], v75, s[20:23], s96 offen offset:2048 sc1
    ds_read_b64_tr_b16 v[32:33], v88 offset:26752
    ds_read_b64_tr_b16 v[34:35], v88 offset:27520
    s_waitcnt lgkmcnt(6)
    v_mfma_f32_32x32x16_bf16 a[112:127], v[20:23], v[244:247], a[112:127]
    ds_read_b64_tr_b16 v[36:37], v88 offset:29696
    ds_read_b64_tr_b16 v[38:39], v88 offset:30464
    s_waitcnt lgkmcnt(6)
    v_mfma_f32_32x32x16_bf16 a[80:95], v[24:27], v[248:251], a[80:95]
    ds_read_b64_tr_b16 v[16:17], v88 offset:29760
    ds_read_b64_tr_b16 v[18:19], v88 offset:30528
    s_waitcnt lgkmcnt(6)
    v_mfma_f32_32x32x16_bf16 a[96:111], v[28:31], v[248:251], a[96:111]
    ds_read_b64_tr_b16 v[20:21], v88 offset:29824
    ds_read_b64_tr_b16 v[22:23], v88 offset:30592
    s_waitcnt lgkmcnt(6)
    v_mfma_f32_32x32x16_bf16 a[112:127], v[32:35], v[248:251], a[112:127]
    buffer_load_dwordx4 a[248:251], v75, s[20:23], s96 offen offset:3072 sc1
    s_waitcnt lgkmcnt(4)
    v_mfma_f32_32x32x16_bf16 a[80:95], v[36:39], v[252:255], a[80:95]
    s_waitcnt lgkmcnt(2)
    v_mfma_f32_32x32x16_bf16 a[96:111], v[16:19], v[252:255], a[96:111]
    s_waitcnt lgkmcnt(0)
    v_mfma_f32_32x32x16_bf16 a[112:127], v[20:23], v[252:255], a[112:127]
    buffer_load_dwordx4 a[252:255], v75, s[20:23], s97 offen offset:0 sc1
    s_cmp_lg_u32 s14, 0
    s_cbranch_scc1 parallel_sum__linear_attn_block__dense_activation_relu__prompt_kernel_b_hb_ok
    v_mov_b32 v68, 8
    s_mov_b64 exec, 1
    s_waitcnt vmcnt(4)
    v_cmp_ge_u32 vcc, v95, v68
    s_nop 3
    s_cmp_eq_u64 vcc, 1
    s_cbranch_scc1 parallel_sum__linear_attn_block__dense_activation_relu__prompt_kernel_b_hb_done
    s_mov_b32 s42, 0
parallel_sum__linear_attn_block__dense_activation_relu__prompt_kernel_b_hb_spin:
    buffer_load_dword v95, v1, s[20:23], 0 offen sc0 sc1
    s_waitcnt vmcnt(0)
    v_cmp_ge_u32 vcc, v95, v68
    s_add_u32 s42, s42, 1
    s_cmp_ge_u32 s42, 0x40000
    s_cbranch_scc1 parallel_sum__linear_attn_block__dense_activation_relu__prompt_kernel_b_hb_done
    s_nop 0
    s_cmp_eq_u64 vcc, 1
    s_cbranch_scc0 parallel_sum__linear_attn_block__dense_activation_relu__prompt_kernel_b_hb_spin
parallel_sum__linear_attn_block__dense_activation_relu__prompt_kernel_b_hb_done:
    s_mov_b64 exec, -1
parallel_sum__linear_attn_block__dense_activation_relu__prompt_kernel_b_hb_ok:
    s_barrier
    buffer_load_dwordx4 a[148:151], v70, s[20:23], s24 offen sc1
    buffer_load_dwordx4 a[152:155], v70, s[20:23], s25 offen sc1
    buffer_load_dwordx4 a[156:159], v70, s[20:23], s26 offen sc1
    buffer_load_dwordx4 a[160:163], v70, s[20:23], s27 offen sc1
    buffer_load_dwordx4 a[184:187], v71, s[20:23], s24 offen sc1
    buffer_load_dwordx4 a[188:191], v71, s[20:23], s25 offen sc1
    buffer_load_dwordx4 a[192:195], v71, s[20:23], s26 offen sc1
    buffer_load_dwordx4 a[196:199], v71, s[20:23], s27 offen sc1
    buffer_load_dwordx4 a[220:223], v72, s[20:23], s24 offen sc1
    buffer_load_dwordx4 a[224:227], v72, s[20:23], s25 offen sc1
    buffer_load_dwordx4 a[228:231], v72, s[20:23], s26 offen sc1
    buffer_load_dwordx4 a[232:235], v72, s[20:23], s27 offen sc1
    v_mov_b32 v78, v11
    s_mov_b32 s8, s76
    s_mov_b32 s9, s77
    s_mov_b32 s10, 2621440
    s_mov_b32 s11, 0x20000
    v_add_u32 v8, 0, v2
    v_mul_u32_u24 v9, 6554, v8
    v_lshrrev_b32 v9, 16, v9
    v_mul_u32_u24 v116, 10, v9
    v_sub_u32 v116, v8, v116
    v_lshlrev_b32 v116, 4, v116
    v_mul_u32_u24 v9, 1280, v9
    v_add_u32 v116, v116, v9
    v_add_u32 v8, 64, v2
    v_mul_u32_u24 v9, 6554, v8
    v_lshrrev_b32 v9, 16, v9
    v_mul_u32_u24 v117, 10, v9
    v_sub_u32 v117, v8, v117
    v_lshlrev_b32 v117, 4, v117
    v_mul_u32_u24 v9, 1280, v9
    v_add_u32 v117, v117, v9
    v_add_u32 v8, 128, v2
    v_mul_u32_u24 v9, 6554, v8
    v_lshrrev_b32 v9, 16, v9
    v_mul_u32_u24 v118, 10, v9
    v_sub_u32 v118, v8, v118
    v_lshlrev_b32 v118, 4, v118
    v_mul_u32_u24 v9, 1280, v9
    v_add_u32 v118, v118, v9
    v_add_u32 v9, 0x40000000, v118
    v_cmp_gt_u32 vcc, 32, v2
    s_nop 1
    v_cndmask_b32 v118, v9, v118, vcc
    s_lshl_b32 s44, s98, 6
    s_lshl_b32 s45, s14, 4
    s_add_u32 s44, s44, s45
    s_mul_i32 s28, s44, 1280
    s_mul_i32 s44, s15, 160
    s_add_u32 s28, s28, s44
    s_mul_i32 s29, s14, 3072
    s_add_u32 s29, s29, 61440
    v_and_b32 v8, 15, v2
    v_mul_u32_u24 v8, 160, v8
    v_lshrrev_b32 v9, 4, v2
    v_lshl_add_u32 v8, v9, 3, v8
    v_add_u32 v8, s29, v8
    v_add_u32 v9, s29, v5
    s_add_u32 s44, s14, 1
    s_and_b32 s44, s44, 3
    s_mul_i32 s44, s44, 15360
    s_add_u32 s44, s44, 0
    v_add_u32 v10, s44, v5
    s_add_u32 s44, s14, 2
    s_and_b32 s44, s44, 3
    s_mul_i32 s44, s44, 15360
    s_add_u32 s44, s44, 5120
    v_add_u32 v11, s44, v5
    s_add_u32 s44, s14, 3
    s_and_b32 s44, s44, 3
    s_mul_i32 s44, s44, 15360
    s_add_u32 s44, s44, 10240
    v_add_u32 v12, s44, v5
    s_mul_i32 s44, s14, 15360
    s_add_u32 s44, s44, 0
    v_add_u32 v13, s44, v5
    s_waitcnt vmcnt(8)
    v_mfma_f32_16x16x32_bf16 v[128:131], a[164:167], a[148:151], 0
    v_accvgpr_read_b32 v16, a112
    v_accvgpr_read_b32 v17, a113
    v_accvgpr_read_b32 v18, a114
    v_accvgpr_read_b32 v19, a115
    v_accvgpr_read_b32 v20, a116
    v_accvgpr_read_b32 v21, a117
    v_accvgpr_read_b32 v22, a118
    v_accvgpr_read_b32 v23, a119
    v_min_f32 v32, 0, v16
    v_min_f32 v33, 0, v17
    v_min_f32 v34, 0, v18
    v_min_f32 v35, 0, v19
    v_min_f32 v36, 0, v20
    v_min_f32 v37, 0, v21
    v_min_f32 v38, 0, v22
    v_min_f32 v39, 0, v23
    v_mul_f32 v32, s57, v32
    v_mul_f32 v33, s57, v33
    v_mul_f32 v34, s57, v34
    v_mul_f32 v35, s57, v35
    v_mfma_f32_16x16x32_bf16 v[132:135], a[168:171], a[148:151], 0
    s_add_u32 s100, s100, 1
    s_cmp_eq_u32 s100, 10
    s_cselect_b32 s100, 0, s100
    s_lshl_b32 s44, s100, 2
    s_add_u32 s44, s44, 16
    s_mul_i32 s45, s44, 5120
    s_lshl_b32 s44, s44, 10
    s_cmp_eq_u32 s100, 9
    s_cselect_b32 s101, s46, 0
    s_add_u32 s44, s44, s101
    s_add_u32 s45, s45, s101
    v_add_u32 v3, s44, v6
    v_add_u32 v4, s45, v7
    buffer_load_dwordx4 a[128:131], v4, s[20:23], s96 offen offset:0 sc1
    v_mul_f32 v36, s57, v36
    v_mul_f32 v37, s57, v37
    v_mul_f32 v38, s57, v38
    v_mul_f32 v39, s57, v39
    v_exp_f32 v32, v32
    v_exp_f32 v33, v33
    v_exp_f32 v34, v34
    v_exp_f32 v35, v35
    v_exp_f32 v36, v36
    v_exp_f32 v37, v37
    v_exp_f32 v38, v38
    v_exp_f32 v39, v39
    v_max_f32 v16, 0, v16
    v_max_f32 v17, 0, v17
    v_max_f32 v18, 0, v18
    v_max_f32 v19, 0, v19
    v_max_f32 v20, 0, v20
    v_max_f32 v21, 0, v21
    v_max_f32 v22, 0, v22
    v_max_f32 v23, 0, v23
    v_mfma_f32_16x16x32_bf16 v[136:139], a[172:175], a[148:151], 0
    v_add_f32 v16, s56, v16
    v_add_f32 v17, s56, v17
    v_add_f32 v18, s56, v18
    v_add_f32 v19, s56, v19
    v_add_f32 v20, s56, v20
    v_add_f32 v21, s56, v21
    v_add_f32 v22, s56, v22
    v_add_f32 v23, s56, v23
    v_add_f32 v16, v16, v32
    v_add_f32 v17, v17, v33
    v_add_f32 v18, v18, v34
    v_add_f32 v19, v19, v35
    v_add_f32 v20, v20, v36
    v_add_f32 v21, v21, v37
    v_add_f32 v22, v22, v38
    v_add_f32 v23, v23, v39
    v_cvt_pk_bf16_f32 v56, v16, v17
    v_cvt_pk_bf16_f32 v57, v18, v19
    v_cvt_pk_bf16_f32 v58, v20, v21
    v_cvt_pk_bf16_f32 v59, v22, v23
    v_mfma_f32_16x16x32_bf16 v[140:143], a[176:179], a[148:151], 0
    buffer_load_dwordx4 a[132:135], v4, s[20:23], s96 offen offset:1024 sc1
    v_accvgpr_read_b32 v16, a80
    v_accvgpr_read_b32 v17, a81
    v_accvgpr_read_b32 v18, a82
    v_accvgpr_read_b32 v19, a83
    v_accvgpr_read_b32 v20, a84
    v_accvgpr_read_b32 v21, a85
    v_accvgpr_read_b32 v22, a86
    v_accvgpr_read_b32 v23, a87
    v_accvgpr_read_b32 v24, a88
    v_accvgpr_read_b32 v25, a89
    v_accvgpr_read_b32 v26, a90
    v_accvgpr_read_b32 v27, a91
    v_accvgpr_read_b32 v28, a92
    v_accvgpr_read_b32 v29, a93
    v_accvgpr_read_b32 v30, a94
    v_accvgpr_read_b32 v31, a95
    v_min_f32 v32, 0, v16
    v_min_f32 v33, 0, v17
    v_min_f32 v34, 0, v18
    v_min_f32 v35, 0, v19
    v_mfma_f32_16x16x32_bf16 v[144:147], a[180:183], a[148:151], 0
    v_min_f32 v36, 0, v20
    v_min_f32 v37, 0, v21
    v_min_f32 v38, 0, v22
    v_min_f32 v39, 0, v23
    v_mul_f32 v32, s57, v32
    v_mul_f32 v33, s57, v33
    v_mul_f32 v34, s57, v34
    v_mul_f32 v35, s57, v35
    v_mul_f32 v36, s57, v36
    v_mul_f32 v37, s57, v37
    v_mul_f32 v38, s57, v38
    v_mul_f32 v39, s57, v39
    v_exp_f32 v32, v32
    v_exp_f32 v33, v33
    v_exp_f32 v34, v34
    v_exp_f32 v35, v35
    v_exp_f32 v36, v36
    v_exp_f32 v37, v37
    v_exp_f32 v38, v38
    v_exp_f32 v39, v39
    v_mfma_f32_16x16x32_bf16 v[148:151], a[164:167], a[152:155], 0
    buffer_load_dwordx4 a[136:139], v4, s[20:23], s96 offen offset:2048 sc1
    v_max_f32 v16, 0, v16
    v_max_f32 v17, 0, v17
    v_max_f32 v18, 0, v18
    v_max_f32 v19, 0, v19
    v_max_f32 v20, 0, v20
    v_max_f32 v21, 0, v21
    v_max_f32 v22, 0, v22
    v_max_f32 v23, 0, v23
    v_add_f32 v16, s56, v16
    v_add_f32 v17, s56, v17
    v_add_f32 v18, s56, v18
    v_add_f32 v19, s56, v19
    v_add_f32 v20, s56, v20
    v_add_f32 v21, s56, v21
    v_add_f32 v22, s56, v22
    v_add_f32 v23, s56, v23
    v_add_f32 v16, v16, v32
    v_add_f32 v17, v17, v33
    v_add_f32 v18, v18, v34
    v_add_f32 v19, v19, v35
    v_mfma_f32_16x16x32_bf16 v[152:155], a[168:171], a[152:155], 0
    v_add_f32 v20, v20, v36
    v_add_f32 v21, v21, v37
    v_add_f32 v22, v22, v38
    v_add_f32 v23, v23, v39
    v_min_f32 v32, 0, v24
    v_min_f32 v33, 0, v25
    v_min_f32 v34, 0, v26
    v_min_f32 v35, 0, v27
    v_min_f32 v36, 0, v28
    v_min_f32 v37, 0, v29
    v_min_f32 v38, 0, v30
    v_min_f32 v39, 0, v31
    v_mul_f32 v32, s57, v32
    v_mul_f32 v33, s57, v33
    v_mul_f32 v34, s57, v34
    v_mul_f32 v35, s57, v35
    v_mul_f32 v36, s57, v36
    v_mul_f32 v37, s57, v37
    v_mul_f32 v38, s57, v38
    v_mul_f32 v39, s57, v39
    v_mfma_f32_16x16x32_bf16 v[156:159], a[172:175], a[152:155], 0
    buffer_load_dwordx4 a[140:143], v4, s[20:23], s96 offen offset:3072 sc1
    v_exp_f32 v32, v32
    v_exp_f32 v33, v33
    v_exp_f32 v34, v34
    v_exp_f32 v35, v35
    v_exp_f32 v36, v36
    v_exp_f32 v37, v37
    v_exp_f32 v38, v38
    v_exp_f32 v39, v39
    v_max_f32 v24, 0, v24
    v_max_f32 v25, 0, v25
    v_max_f32 v26, 0, v26
    v_max_f32 v27, 0, v27
    v_max_f32 v28, 0, v28
    v_max_f32 v29, 0, v29
    v_max_f32 v30, 0, v30
    v_max_f32 v31, 0, v31
    v_add_f32 v24, s56, v24
    v_add_f32 v25, s56, v25
    v_add_f32 v26, s56, v26
    v_add_f32 v27, s56, v27
    v_mfma_f32_16x16x32_bf16 v[160:163], a[176:179], a[152:155], 0
    v_add_f32 v28, s56, v28
    v_add_f32 v29, s56, v29
    v_add_f32 v30, s56, v30
    v_add_f32 v31, s56, v31
    v_add_f32 v24, v24, v32
    v_add_f32 v25, v25, v33
    v_add_f32 v26, v26, v34
    v_add_f32 v27, v27, v35
    v_add_f32 v28, v28, v36
    v_add_f32 v29, v29, v37
    v_add_f32 v30, v30, v38
    v_add_f32 v31, v31, v39
    v_cvt_pk_bf16_f32 v40, v16, v17
    v_cvt_pk_bf16_f32 v41, v18, v19
    v_cvt_pk_bf16_f32 v42, v20, v21
    v_cvt_pk_bf16_f32 v43, v22, v23
    v_cvt_pk_bf16_f32 v44, v24, v25
    v_cvt_pk_bf16_f32 v45, v26, v27
    v_cvt_pk_bf16_f32 v46, v28, v29
    v_cvt_pk_bf16_f32 v47, v30, v31
    v_mfma_f32_16x16x32_bf16 v[164:167], a[180:183], a[152:155], 0
    buffer_load_dwordx4 a[144:147], v4, s[20:23], s97 offen offset:0 sc1
    v_accvgpr_read_b32 v16, a96
    v_accvgpr_read_b32 v17, a97
    v_accvgpr_read_b32 v18, a98
    v_accvgpr_read_b32 v19, a99
    v_accvgpr_read_b32 v20, a100
    v_accvgpr_read_b32 v21, a101
    v_accvgpr_read_b32 v22, a102
    v_accvgpr_read_b32 v23, a103
    v_accvgpr_read_b32 v24, a104
    v_accvgpr_read_b32 v25, a105
    v_accvgpr_read_b32 v26, a106
    v_accvgpr_read_b32 v27, a107
    v_accvgpr_read_b32 v28, a108
    v_accvgpr_read_b32 v29, a109
    v_accvgpr_read_b32 v30, a110
    v_accvgpr_read_b32 v31, a111
    v_min_f32 v32, 0, v16
    v_min_f32 v33, 0, v17
    v_min_f32 v34, 0, v18
    v_min_f32 v35, 0, v19
    v_mfma_f32_16x16x32_bf16 v[168:171], a[164:167], a[156:159], 0
    v_min_f32 v36, 0, v20
    v_min_f32 v37, 0, v21
    v_min_f32 v38, 0, v22
    v_min_f32 v39, 0, v23
    v_mul_f32 v32, s57, v32
    v_mul_f32 v33, s57, v33
    v_mul_f32 v34, s57, v34
    v_mul_f32 v35, s57, v35
    v_mul_f32 v36, s57, v36
    v_mul_f32 v37, s57, v37
    v_mul_f32 v38, s57, v38
    v_mul_f32 v39, s57, v39
    v_exp_f32 v32, v32
    v_exp_f32 v33, v33
    v_exp_f32 v34, v34
    v_exp_f32 v35, v35
    v_exp_f32 v36, v36
    v_exp_f32 v37, v37
    v_exp_f32 v38, v38
    v_exp_f32 v39, v39
    v_mfma_f32_16x16x32_bf16 v[172:175], a[168:171], a[156:159], 0
    buffer_load_dwordx4 a[112:115], v3, s[20:23], s24 offen sc1
    v_max_f32 v16, 0, v16
    v_max_f32 v17, 0, v17
    v_max_f32 v18, 0, v18
    v_max_f32 v19, 0, v19
    v_max_f32 v20, 0, v20
    v_max_f32 v21, 0, v21
    v_max_f32 v22, 0, v22
    v_max_f32 v23, 0, v23
    v_add_f32 v16, s56, v16
    v_add_f32 v17, s56, v17
    v_add_f32 v18, s56, v18
    v_add_f32 v19, s56, v19
    v_add_f32 v20, s56, v20
    v_add_f32 v21, s56, v21
    v_add_f32 v22, s56, v22
    v_add_f32 v23, s56, v23
    v_add_f32 v16, v16, v32
    v_add_f32 v17, v17, v33
    v_add_f32 v18, v18, v34
    v_add_f32 v19, v19, v35
    v_mfma_f32_16x16x32_bf16 v[176:179], a[172:175], a[156:159], 0
    v_add_f32 v20, v20, v36
    v_add_f32 v21, v21, v37
    v_add_f32 v22, v22, v38
    v_add_f32 v23, v23, v39
    v_min_f32 v32, 0, v24
    v_min_f32 v33, 0, v25
    v_min_f32 v34, 0, v26
    v_min_f32 v35, 0, v27
    v_min_f32 v36, 0, v28
    v_min_f32 v37, 0, v29
    v_min_f32 v38, 0, v30
    v_min_f32 v39, 0, v31
    v_mul_f32 v32, s57, v32
    v_mul_f32 v33, s57, v33
    v_mul_f32 v34, s57, v34
    v_mul_f32 v35, s57, v35
    v_mul_f32 v36, s57, v36
    v_mul_f32 v37, s57, v37
    v_mul_f32 v38, s57, v38
    v_mul_f32 v39, s57, v39
    v_mfma_f32_16x16x32_bf16 v[180:183], a[176:179], a[156:159], 0
    buffer_load_dwordx4 a[116:119], v3, s[20:23], s25 offen sc1
    v_exp_f32 v32, v32
    v_exp_f32 v33, v33
    v_exp_f32 v34, v34
    v_exp_f32 v35, v35
    v_exp_f32 v36, v36
    v_exp_f32 v37, v37
    v_exp_f32 v38, v38
    v_exp_f32 v39, v39
    v_max_f32 v24, 0, v24
    v_max_f32 v25, 0, v25
    v_max_f32 v26, 0, v26
    v_max_f32 v27, 0, v27
    v_max_f32 v28, 0, v28
    v_max_f32 v29, 0, v29
    v_max_f32 v30, 0, v30
    v_max_f32 v31, 0, v31
    v_add_f32 v24, s56, v24
    v_add_f32 v25, s56, v25
    v_add_f32 v26, s56, v26
    v_add_f32 v27, s56, v27
    v_mfma_f32_16x16x32_bf16 v[184:187], a[180:183], a[156:159], 0
    v_add_f32 v28, s56, v28
    v_add_f32 v29, s56, v29
    v_add_f32 v30, s56, v30
    v_add_f32 v31, s56, v31
    v_add_f32 v24, v24, v32
    v_add_f32 v25, v25, v33
    v_add_f32 v26, v26, v34
    v_add_f32 v27, v27, v35
    v_add_f32 v28, v28, v36
    v_add_f32 v29, v29, v37
    v_add_f32 v30, v30, v38
    v_add_f32 v31, v31, v39
    v_cvt_pk_bf16_f32 v48, v16, v17
    v_cvt_pk_bf16_f32 v49, v18, v19
    v_cvt_pk_bf16_f32 v50, v20, v21
    v_cvt_pk_bf16_f32 v51, v22, v23
    v_cvt_pk_bf16_f32 v52, v24, v25
    v_cvt_pk_bf16_f32 v53, v26, v27
    v_cvt_pk_bf16_f32 v54, v28, v29
    v_cvt_pk_bf16_f32 v55, v30, v31
    v_mfma_f32_16x16x32_bf16 v[188:191], a[164:167], a[160:163], 0
    buffer_load_dwordx4 a[120:123], v3, s[20:23], s26 offen sc1
    v_mfma_f32_16x16x32_bf16 v[192:195], a[168:171], a[160:163], 0
    v_mfma_f32_16x16x32_bf16 v[196:199], a[172:175], a[160:163], 0
    buffer_load_dwordx4 a[124:127], v3, s[20:23], s27 offen sc1
    v_mfma_f32_16x16x32_bf16 v[200:203], a[176:179], a[160:163], 0
    v_mfma_f32_16x16x32_bf16 v[204:207], a[180:183], a[160:163], 0
    s_cmp_lg_u32 s14, 0
    s_cbranch_scc1 parallel_sum__linear_attn_block__dense_activation_relu__prompt_kernel_b_kvp_pre
    s_lshl_b32 s40, s15, 7
    s_add_u32 s40, s40, 15564800
    v_mov_b32 v111, s40
    s_mov_b64 exec, 1
    buffer_load_dword v110, v111, s[20:23], 0 offen sc0 sc1
    s_mov_b64 exec, -1
parallel_sum__linear_attn_block__dense_activation_relu__prompt_kernel_b_kvp_pre:
    s_waitcnt vmcnt(13)
    v_mfma_f32_16x16x32_bf16 v[128:131], a[200:203], a[184:187], v[128:131]
    v_mfma_f32_16x16x32_bf16 v[132:135], a[204:207], a[184:187], v[132:135]
    s_add_u32 s100, s100, 1
    s_cmp_eq_u32 s100, 10
    s_cselect_b32 s100, 0, s100
    s_lshl_b32 s44, s100, 2
    s_add_u32 s44, s44, 16
    s_mul_i32 s45, s44, 5120
    s_lshl_b32 s44, s44, 10
    s_cmp_eq_u32 s100, 9
    s_cselect_b32 s101, s46, 0
    s_add_u32 s44, s44, s101
    s_add_u32 s45, s45, s101
    v_add_u32 v3, s44, v6
    v_add_u32 v4, s45, v7
    buffer_load_dwordx4 a[164:167], v4, s[20:23], s96 offen offset:0 sc1
    v_mfma_f32_16x16x32_bf16 v[136:139], a[208:211], a[184:187], v[136:139]
    v_mfma_f32_16x16x32_bf16 v[140:143], a[212:215], a[184:187], v[140:143]
    buffer_load_dwordx4 a[168:171], v4, s[20:23], s96 offen offset:1024 sc1
    v_mfma_f32_16x16x32_bf16 v[144:147], a[216:219], a[184:187], v[144:147]
    v_mfma_f32_16x16x32_bf16 v[148:151], a[200:203], a[188:191], v[148:151]
    buffer_load_dwordx4 a[172:175], v4, s[20:23], s96 offen offset:2048 sc1
    v_mfma_f32_16x16x32_bf16 v[152:155], a[204:207], a[188:191], v[152:155]
    v_mfma_f32_16x16x32_bf16 v[156:159], a[208:211], a[188:191], v[156:159]
    buffer_load_dwordx4 a[176:179], v4, s[20:23], s96 offen offset:3072 sc1
    v_mfma_f32_16x16x32_bf16 v[160:163], a[212:215], a[188:191], v[160:163]
    v_mfma_f32_16x16x32_bf16 v[164:167], a[216:219], a[188:191], v[164:167]
    buffer_load_dwordx4 a[180:183], v4, s[20:23], s97 offen offset:0 sc1
    v_mfma_f32_16x16x32_bf16 v[168:171], a[200:203], a[192:195], v[168:171]
    v_mfma_f32_16x16x32_bf16 v[172:175], a[204:207], a[192:195], v[172:175]
    buffer_load_dwordx4 a[148:151], v3, s[20:23], s24 offen sc1
    v_mfma_f32_16x16x32_bf16 v[176:179], a[208:211], a[192:195], v[176:179]
    v_mfma_f32_16x16x32_bf16 v[180:183], a[212:215], a[192:195], v[180:183]
    buffer_load_dwordx4 a[152:155], v3, s[20:23], s25 offen sc1
    v_mfma_f32_16x16x32_bf16 v[184:187], a[216:219], a[192:195], v[184:187]
    v_mfma_f32_16x16x32_bf16 v[188:191], a[200:203], a[196:199], v[188:191]
    buffer_load_dwordx4 a[156:159], v3, s[20:23], s26 offen sc1
    v_mfma_f32_16x16x32_bf16 v[192:195], a[204:207], a[196:199], v[192:195]
    v_mfma_f32_16x16x32_bf16 v[196:199], a[208:211], a[196:199], v[196:199]
    buffer_load_dwordx4 a[160:163], v3, s[20:23], s27 offen sc1
    v_mfma_f32_16x16x32_bf16 v[200:203], a[212:215], a[196:199], v[200:203]
    v_mfma_f32_16x16x32_bf16 v[204:207], a[216:219], a[196:199], v[204:207]
    s_cmp_lg_u32 s14, 0
    s_cbranch_scc1 parallel_sum__linear_attn_block__dense_activation_relu__prompt_kernel_b_kv_ok
    v_mov_b32 v106, 16
    s_mov_b64 exec, 1
    s_waitcnt vmcnt(9)
    v_cmp_ge_u32 vcc, v110, v106
    s_nop 3
    s_cmp_eq_u64 vcc, 1
    s_cbranch_scc1 parallel_sum__linear_attn_block__dense_activation_relu__prompt_kernel_b_kv_done
    s_mov_b32 s42, 0
parallel_sum__linear_attn_block__dense_activation_relu__prompt_kernel_b_kv_spin:
    buffer_load_dword v110, v111, s[20:23], 0 offen sc0 sc1
    s_waitcnt vmcnt(0)
    v_cmp_ge_u32 vcc, v110, v106
    s_add_u32 s42, s42, 1
    s_cmp_ge_u32 s42, 0x40000
    s_cbranch_scc1 parallel_sum__linear_attn_block__dense_activation_relu__prompt_kernel_b_kv_done
    s_nop 0
    s_cmp_eq_u64 vcc, 1
    s_cbranch_scc0 parallel_sum__linear_attn_block__dense_activation_relu__prompt_kernel_b_kv_spin
parallel_sum__linear_attn_block__dense_activation_relu__prompt_kernel_b_kv_done:
    s_mov_b64 exec, -1
parallel_sum__linear_attn_block__dense_activation_relu__prompt_kernel_b_kv_ok:
    s_barrier
    v_lshlrev_b32 v60, 4, v0
    s_add_u32 s42, s58, 4096
    buffer_load_dwordx4 v[64:67], v60, s[20:23], s58 offen sc0 sc1
    buffer_load_dwordx4 v[68:71], v60, s[20:23], s42 offen sc0 sc1
    s_waitcnt vmcnt(20)
    v_mfma_f32_16x16x32_bf16 v[128:131], a[236:239], a[220:223], v[128:131]
    s_waitcnt vmcnt(1)
    ds_write_b128 v91, v[64:67]
    ds_write_b128 v92, v[64:67]
    s_waitcnt vmcnt(0)
    ds_write_b128 v93, v[68:71]
    ds_write_b128 v94, v[68:71]
    s_waitcnt lgkmcnt(0)
    s_barrier
    ds_read_b128 v[16:19], v90 offset:0
    ds_read_b128 v[20:23], v90 offset:32
    ds_read_b128 v[24:27], v90 offset:64
    ds_read_b128 v[28:31], v90 offset:96
    ds_read_b128 v[80:83], v90 offset:128
    ds_read_b128 v[84:87], v90 offset:160
    ds_read_b128 v[120:123], v90 offset:10816
    ds_read_b128 v[124:127], v90 offset:10848
    s_waitcnt lgkmcnt(6)
    v_cvt_pk_bf16_f32 v32, v16, v17
    v_cvt_pk_bf16_f32 v33, v18, v19
    v_cvt_pk_bf16_f32 v34, v20, v21
    v_cvt_pk_bf16_f32 v35, v22, v23
    ds_read_b128 v[16:19], v90 offset:10880
    ds_read_b128 v[20:23], v90 offset:10912
    v_mfma_f32_32x32x16_bf16 v[208:223], v[32:35], v[40:43], 0
    s_waitcnt lgkmcnt(6)
    v_cvt_pk_bf16_f32 v36, v24, v25
    v_cvt_pk_bf16_f32 v37, v26, v27
    v_cvt_pk_bf16_f32 v38, v28, v29
    v_cvt_pk_bf16_f32 v39, v30, v31
    v_mfma_f32_16x16x32_bf16 v[132:135], a[240:243], a[220:223], v[132:135]
    s_add_u32 s100, s100, 1
    s_cmp_eq_u32 s100, 10
    s_cselect_b32 s100, 0, s100
    s_lshl_b32 s44, s100, 2
    s_add_u32 s44, s44, 16
    s_mul_i32 s45, s44, 5120
    s_lshl_b32 s44, s44, 10
    s_cmp_eq_u32 s100, 9
    s_cselect_b32 s101, s46, 0
    s_add_u32 s44, s44, s101
    s_add_u32 s45, s45, s101
    v_add_u32 v3, s44, v6
    v_add_u32 v4, s45, v7
    buffer_load_dwordx4 a[200:203], v4, s[20:23], s96 offen offset:0 sc1
    ds_read_b128 v[24:27], v90 offset:10944
    ds_read_b128 v[28:31], v90 offset:10976
    v_mfma_f32_32x32x16_bf16 v[208:223], v[36:39], v[44:47], v[208:223]
    s_waitcnt lgkmcnt(6)
    v_cvt_pk_bf16_f32 v32, v80, v81
    v_cvt_pk_bf16_f32 v33, v82, v83
    v_cvt_pk_bf16_f32 v34, v84, v85
    v_cvt_pk_bf16_f32 v35, v86, v87
    ds_read_b128 v[80:83], v90 offset:11008
    ds_read_b128 v[84:87], v90 offset:11040
    v_mfma_f32_32x32x16_bf16 v[208:223], v[32:35], v[48:51], v[208:223]
    s_waitcnt lgkmcnt(6)
    v_cvt_pk_bf16_f32 v36, v120, v121
    v_cvt_pk_bf16_f32 v37, v122, v123
    v_cvt_pk_bf16_f32 v38, v124, v125
    v_cvt_pk_bf16_f32 v39, v126, v127
    ds_read_b128 v[120:123], v90 offset:21504
    ds_read_b128 v[124:127], v90 offset:21536
    v_mfma_f32_32x32x16_bf16 v[224:239], v[36:39], v[44:47], 0
    s_waitcnt lgkmcnt(6)
    v_cvt_pk_bf16_f32 v32, v16, v17
    v_cvt_pk_bf16_f32 v33, v18, v19
    v_cvt_pk_bf16_f32 v34, v20, v21
    v_cvt_pk_bf16_f32 v35, v22, v23
    v_mfma_f32_16x16x32_bf16 v[136:139], a[244:247], a[220:223], v[136:139]
    ds_read_b128 v[16:19], v90 offset:21568
    ds_read_b128 v[20:23], v90 offset:21600
    v_mfma_f32_32x32x16_bf16 v[224:239], v[32:35], v[48:51], v[224:239]
    s_waitcnt lgkmcnt(6)
    v_cvt_pk_bf16_f32 v36, v24, v25
    v_cvt_pk_bf16_f32 v37, v26, v27
    v_cvt_pk_bf16_f32 v38, v28, v29
    v_cvt_pk_bf16_f32 v39, v30, v31
    ds_read_b128 v[24:27], v90 offset:21632
    ds_read_b128 v[28:31], v90 offset:21664
    v_mfma_f32_32x32x16_bf16 v[224:239], v[36:39], v[52:55], v[224:239]
    s_waitcnt lgkmcnt(6)
    v_cvt_pk_bf16_f32 v32, v80, v81
    v_cvt_pk_bf16_f32 v33, v82, v83
    v_cvt_pk_bf16_f32 v34, v84, v85
    v_cvt_pk_bf16_f32 v35, v86, v87
    ds_read_b128 v[80:83], v90 offset:21696
    ds_read_b128 v[84:87], v90 offset:21728
    v_mfma_f32_32x32x16_bf16 v[224:239], v[32:35], v[56:59], v[224:239]
    s_waitcnt lgkmcnt(6)
    v_cvt_pk_bf16_f32 v36, v120, v121
    v_cvt_pk_bf16_f32 v37, v122, v123
    v_cvt_pk_bf16_f32 v38, v124, v125
    v_cvt_pk_bf16_f32 v39, v126, v127
    v_mfma_f32_16x16x32_bf16 v[140:143], a[248:251], a[220:223], v[140:143]
    buffer_load_dwordx4 a[204:207], v4, s[20:23], s96 offen offset:1024 sc1
    ds_read_b128 v[120:123], v90 offset:21760
    ds_read_b128 v[124:127], v90 offset:21792
    v_mfma_f32_32x32x16_bf16 v[240:255], v[36:39], v[40:43], 0
    s_waitcnt lgkmcnt(6)
    v_cvt_pk_bf16_f32 v32, v16, v17
    v_cvt_pk_bf16_f32 v33, v18, v19
    v_cvt_pk_bf16_f32 v34, v20, v21
    v_cvt_pk_bf16_f32 v35, v22, v23
    s_nop 1
    v_mfma_f32_32x32x16_bf16 v[240:255], v[32:35], v[44:47], v[240:255]
    s_waitcnt lgkmcnt(4)
    v_cvt_pk_bf16_f32 v36, v24, v25
    v_cvt_pk_bf16_f32 v37, v26, v27
    v_cvt_pk_bf16_f32 v38, v28, v29
    v_cvt_pk_bf16_f32 v39, v30, v31
    s_nop 1
    v_mfma_f32_32x32x16_bf16 v[240:255], v[36:39], v[48:51], v[240:255]
    s_waitcnt lgkmcnt(2)
    v_cvt_pk_bf16_f32 v32, v80, v81
    v_cvt_pk_bf16_f32 v33, v82, v83
    v_cvt_pk_bf16_f32 v34, v84, v85
    v_cvt_pk_bf16_f32 v35, v86, v87
    s_nop 1
    v_mfma_f32_32x32x16_bf16 v[240:255], v[32:35], v[52:55], v[240:255]
    s_waitcnt lgkmcnt(0)
    v_cvt_pk_bf16_f32 v36, v120, v121
    v_cvt_pk_bf16_f32 v37, v122, v123
    v_cvt_pk_bf16_f32 v38, v124, v125
    v_cvt_pk_bf16_f32 v39, v126, v127
    v_mfma_f32_16x16x32_bf16 v[144:147], a[252:255], a[220:223], v[144:147]
    s_nop 0
    v_mfma_f32_32x32x16_bf16 v[240:255], v[36:39], v[56:59], v[240:255]
    s_nop 11
    v_add_f32 v72, s56, v248
    v_add_f32 v73, s56, v249
    v_add_f32 v74, s56, v250
    v_add_f32 v75, s56, v251
    v_rcp_f32 v72, v72
    v_rcp_f32 v73, v73
    v_rcp_f32 v74, v74
    v_rcp_f32 v75, v75
    v_cndmask_b32 v76, v72, v73, s[60:61]
    v_cndmask_b32 v77, v74, v75, s[60:61]
    v_mul_f32 v208, v208, v72
    v_mul_f32 v209, v209, v72
    v_mul_f32 v210, v210, v72
    v_mul_f32 v211, v211, v72
    v_mul_f32 v212, v212, v72
    v_mul_f32 v213, v213, v72
    v_mul_f32 v214, v214, v72
    v_mul_f32 v215, v215, v72
    v_cvt_pk_bf16_f32 v208, v208, v209
    v_mfma_f32_16x16x32_bf16 v[148:151], a[236:239], a[224:227], v[148:151]
    buffer_load_dwordx4 a[208:211], v4, s[20:23], s96 offen offset:2048 sc1
    v_cvt_pk_bf16_f32 v209, v210, v211
    v_cvt_pk_bf16_f32 v210, v212, v213
    v_cvt_pk_bf16_f32 v211, v214, v215
    buffer_store_dwordx4 v[208:211], v78, s[20:23], s50 offen sc1
    v_mul_f32 v216, v216, v76
    v_mul_f32 v217, v217, v76
    v_mul_f32 v218, v218, v76
    v_mul_f32 v219, v219, v76
    v_mul_f32 v220, v220, v73
    v_mul_f32 v221, v221, v73
    v_mul_f32 v222, v222, v73
    v_mul_f32 v223, v223, v73
    v_cvt_pk_bf16_f32 v216, v216, v217
    v_cvt_pk_bf16_f32 v217, v218, v219
    v_cvt_pk_bf16_f32 v218, v220, v221
    v_cvt_pk_bf16_f32 v219, v222, v223
    buffer_store_dwordx4 v[216:219], v78, s[20:23], s51 offen sc1
    v_mul_f32 v224, v224, v73
    v_mul_f32 v225, v225, v73
    v_mul_f32 v226, v226, v73
    v_mfma_f32_16x16x32_bf16 v[152:155], a[240:243], a[224:227], v[152:155]
    v_mul_f32 v227, v227, v73
    v_mul_f32 v228, v228, v74
    v_mul_f32 v229, v229, v74
    v_mul_f32 v230, v230, v74
    v_mul_f32 v231, v231, v74
    v_cvt_pk_bf16_f32 v224, v224, v225
    v_cvt_pk_bf16_f32 v225, v226, v227
    v_cvt_pk_bf16_f32 v226, v228, v229
    v_cvt_pk_bf16_f32 v227, v230, v231
    buffer_store_dwordx4 v[224:227], v78, s[20:23], s52 offen sc1
    v_mul_f32 v232, v232, v74
    v_mul_f32 v233, v233, v74
    v_mul_f32 v234, v234, v74
    v_mul_f32 v235, v235, v74
    v_mul_f32 v236, v236, v77
    v_mul_f32 v237, v237, v77
    v_mul_f32 v238, v238, v77
    v_mul_f32 v239, v239, v77
    v_cvt_pk_bf16_f32 v232, v232, v233
    v_cvt_pk_bf16_f32 v233, v234, v235
    v_mfma_f32_16x16x32_bf16 v[156:159], a[244:247], a[224:227], v[156:159]
    buffer_load_dwordx4 a[212:215], v4, s[20:23], s96 offen offset:3072 sc1
    v_cvt_pk_bf16_f32 v234, v236, v237
    v_cvt_pk_bf16_f32 v235, v238, v239
    buffer_store_dwordx4 v[232:235], v78, s[20:23], s53 offen sc1
    v_mul_f32 v240, v240, v75
    v_mul_f32 v241, v241, v75
    v_mul_f32 v242, v242, v75
    v_mul_f32 v243, v243, v75
    v_mul_f32 v244, v244, v75
    v_mul_f32 v245, v245, v75
    v_mul_f32 v246, v246, v75
    v_mul_f32 v247, v247, v75
    v_cvt_pk_bf16_f32 v240, v240, v241
    v_cvt_pk_bf16_f32 v241, v242, v243
    v_cvt_pk_bf16_f32 v242, v244, v245
    v_cvt_pk_bf16_f32 v243, v246, v247
    buffer_store_dwordx4 v[240:243], v78, s[20:23], s54 offen sc1
    v_mfma_f32_16x16x32_bf16 v[160:163], a[248:251], a[224:227], v[160:163]
    v_mfma_f32_16x16x32_bf16 v[164:167], a[252:255], a[224:227], v[164:167]
    buffer_load_dwordx4 a[216:219], v4, s[20:23], s97 offen offset:0 sc1
    v_mfma_f32_16x16x32_bf16 v[168:171], a[236:239], a[228:231], v[168:171]
    v_mfma_f32_16x16x32_bf16 v[172:175], a[240:243], a[228:231], v[172:175]
    buffer_load_dwordx4 a[184:187], v3, s[20:23], s24 offen sc1
    v_mfma_f32_16x16x32_bf16 v[176:179], a[244:247], a[228:231], v[176:179]
    v_mfma_f32_16x16x32_bf16 v[180:183], a[248:251], a[228:231], v[180:183]
    buffer_load_dwordx4 a[188:191], v3, s[20:23], s25 offen sc1
    v_mfma_f32_16x16x32_bf16 v[184:187], a[252:255], a[228:231], v[184:187]
    v_mfma_f32_16x16x32_bf16 v[188:191], a[236:239], a[232:235], v[188:191]
    buffer_load_dwordx4 a[192:195], v3, s[20:23], s26 offen sc1
    v_mfma_f32_16x16x32_bf16 v[192:195], a[240:243], a[232:235], v[192:195]
    v_mfma_f32_16x16x32_bf16 v[196:199], a[244:247], a[232:235], v[196:199]
    buffer_load_dwordx4 a[196:199], v3, s[20:23], s27 offen sc1
    v_mfma_f32_16x16x32_bf16 v[200:203], a[248:251], a[232:235], v[200:203]
    v_mfma_f32_16x16x32_bf16 v[204:207], a[252:255], a[232:235], v[204:207]
    v_mfma_f32_16x16x32_bf16 v[128:131], a[128:131], a[112:115], v[128:131]
    v_mfma_f32_16x16x32_bf16 v[132:135], a[132:135], a[112:115], v[132:135]
    s_add_u32 s100, s100, 1
    s_cmp_eq_u32 s100, 10
    s_cselect_b32 s100, 0, s100
    s_lshl_b32 s44, s100, 2
    s_add_u32 s44, s44, 16
    s_mul_i32 s45, s44, 5120
    s_lshl_b32 s44, s44, 10
    s_cmp_eq_u32 s100, 9
    s_cselect_b32 s101, s46, 0
    s_add_u32 s44, s44, s101
    s_add_u32 s45, s45, s101
    v_add_u32 v3, s44, v6
    v_add_u32 v4, s45, v7
    buffer_load_dwordx4 a[236:239], v4, s[20:23], s96 offen offset:0 sc1
    v_mfma_f32_16x16x32_bf16 v[136:139], a[136:139], a[112:115], v[136:139]
    v_mfma_f32_16x16x32_bf16 v[140:143], a[140:143], a[112:115], v[140:143]
    buffer_load_dwordx4 a[240:243], v4, s[20:23], s96 offen offset:1024 sc1
    v_mfma_f32_16x16x32_bf16 v[144:147], a[144:147], a[112:115], v[144:147]
    v_mfma_f32_16x16x32_bf16 v[148:151], a[128:131], a[116:119], v[148:151]
    buffer_load_dwordx4 a[244:247], v4, s[20:23], s96 offen offset:2048 sc1
    v_mfma_f32_16x16x32_bf16 v[152:155], a[132:135], a[116:119], v[152:155]
    v_mfma_f32_16x16x32_bf16 v[156:159], a[136:139], a[116:119], v[156:159]
    buffer_load_dwordx4 a[248:251], v4, s[20:23], s96 offen offset:3072 sc1
    v_mfma_f32_16x16x32_bf16 v[160:163], a[140:143], a[116:119], v[160:163]
    v_mfma_f32_16x16x32_bf16 v[164:167], a[144:147], a[116:119], v[164:167]
    buffer_load_dwordx4 a[252:255], v4, s[20:23], s97 offen offset:0 sc1
    v_mfma_f32_16x16x32_bf16 v[168:171], a[128:131], a[120:123], v[168:171]
    v_mfma_f32_16x16x32_bf16 v[172:175], a[132:135], a[120:123], v[172:175]
    buffer_load_dwordx4 a[220:223], v3, s[20:23], s24 offen sc1
    v_mfma_f32_16x16x32_bf16 v[176:179], a[136:139], a[120:123], v[176:179]
    v_mfma_f32_16x16x32_bf16 v[180:183], a[140:143], a[120:123], v[180:183]
    buffer_load_dwordx4 a[224:227], v3, s[20:23], s25 offen sc1
    v_mfma_f32_16x16x32_bf16 v[184:187], a[144:147], a[120:123], v[184:187]
    v_mfma_f32_16x16x32_bf16 v[188:191], a[128:131], a[124:127], v[188:191]
    buffer_load_dwordx4 a[228:231], v3, s[20:23], s26 offen sc1
    v_mfma_f32_16x16x32_bf16 v[192:195], a[132:135], a[124:127], v[192:195]
    v_mfma_f32_16x16x32_bf16 v[196:199], a[136:139], a[124:127], v[196:199]
    buffer_load_dwordx4 a[232:235], v3, s[20:23], s27 offen sc1
    v_mfma_f32_16x16x32_bf16 v[200:203], a[140:143], a[124:127], v[200:203]
    v_mfma_f32_16x16x32_bf16 v[204:207], a[144:147], a[124:127], v[204:207]
    v_mfma_f32_16x16x32_bf16 v[128:131], a[164:167], a[148:151], v[128:131]
    v_mfma_f32_16x16x32_bf16 v[132:135], a[168:171], a[148:151], v[132:135]
    s_add_u32 s100, s100, 1
    s_cmp_eq_u32 s100, 10
    s_cselect_b32 s100, 0, s100
    s_lshl_b32 s44, s100, 2
    s_add_u32 s44, s44, 16
    s_mul_i32 s45, s44, 5120
    s_lshl_b32 s44, s44, 10
    s_cmp_eq_u32 s100, 9
    s_cselect_b32 s101, s46, 0
    s_add_u32 s44, s44, s101
    s_add_u32 s45, s45, s101
    v_add_u32 v3, s44, v6
    v_add_u32 v4, s45, v7
    buffer_load_dwordx4 a[128:131], v4, s[20:23], s96 offen offset:0 sc1
    v_mfma_f32_16x16x32_bf16 v[136:139], a[172:175], a[148:151], v[136:139]
    v_mfma_f32_16x16x32_bf16 v[140:143], a[176:179], a[148:151], v[140:143]
    buffer_load_dwordx4 a[132:135], v4, s[20:23], s96 offen offset:1024 sc1
    v_mfma_f32_16x16x32_bf16 v[144:147], a[180:183], a[148:151], v[144:147]
    v_mfma_f32_16x16x32_bf16 v[148:151], a[164:167], a[152:155], v[148:151]
    buffer_load_dwordx4 a[136:139], v4, s[20:23], s96 offen offset:2048 sc1
    v_mfma_f32_16x16x32_bf16 v[152:155], a[168:171], a[152:155], v[152:155]
    v_mfma_f32_16x16x32_bf16 v[156:159], a[172:175], a[152:155], v[156:159]
    buffer_load_dwordx4 a[140:143], v4, s[20:23], s96 offen offset:3072 sc1
    v_mfma_f32_16x16x32_bf16 v[160:163], a[176:179], a[152:155], v[160:163]
    v_mfma_f32_16x16x32_bf16 v[164:167], a[180:183], a[152:155], v[164:167]
    buffer_load_dwordx4 a[144:147], v4, s[20:23], s97 offen offset:0 sc1
    v_mfma_f32_16x16x32_bf16 v[168:171], a[164:167], a[156:159], v[168:171]
    v_mfma_f32_16x16x32_bf16 v[172:175], a[168:171], a[156:159], v[172:175]
    buffer_load_dwordx4 a[112:115], v3, s[20:23], s24 offen sc1
    v_mfma_f32_16x16x32_bf16 v[176:179], a[172:175], a[156:159], v[176:179]
    v_mfma_f32_16x16x32_bf16 v[180:183], a[176:179], a[156:159], v[180:183]
    buffer_load_dwordx4 a[116:119], v3, s[20:23], s25 offen sc1
    v_mfma_f32_16x16x32_bf16 v[184:187], a[180:183], a[156:159], v[184:187]
    v_mfma_f32_16x16x32_bf16 v[188:191], a[164:167], a[160:163], v[188:191]
    buffer_load_dwordx4 a[120:123], v3, s[20:23], s26 offen sc1
    v_mfma_f32_16x16x32_bf16 v[192:195], a[168:171], a[160:163], v[192:195]
    v_mfma_f32_16x16x32_bf16 v[196:199], a[172:175], a[160:163], v[196:199]
    buffer_load_dwordx4 a[124:127], v3, s[20:23], s27 offen sc1
    v_mfma_f32_16x16x32_bf16 v[200:203], a[176:179], a[160:163], v[200:203]
    v_mfma_f32_16x16x32_bf16 v[204:207], a[180:183], a[160:163], v[204:207]
    s_waitcnt vmcnt(23)
    s_barrier
    s_cmp_lg_u32 s14, 0
    s_cbranch_scc1 parallel_sum__linear_attn_block__dense_activation_relu__prompt_kernel_b_own_sig
    v_mov_b32 v108, 1
    s_lshl_b32 s40, s16, 7
    s_add_u32 s40, s40, 15569920
    v_mov_b32 v109, s40
    s_mov_b64 exec, 1
    buffer_atomic_add v108, v109, s[20:23], 0 offen
    s_mov_b64 exec, -1
parallel_sum__linear_attn_block__dense_activation_relu__prompt_kernel_b_own_sig:
    s_waitcnt vmcnt(18)
    v_mfma_f32_16x16x32_bf16 v[128:131], a[200:203], a[184:187], v[128:131]
    v_mfma_f32_16x16x32_bf16 v[132:135], a[204:207], a[184:187], v[132:135]
    s_add_u32 s100, s100, 1
    s_cmp_eq_u32 s100, 10
    s_cselect_b32 s100, 0, s100
    s_lshl_b32 s44, s100, 2
    s_add_u32 s44, s44, 16
    s_mul_i32 s45, s44, 5120
    s_lshl_b32 s44, s44, 10
    s_cmp_eq_u32 s100, 9
    s_cselect_b32 s101, s46, 0
    s_add_u32 s44, s44, s101
    s_add_u32 s45, s45, s101
    v_add_u32 v3, s44, v6
    v_add_u32 v4, s45, v7
    buffer_load_dwordx4 a[164:167], v4, s[20:23], s96 offen offset:0 sc1
    v_mfma_f32_16x16x32_bf16 v[136:139], a[208:211], a[184:187], v[136:139]
    v_mfma_f32_16x16x32_bf16 v[140:143], a[212:215], a[184:187], v[140:143]
    buffer_load_dwordx4 a[168:171], v4, s[20:23], s96 offen offset:1024 sc1
    v_mfma_f32_16x16x32_bf16 v[144:147], a[216:219], a[184:187], v[144:147]
    v_mfma_f32_16x16x32_bf16 v[148:151], a[200:203], a[188:191], v[148:151]
    buffer_load_dwordx4 a[172:175], v4, s[20:23], s96 offen offset:2048 sc1
    v_mfma_f32_16x16x32_bf16 v[152:155], a[204:207], a[188:191], v[152:155]
    v_mfma_f32_16x16x32_bf16 v[156:159], a[208:211], a[188:191], v[156:159]
    buffer_load_dwordx4 a[176:179], v4, s[20:23], s96 offen offset:3072 sc1
    v_mfma_f32_16x16x32_bf16 v[160:163], a[212:215], a[188:191], v[160:163]
    v_mfma_f32_16x16x32_bf16 v[164:167], a[216:219], a[188:191], v[164:167]
    buffer_load_dwordx4 a[180:183], v4, s[20:23], s97 offen offset:0 sc1
    v_mfma_f32_16x16x32_bf16 v[168:171], a[200:203], a[192:195], v[168:171]
    v_mfma_f32_16x16x32_bf16 v[172:175], a[204:207], a[192:195], v[172:175]
    buffer_load_dwordx4 a[148:151], v3, s[20:23], s24 offen sc1
    v_mfma_f32_16x16x32_bf16 v[176:179], a[208:211], a[192:195], v[176:179]
    v_mfma_f32_16x16x32_bf16 v[180:183], a[212:215], a[192:195], v[180:183]
    buffer_load_dwordx4 a[152:155], v3, s[20:23], s25 offen sc1
    v_mfma_f32_16x16x32_bf16 v[184:187], a[216:219], a[192:195], v[184:187]
    v_mfma_f32_16x16x32_bf16 v[188:191], a[200:203], a[196:199], v[188:191]
    buffer_load_dwordx4 a[156:159], v3, s[20:23], s26 offen sc1
    v_mfma_f32_16x16x32_bf16 v[192:195], a[204:207], a[196:199], v[192:195]
    v_mfma_f32_16x16x32_bf16 v[196:199], a[208:211], a[196:199], v[196:199]
    buffer_load_dwordx4 a[160:163], v3, s[20:23], s27 offen sc1
    v_mfma_f32_16x16x32_bf16 v[200:203], a[212:215], a[196:199], v[200:203]
    v_mfma_f32_16x16x32_bf16 v[204:207], a[216:219], a[196:199], v[204:207]
    s_cmp_lg_u32 s14, 0
    s_cbranch_scc1 parallel_sum__linear_attn_block__dense_activation_relu__prompt_kernel_b_hap_pre
    s_lshl_b32 s40, s16, 7
    s_add_u32 s40, s40, 15567872
    v_mov_b32 v1, s40
    s_mov_b64 exec, 1
    buffer_load_dword v95, v1, s[20:23], 0 offen sc0 sc1
    s_mov_b64 exec, -1
parallel_sum__linear_attn_block__dense_activation_relu__prompt_kernel_b_hap_pre:
    s_waitcnt vmcnt(18)
    v_mfma_f32_16x16x32_bf16 v[128:131], a[236:239], a[220:223], v[128:131]
    v_mfma_f32_16x16x32_bf16 v[132:135], a[240:243], a[220:223], v[132:135]
    s_add_u32 s100, s100, 1
    s_cmp_eq_u32 s100, 10
    s_cselect_b32 s100, 0, s100
    s_lshl_b32 s44, s100, 2
    s_add_u32 s44, s44, 16
    s_mul_i32 s45, s44, 5120
    s_lshl_b32 s44, s44, 10
    s_cmp_eq_u32 s100, 9
    s_cselect_b32 s101, s46, 0
    s_add_u32 s44, s44, s101
    s_add_u32 s45, s45, s101
    v_add_u32 v3, s44, v6
    v_add_u32 v4, s45, v7
    buffer_load_dwordx4 a[200:203], v4, s[20:23], s96 offen offset:0 sc1
    v_mfma_f32_16x16x32_bf16 v[136:139], a[244:247], a[220:223], v[136:139]
    v_mfma_f32_16x16x32_bf16 v[140:143], a[248:251], a[220:223], v[140:143]
    buffer_load_dwordx4 a[204:207], v4, s[20:23], s96 offen offset:1024 sc1
    v_mfma_f32_16x16x32_bf16 v[144:147], a[252:255], a[220:223], v[144:147]
    v_mfma_f32_16x16x32_bf16 v[148:151], a[236:239], a[224:227], v[148:151]
    buffer_load_dwordx4 a[208:211], v4, s[20:23], s96 offen offset:2048 sc1
    v_mfma_f32_16x16x32_bf16 v[152:155], a[240:243], a[224:227], v[152:155]
    v_mfma_f32_16x16x32_bf16 v[156:159], a[244:247], a[224:227], v[156:159]
    buffer_load_dwordx4 a[212:215], v4, s[20:23], s96 offen offset:3072 sc1
    v_mfma_f32_16x16x32_bf16 v[160:163], a[248:251], a[224:227], v[160:163]
    v_mfma_f32_16x16x32_bf16 v[164:167], a[252:255], a[224:227], v[164:167]
    buffer_load_dwordx4 a[216:219], v4, s[20:23], s97 offen offset:0 sc1
    v_mfma_f32_16x16x32_bf16 v[168:171], a[236:239], a[228:231], v[168:171]
    v_mfma_f32_16x16x32_bf16 v[172:175], a[240:243], a[228:231], v[172:175]
    buffer_load_dwordx4 a[184:187], v3, s[20:23], s24 offen sc1
    v_mfma_f32_16x16x32_bf16 v[176:179], a[244:247], a[228:231], v[176:179]
    v_mfma_f32_16x16x32_bf16 v[180:183], a[248:251], a[228:231], v[180:183]
    buffer_load_dwordx4 a[188:191], v3, s[20:23], s25 offen sc1
    v_mfma_f32_16x16x32_bf16 v[184:187], a[252:255], a[228:231], v[184:187]
    v_mfma_f32_16x16x32_bf16 v[188:191], a[236:239], a[232:235], v[188:191]
    buffer_load_dwordx4 a[192:195], v3, s[20:23], s26 offen sc1
    v_mfma_f32_16x16x32_bf16 v[192:195], a[240:243], a[232:235], v[192:195]
    v_mfma_f32_16x16x32_bf16 v[196:199], a[244:247], a[232:235], v[196:199]
    buffer_load_dwordx4 a[196:199], v3, s[20:23], s27 offen sc1
    v_mfma_f32_16x16x32_bf16 v[200:203], a[248:251], a[232:235], v[200:203]
    v_mfma_f32_16x16x32_bf16 v[204:207], a[252:255], a[232:235], v[204:207]
    s_cmp_lg_u32 s14, 0
    s_cbranch_scc1 parallel_sum__linear_attn_block__dense_activation_relu__prompt_kernel_b_ha_ok
    v_mov_b32 v106, 8
    s_mov_b64 exec, 1
    s_waitcnt vmcnt(9)
    v_cmp_ge_u32 vcc, v95, v106
    s_nop 3
    s_cmp_eq_u64 vcc, 1
    s_cbranch_scc1 parallel_sum__linear_attn_block__dense_activation_relu__prompt_kernel_b_ha_done
    s_mov_b32 s42, 0
parallel_sum__linear_attn_block__dense_activation_relu__prompt_kernel_b_ha_spin:
    buffer_load_dword v95, v1, s[20:23], 0 offen sc0 sc1
    s_waitcnt vmcnt(0)
    v_cmp_ge_u32 vcc, v95, v106
    s_add_u32 s42, s42, 1
    s_cmp_ge_u32 s42, 0x40000
    s_cbranch_scc1 parallel_sum__linear_attn_block__dense_activation_relu__prompt_kernel_b_ha_done
    s_nop 0
    s_cmp_eq_u64 vcc, 1
    s_cbranch_scc0 parallel_sum__linear_attn_block__dense_activation_relu__prompt_kernel_b_ha_spin
parallel_sum__linear_attn_block__dense_activation_relu__prompt_kernel_b_ha_done:
    s_mov_b64 exec, -1
parallel_sum__linear_attn_block__dense_activation_relu__prompt_kernel_b_ha_ok:
    s_barrier
    s_waitcnt vmcnt(18)
    v_mfma_f32_16x16x32_bf16 v[128:131], a[128:131], a[112:115], v[128:131]
    v_mfma_f32_16x16x32_bf16 v[132:135], a[132:135], a[112:115], v[132:135]
    s_mul_i32 s44, s99, 16384
    s_lshr_b32 s44, s44, 16
    s_mul_i32 s44, s44, 4
    s_sub_u32 s100, s99, s44
    s_lshl_b32 s44, s100, 2
    s_add_u32 s44, s44, 0
    s_mul_i32 s45, s44, 5120
    s_lshl_b32 s44, s44, 10
    v_add_u32 v3, s44, v6
    v_add_u32 v4, s45, v7
    buffer_load_dwordx4 a[236:239], v4, s[20:23], s96 offen offset:0 sc1
    v_mfma_f32_16x16x32_bf16 v[136:139], a[136:139], a[112:115], v[136:139]
    v_mfma_f32_16x16x32_bf16 v[140:143], a[140:143], a[112:115], v[140:143]
    buffer_load_dwordx4 a[240:243], v4, s[20:23], s96 offen offset:1024 sc1
    v_mfma_f32_16x16x32_bf16 v[144:147], a[144:147], a[112:115], v[144:147]
    v_mfma_f32_16x16x32_bf16 v[148:151], a[128:131], a[116:119], v[148:151]
    buffer_load_dwordx4 a[244:247], v4, s[20:23], s96 offen offset:2048 sc1
    v_mfma_f32_16x16x32_bf16 v[152:155], a[132:135], a[116:119], v[152:155]
    v_mfma_f32_16x16x32_bf16 v[156:159], a[136:139], a[116:119], v[156:159]
    buffer_load_dwordx4 a[248:251], v4, s[20:23], s96 offen offset:3072 sc1
    v_mfma_f32_16x16x32_bf16 v[160:163], a[140:143], a[116:119], v[160:163]
    v_mfma_f32_16x16x32_bf16 v[164:167], a[144:147], a[116:119], v[164:167]
    buffer_load_dwordx4 a[252:255], v4, s[20:23], s97 offen offset:0 sc1
    v_mfma_f32_16x16x32_bf16 v[168:171], a[128:131], a[120:123], v[168:171]
    v_mfma_f32_16x16x32_bf16 v[172:175], a[132:135], a[120:123], v[172:175]
    buffer_load_dwordx4 a[220:223], v3, s[20:23], s24 offen sc1
    v_mfma_f32_16x16x32_bf16 v[176:179], a[136:139], a[120:123], v[176:179]
    v_mfma_f32_16x16x32_bf16 v[180:183], a[140:143], a[120:123], v[180:183]
    buffer_load_dwordx4 a[224:227], v3, s[20:23], s25 offen sc1
    v_mfma_f32_16x16x32_bf16 v[184:187], a[144:147], a[120:123], v[184:187]
    v_mfma_f32_16x16x32_bf16 v[188:191], a[128:131], a[124:127], v[188:191]
    buffer_load_dwordx4 a[228:231], v3, s[20:23], s26 offen sc1
    v_mfma_f32_16x16x32_bf16 v[192:195], a[132:135], a[124:127], v[192:195]
    v_mfma_f32_16x16x32_bf16 v[196:199], a[136:139], a[124:127], v[196:199]
    buffer_load_dwordx4 a[232:235], v3, s[20:23], s27 offen sc1
    v_mfma_f32_16x16x32_bf16 v[200:203], a[140:143], a[124:127], v[200:203]
    v_mfma_f32_16x16x32_bf16 v[204:207], a[144:147], a[124:127], v[204:207]
    s_waitcnt vmcnt(18)
    v_mfma_f32_16x16x32_bf16 v[128:131], a[164:167], a[148:151], v[128:131]
    v_mfma_f32_16x16x32_bf16 v[132:135], a[168:171], a[148:151], v[132:135]
    s_add_u32 s100, s100, 1
    s_cmp_eq_u32 s100, 4
    s_cselect_b32 s100, 0, s100
    s_lshl_b32 s44, s100, 2
    s_add_u32 s44, s44, 0
    s_mul_i32 s45, s44, 5120
    s_lshl_b32 s44, s44, 10
    v_add_u32 v3, s44, v6
    v_add_u32 v4, s45, v7
    buffer_load_dwordx4 a[128:131], v4, s[20:23], s96 offen offset:0 sc1
    v_mfma_f32_16x16x32_bf16 v[136:139], a[172:175], a[148:151], v[136:139]
    v_mfma_f32_16x16x32_bf16 v[140:143], a[176:179], a[148:151], v[140:143]
    buffer_load_dwordx4 a[132:135], v4, s[20:23], s96 offen offset:1024 sc1
    v_mfma_f32_16x16x32_bf16 v[144:147], a[180:183], a[148:151], v[144:147]
    v_mfma_f32_16x16x32_bf16 v[148:151], a[164:167], a[152:155], v[148:151]
    buffer_load_dwordx4 a[136:139], v4, s[20:23], s96 offen offset:2048 sc1
    v_mfma_f32_16x16x32_bf16 v[152:155], a[168:171], a[152:155], v[152:155]
    v_mfma_f32_16x16x32_bf16 v[156:159], a[172:175], a[152:155], v[156:159]
    buffer_load_dwordx4 a[140:143], v4, s[20:23], s96 offen offset:3072 sc1
    v_mfma_f32_16x16x32_bf16 v[160:163], a[176:179], a[152:155], v[160:163]
    v_mfma_f32_16x16x32_bf16 v[164:167], a[180:183], a[152:155], v[164:167]
    buffer_load_dwordx4 a[144:147], v4, s[20:23], s97 offen offset:0 sc1
    v_mfma_f32_16x16x32_bf16 v[168:171], a[164:167], a[156:159], v[168:171]
    v_mfma_f32_16x16x32_bf16 v[172:175], a[168:171], a[156:159], v[172:175]
    buffer_load_dwordx4 a[112:115], v3, s[20:23], s24 offen sc1
    v_mfma_f32_16x16x32_bf16 v[176:179], a[172:175], a[156:159], v[176:179]
    v_mfma_f32_16x16x32_bf16 v[180:183], a[176:179], a[156:159], v[180:183]
    buffer_load_dwordx4 a[116:119], v3, s[20:23], s25 offen sc1
    v_mfma_f32_16x16x32_bf16 v[184:187], a[180:183], a[156:159], v[184:187]
    v_mfma_f32_16x16x32_bf16 v[188:191], a[164:167], a[160:163], v[188:191]
    buffer_load_dwordx4 a[120:123], v3, s[20:23], s26 offen sc1
    v_mfma_f32_16x16x32_bf16 v[192:195], a[168:171], a[160:163], v[192:195]
    v_mfma_f32_16x16x32_bf16 v[196:199], a[172:175], a[160:163], v[196:199]
    buffer_load_dwordx4 a[124:127], v3, s[20:23], s27 offen sc1
    v_mfma_f32_16x16x32_bf16 v[200:203], a[176:179], a[160:163], v[200:203]
    v_mfma_f32_16x16x32_bf16 v[204:207], a[180:183], a[160:163], v[204:207]
    s_waitcnt vmcnt(18)
    v_mfma_f32_16x16x32_bf16 v[128:131], a[200:203], a[184:187], v[128:131]
    v_mfma_f32_16x16x32_bf16 v[132:135], a[204:207], a[184:187], v[132:135]
    s_add_u32 s100, s100, 1
    s_cmp_eq_u32 s100, 4
    s_cselect_b32 s100, 0, s100
    s_lshl_b32 s44, s100, 2
    s_add_u32 s44, s44, 0
    s_mul_i32 s45, s44, 5120
    s_lshl_b32 s44, s44, 10
    v_add_u32 v3, s44, v6
    v_add_u32 v4, s45, v7
    buffer_load_dwordx4 a[164:167], v4, s[20:23], s96 offen offset:0 sc1
    v_mfma_f32_16x16x32_bf16 v[136:139], a[208:211], a[184:187], v[136:139]
    v_mfma_f32_16x16x32_bf16 v[140:143], a[212:215], a[184:187], v[140:143]
    buffer_load_dwordx4 a[168:171], v4, s[20:23], s96 offen offset:1024 sc1
    v_mfma_f32_16x16x32_bf16 v[144:147], a[216:219], a[184:187], v[144:147]
    v_mfma_f32_16x16x32_bf16 v[148:151], a[200:203], a[188:191], v[148:151]
    buffer_load_dwordx4 a[172:175], v4, s[20:23], s96 offen offset:2048 sc1
    v_mfma_f32_16x16x32_bf16 v[152:155], a[204:207], a[188:191], v[152:155]
    v_mfma_f32_16x16x32_bf16 v[156:159], a[208:211], a[188:191], v[156:159]
    buffer_load_dwordx4 a[176:179], v4, s[20:23], s96 offen offset:3072 sc1
    v_mfma_f32_16x16x32_bf16 v[160:163], a[212:215], a[188:191], v[160:163]
    v_mfma_f32_16x16x32_bf16 v[164:167], a[216:219], a[188:191], v[164:167]
    buffer_load_dwordx4 a[180:183], v4, s[20:23], s97 offen offset:0 sc1
    v_mfma_f32_16x16x32_bf16 v[168:171], a[200:203], a[192:195], v[168:171]
    v_mfma_f32_16x16x32_bf16 v[172:175], a[204:207], a[192:195], v[172:175]
    buffer_load_dwordx4 a[148:151], v3, s[20:23], s24 offen sc1
    v_mfma_f32_16x16x32_bf16 v[176:179], a[208:211], a[192:195], v[176:179]
    v_mfma_f32_16x16x32_bf16 v[180:183], a[212:215], a[192:195], v[180:183]
    buffer_load_dwordx4 a[152:155], v3, s[20:23], s25 offen sc1
    v_mfma_f32_16x16x32_bf16 v[184:187], a[216:219], a[192:195], v[184:187]
    v_mfma_f32_16x16x32_bf16 v[188:191], a[200:203], a[196:199], v[188:191]
    buffer_load_dwordx4 a[156:159], v3, s[20:23], s26 offen sc1
    v_mfma_f32_16x16x32_bf16 v[192:195], a[204:207], a[196:199], v[192:195]
    v_mfma_f32_16x16x32_bf16 v[196:199], a[208:211], a[196:199], v[196:199]
    buffer_load_dwordx4 a[160:163], v3, s[20:23], s27 offen sc1
    v_mfma_f32_16x16x32_bf16 v[200:203], a[212:215], a[196:199], v[200:203]
    v_mfma_f32_16x16x32_bf16 v[204:207], a[216:219], a[196:199], v[204:207]
    s_cmp_lg_u32 s14, 0
    s_cbranch_scc1 parallel_sum__linear_attn_block__dense_activation_relu__prompt_kernel_b_obp_pre
    s_lshl_b32 s40, s16, 7
    s_add_u32 s40, s40, 15569920
    v_mov_b32 v1, s40
    s_mov_b64 exec, 1
    buffer_load_dword v95, v1, s[20:23], 0 offen sc0 sc1
    s_mov_b64 exec, -1
parallel_sum__linear_attn_block__dense_activation_relu__prompt_kernel_b_obp_pre:
    s_waitcnt vmcnt(18)
    v_mfma_f32_16x16x32_bf16 v[128:131], a[236:239], a[220:223], v[128:131]
    v_mfma_f32_16x16x32_bf16 v[132:135], a[240:243], a[220:223], v[132:135]
    s_add_u32 s100, s100, 1
    s_cmp_eq_u32 s100, 4
    s_cselect_b32 s100, 0, s100
    s_lshl_b32 s44, s100, 2
    s_add_u32 s44, s44, 0
    s_mul_i32 s45, s44, 5120
    s_lshl_b32 s44, s44, 10
    v_add_u32 v3, s44, v6
    v_add_u32 v4, s45, v7
    buffer_load_dwordx4 a[200:203], v4, s[20:23], s96 offen offset:0 sc1
    v_mfma_f32_16x16x32_bf16 v[136:139], a[244:247], a[220:223], v[136:139]
    v_mfma_f32_16x16x32_bf16 v[140:143], a[248:251], a[220:223], v[140:143]
    buffer_load_dwordx4 a[204:207], v4, s[20:23], s96 offen offset:1024 sc1
    v_mfma_f32_16x16x32_bf16 v[144:147], a[252:255], a[220:223], v[144:147]
    v_mfma_f32_16x16x32_bf16 v[148:151], a[236:239], a[224:227], v[148:151]
    buffer_load_dwordx4 a[208:211], v4, s[20:23], s96 offen offset:2048 sc1
    v_mfma_f32_16x16x32_bf16 v[152:155], a[240:243], a[224:227], v[152:155]
    v_mfma_f32_16x16x32_bf16 v[156:159], a[244:247], a[224:227], v[156:159]
    buffer_load_dwordx4 a[212:215], v4, s[20:23], s96 offen offset:3072 sc1
    v_mfma_f32_16x16x32_bf16 v[160:163], a[248:251], a[224:227], v[160:163]
    v_mfma_f32_16x16x32_bf16 v[164:167], a[252:255], a[224:227], v[164:167]
    buffer_load_dwordx4 a[216:219], v4, s[20:23], s97 offen offset:0 sc1
    v_mfma_f32_16x16x32_bf16 v[168:171], a[236:239], a[228:231], v[168:171]
    v_mfma_f32_16x16x32_bf16 v[172:175], a[240:243], a[228:231], v[172:175]
    buffer_load_dwordx4 a[184:187], v3, s[20:23], s24 offen sc1
    v_mfma_f32_16x16x32_bf16 v[176:179], a[244:247], a[228:231], v[176:179]
    v_mfma_f32_16x16x32_bf16 v[180:183], a[248:251], a[228:231], v[180:183]
    buffer_load_dwordx4 a[188:191], v3, s[20:23], s25 offen sc1
    v_mfma_f32_16x16x32_bf16 v[184:187], a[252:255], a[228:231], v[184:187]
    v_mfma_f32_16x16x32_bf16 v[188:191], a[236:239], a[232:235], v[188:191]
    buffer_load_dwordx4 a[192:195], v3, s[20:23], s26 offen sc1
    v_mfma_f32_16x16x32_bf16 v[192:195], a[240:243], a[232:235], v[192:195]
    v_mfma_f32_16x16x32_bf16 v[196:199], a[244:247], a[232:235], v[196:199]
    buffer_load_dwordx4 a[196:199], v3, s[20:23], s27 offen sc1
    v_mfma_f32_16x16x32_bf16 v[200:203], a[248:251], a[232:235], v[200:203]
    v_mfma_f32_16x16x32_bf16 v[204:207], a[252:255], a[232:235], v[204:207]
    s_cmp_lg_u32 s14, 0
    s_cbranch_scc1 parallel_sum__linear_attn_block__dense_activation_relu__prompt_kernel_b_ob_ok
    v_mov_b32 v106, 8
    s_mov_b64 exec, 1
    s_waitcnt vmcnt(9)
    v_cmp_ge_u32 vcc, v95, v106
    s_nop 3
    s_cmp_eq_u64 vcc, 1
    s_cbranch_scc1 parallel_sum__linear_attn_block__dense_activation_relu__prompt_kernel_b_ob_done
    s_mov_b32 s42, 0
parallel_sum__linear_attn_block__dense_activation_relu__prompt_kernel_b_ob_spin:
    buffer_load_dword v95, v1, s[20:23], 0 offen sc0 sc1
    s_waitcnt vmcnt(0)
    v_cmp_ge_u32 vcc, v95, v106
    s_add_u32 s42, s42, 1
    s_cmp_ge_u32 s42, 0x40000
    s_cbranch_scc1 parallel_sum__linear_attn_block__dense_activation_relu__prompt_kernel_b_ob_done
    s_nop 0
    s_cmp_eq_u64 vcc, 1
    s_cbranch_scc0 parallel_sum__linear_attn_block__dense_activation_relu__prompt_kernel_b_ob_spin
parallel_sum__linear_attn_block__dense_activation_relu__prompt_kernel_b_ob_done:
    s_mov_b64 exec, -1
parallel_sum__linear_attn_block__dense_activation_relu__prompt_kernel_b_ob_ok:
    s_barrier
    s_waitcnt vmcnt(18)
    v_mfma_f32_16x16x32_bf16 v[128:131], a[128:131], a[112:115], v[128:131]
    v_mfma_f32_16x16x32_bf16 v[132:135], a[132:135], a[112:115], v[132:135]
    s_mul_i32 s44, s99, 13108
    s_lshr_b32 s44, s44, 16
    s_mul_i32 s44, s44, 5
    s_sub_u32 s100, s99, s44
    s_lshl_b32 s44, s100, 2
    s_add_u32 s44, s44, 54
    s_mul_i32 s45, s44, 5120
    s_lshl_b32 s44, s44, 10
    v_add_u32 v3, s44, v6
    v_add_u32 v4, s45, v7
    buffer_load_dwordx4 a[236:239], v4, s[20:23], s96 offen offset:0 sc1
    v_mfma_f32_16x16x32_bf16 v[136:139], a[136:139], a[112:115], v[136:139]
    v_mfma_f32_16x16x32_bf16 v[140:143], a[140:143], a[112:115], v[140:143]
    buffer_load_dwordx4 a[240:243], v4, s[20:23], s96 offen offset:1024 sc1
    v_mfma_f32_16x16x32_bf16 v[144:147], a[144:147], a[112:115], v[144:147]
    v_mfma_f32_16x16x32_bf16 v[148:151], a[128:131], a[116:119], v[148:151]
    buffer_load_dwordx4 a[244:247], v4, s[20:23], s96 offen offset:2048 sc1
    v_mfma_f32_16x16x32_bf16 v[152:155], a[132:135], a[116:119], v[152:155]
    v_mfma_f32_16x16x32_bf16 v[156:159], a[136:139], a[116:119], v[156:159]
    buffer_load_dwordx4 a[248:251], v4, s[20:23], s96 offen offset:3072 sc1
    v_mfma_f32_16x16x32_bf16 v[160:163], a[140:143], a[116:119], v[160:163]
    v_mfma_f32_16x16x32_bf16 v[164:167], a[144:147], a[116:119], v[164:167]
    buffer_load_dwordx4 a[252:255], v4, s[20:23], s97 offen offset:0 sc1
    v_mfma_f32_16x16x32_bf16 v[168:171], a[128:131], a[120:123], v[168:171]
    v_mfma_f32_16x16x32_bf16 v[172:175], a[132:135], a[120:123], v[172:175]
    buffer_load_dwordx4 a[220:223], v3, s[20:23], s24 offen sc1
    v_mfma_f32_16x16x32_bf16 v[176:179], a[136:139], a[120:123], v[176:179]
    v_mfma_f32_16x16x32_bf16 v[180:183], a[140:143], a[120:123], v[180:183]
    buffer_load_dwordx4 a[224:227], v3, s[20:23], s25 offen sc1
    v_mfma_f32_16x16x32_bf16 v[184:187], a[144:147], a[120:123], v[184:187]
    v_mfma_f32_16x16x32_bf16 v[188:191], a[128:131], a[124:127], v[188:191]
    buffer_load_dwordx4 a[228:231], v3, s[20:23], s26 offen sc1
    v_mfma_f32_16x16x32_bf16 v[192:195], a[132:135], a[124:127], v[192:195]
    v_mfma_f32_16x16x32_bf16 v[196:199], a[136:139], a[124:127], v[196:199]
    buffer_load_dwordx4 a[232:235], v3, s[20:23], s27 offen sc1
    v_mfma_f32_16x16x32_bf16 v[200:203], a[140:143], a[124:127], v[200:203]
    v_mfma_f32_16x16x32_bf16 v[204:207], a[144:147], a[124:127], v[204:207]
    s_waitcnt vmcnt(18)
    v_mfma_f32_16x16x32_bf16 v[128:131], a[164:167], a[148:151], v[128:131]
    v_mfma_f32_16x16x32_bf16 v[132:135], a[168:171], a[148:151], v[132:135]
    s_add_u32 s100, s100, 1
    s_cmp_eq_u32 s100, 5
    s_cselect_b32 s100, 0, s100
    s_lshl_b32 s44, s100, 2
    s_add_u32 s44, s44, 54
    s_mul_i32 s45, s44, 5120
    s_lshl_b32 s44, s44, 10
    v_add_u32 v3, s44, v6
    v_add_u32 v4, s45, v7
    buffer_load_dwordx4 a[128:131], v4, s[20:23], s96 offen offset:0 sc1
    v_mfma_f32_16x16x32_bf16 v[136:139], a[172:175], a[148:151], v[136:139]
    v_mfma_f32_16x16x32_bf16 v[140:143], a[176:179], a[148:151], v[140:143]
    buffer_load_dwordx4 a[132:135], v4, s[20:23], s96 offen offset:1024 sc1
    v_mfma_f32_16x16x32_bf16 v[144:147], a[180:183], a[148:151], v[144:147]
    v_mfma_f32_16x16x32_bf16 v[148:151], a[164:167], a[152:155], v[148:151]
    buffer_load_dwordx4 a[136:139], v4, s[20:23], s96 offen offset:2048 sc1
    v_mfma_f32_16x16x32_bf16 v[152:155], a[168:171], a[152:155], v[152:155]
    v_mfma_f32_16x16x32_bf16 v[156:159], a[172:175], a[152:155], v[156:159]
    buffer_load_dwordx4 a[140:143], v4, s[20:23], s96 offen offset:3072 sc1
    v_mfma_f32_16x16x32_bf16 v[160:163], a[176:179], a[152:155], v[160:163]
    v_mfma_f32_16x16x32_bf16 v[164:167], a[180:183], a[152:155], v[164:167]
    buffer_load_dwordx4 a[144:147], v4, s[20:23], s97 offen offset:0 sc1
    v_mfma_f32_16x16x32_bf16 v[168:171], a[164:167], a[156:159], v[168:171]
    v_mfma_f32_16x16x32_bf16 v[172:175], a[168:171], a[156:159], v[172:175]
    buffer_load_dwordx4 a[112:115], v3, s[20:23], s24 offen sc1
    v_mfma_f32_16x16x32_bf16 v[176:179], a[172:175], a[156:159], v[176:179]
    v_mfma_f32_16x16x32_bf16 v[180:183], a[176:179], a[156:159], v[180:183]
    buffer_load_dwordx4 a[116:119], v3, s[20:23], s25 offen sc1
    v_mfma_f32_16x16x32_bf16 v[184:187], a[180:183], a[156:159], v[184:187]
    v_mfma_f32_16x16x32_bf16 v[188:191], a[164:167], a[160:163], v[188:191]
    buffer_load_dwordx4 a[120:123], v3, s[20:23], s26 offen sc1
    v_mfma_f32_16x16x32_bf16 v[192:195], a[168:171], a[160:163], v[192:195]
    v_mfma_f32_16x16x32_bf16 v[196:199], a[172:175], a[160:163], v[196:199]
    buffer_load_dwordx4 a[124:127], v3, s[20:23], s27 offen sc1
    v_mfma_f32_16x16x32_bf16 v[200:203], a[176:179], a[160:163], v[200:203]
    v_mfma_f32_16x16x32_bf16 v[204:207], a[180:183], a[160:163], v[204:207]
    s_waitcnt vmcnt(18)
    v_mfma_f32_16x16x32_bf16 v[128:131], a[200:203], a[184:187], v[128:131]
    v_mfma_f32_16x16x32_bf16 v[132:135], a[204:207], a[184:187], v[132:135]
    s_add_u32 s100, s100, 1
    s_cmp_eq_u32 s100, 5
    s_cselect_b32 s100, 0, s100
    s_lshl_b32 s44, s100, 2
    s_add_u32 s44, s44, 54
    s_mul_i32 s45, s44, 5120
    s_lshl_b32 s44, s44, 10
    v_add_u32 v3, s44, v6
    v_add_u32 v4, s45, v7
    buffer_load_dwordx4 a[164:167], v4, s[20:23], s96 offen offset:0 sc1
    v_mfma_f32_16x16x32_bf16 v[136:139], a[208:211], a[184:187], v[136:139]
    v_mfma_f32_16x16x32_bf16 v[140:143], a[212:215], a[184:187], v[140:143]
    buffer_load_dwordx4 a[168:171], v4, s[20:23], s96 offen offset:1024 sc1
    v_mfma_f32_16x16x32_bf16 v[144:147], a[216:219], a[184:187], v[144:147]
    v_mfma_f32_16x16x32_bf16 v[148:151], a[200:203], a[188:191], v[148:151]
    buffer_load_dwordx4 a[172:175], v4, s[20:23], s96 offen offset:2048 sc1
    v_mfma_f32_16x16x32_bf16 v[152:155], a[204:207], a[188:191], v[152:155]
    v_mfma_f32_16x16x32_bf16 v[156:159], a[208:211], a[188:191], v[156:159]
    buffer_load_dwordx4 a[176:179], v4, s[20:23], s96 offen offset:3072 sc1
    v_mfma_f32_16x16x32_bf16 v[160:163], a[212:215], a[188:191], v[160:163]
    v_mfma_f32_16x16x32_bf16 v[164:167], a[216:219], a[188:191], v[164:167]
    buffer_load_dwordx4 a[180:183], v4, s[20:23], s97 offen offset:0 sc1
    v_mfma_f32_16x16x32_bf16 v[168:171], a[200:203], a[192:195], v[168:171]
    v_mfma_f32_16x16x32_bf16 v[172:175], a[204:207], a[192:195], v[172:175]
    buffer_load_dwordx4 a[148:151], v3, s[20:23], s24 offen sc1
    v_mfma_f32_16x16x32_bf16 v[176:179], a[208:211], a[192:195], v[176:179]
    v_mfma_f32_16x16x32_bf16 v[180:183], a[212:215], a[192:195], v[180:183]
    buffer_load_dwordx4 a[152:155], v3, s[20:23], s25 offen sc1
    v_mfma_f32_16x16x32_bf16 v[184:187], a[216:219], a[192:195], v[184:187]
    v_mfma_f32_16x16x32_bf16 v[188:191], a[200:203], a[196:199], v[188:191]
    buffer_load_dwordx4 a[156:159], v3, s[20:23], s26 offen sc1
    v_mfma_f32_16x16x32_bf16 v[192:195], a[204:207], a[196:199], v[192:195]
    v_mfma_f32_16x16x32_bf16 v[196:199], a[208:211], a[196:199], v[196:199]
    buffer_load_dwordx4 a[160:163], v3, s[20:23], s27 offen sc1
    v_mfma_f32_16x16x32_bf16 v[200:203], a[212:215], a[196:199], v[200:203]
    v_mfma_f32_16x16x32_bf16 v[204:207], a[216:219], a[196:199], v[204:207]
    s_waitcnt vmcnt(18)
    v_mfma_f32_16x16x32_bf16 v[128:131], a[236:239], a[220:223], v[128:131]
    v_mfma_f32_16x16x32_bf16 v[132:135], a[240:243], a[220:223], v[132:135]
    s_add_u32 s100, s100, 1
    s_cmp_eq_u32 s100, 5
    s_cselect_b32 s100, 0, s100
    s_lshl_b32 s44, s100, 2
    s_add_u32 s44, s44, 54
    s_mul_i32 s45, s44, 5120
    s_lshl_b32 s44, s44, 10
    v_add_u32 v3, s44, v6
    v_add_u32 v4, s45, v7
    buffer_load_dwordx4 a[200:203], v4, s[20:23], s96 offen offset:0 sc1
    v_mfma_f32_16x16x32_bf16 v[136:139], a[244:247], a[220:223], v[136:139]
    v_mfma_f32_16x16x32_bf16 v[140:143], a[248:251], a[220:223], v[140:143]
    buffer_load_dwordx4 a[204:207], v4, s[20:23], s96 offen offset:1024 sc1
    v_mfma_f32_16x16x32_bf16 v[144:147], a[252:255], a[220:223], v[144:147]
    v_mfma_f32_16x16x32_bf16 v[148:151], a[236:239], a[224:227], v[148:151]
    buffer_load_dwordx4 a[208:211], v4, s[20:23], s96 offen offset:2048 sc1
    v_mfma_f32_16x16x32_bf16 v[152:155], a[240:243], a[224:227], v[152:155]
    v_mfma_f32_16x16x32_bf16 v[156:159], a[244:247], a[224:227], v[156:159]
    buffer_load_dwordx4 a[212:215], v4, s[20:23], s96 offen offset:3072 sc1
    v_mfma_f32_16x16x32_bf16 v[160:163], a[248:251], a[224:227], v[160:163]
    v_mfma_f32_16x16x32_bf16 v[164:167], a[252:255], a[224:227], v[164:167]
    buffer_load_dwordx4 a[216:219], v4, s[20:23], s97 offen offset:0 sc1
    v_mfma_f32_16x16x32_bf16 v[168:171], a[236:239], a[228:231], v[168:171]
    v_mfma_f32_16x16x32_bf16 v[172:175], a[240:243], a[228:231], v[172:175]
    buffer_load_dwordx4 a[184:187], v3, s[20:23], s24 offen sc1
    v_mfma_f32_16x16x32_bf16 v[176:179], a[244:247], a[228:231], v[176:179]
    v_mfma_f32_16x16x32_bf16 v[180:183], a[248:251], a[228:231], v[180:183]
    buffer_load_dwordx4 a[188:191], v3, s[20:23], s25 offen sc1
    v_mfma_f32_16x16x32_bf16 v[184:187], a[252:255], a[228:231], v[184:187]
    v_mfma_f32_16x16x32_bf16 v[188:191], a[236:239], a[232:235], v[188:191]
    buffer_load_dwordx4 a[192:195], v3, s[20:23], s26 offen sc1
    v_mfma_f32_16x16x32_bf16 v[192:195], a[240:243], a[232:235], v[192:195]
    v_mfma_f32_16x16x32_bf16 v[196:199], a[244:247], a[232:235], v[196:199]
    buffer_load_dwordx4 a[196:199], v3, s[20:23], s27 offen sc1
    v_mfma_f32_16x16x32_bf16 v[200:203], a[248:251], a[232:235], v[200:203]
    v_mfma_f32_16x16x32_bf16 v[204:207], a[252:255], a[232:235], v[204:207]
    s_waitcnt vmcnt(18)
    v_mfma_f32_16x16x32_bf16 v[128:131], a[128:131], a[112:115], v[128:131]
    v_mfma_f32_16x16x32_bf16 v[132:135], a[132:135], a[112:115], v[132:135]
    s_add_u32 s100, s100, 1
    s_cmp_eq_u32 s100, 5
    s_cselect_b32 s100, 0, s100
    s_lshl_b32 s44, s100, 2
    s_add_u32 s44, s44, 54
    s_mul_i32 s45, s44, 5120
    s_lshl_b32 s44, s44, 10
    v_add_u32 v3, s44, v6
    v_add_u32 v4, s45, v7
    buffer_load_dwordx4 a[236:239], v4, s[20:23], s96 offen offset:0 sc1
    v_mfma_f32_16x16x32_bf16 v[136:139], a[136:139], a[112:115], v[136:139]
    v_mfma_f32_16x16x32_bf16 v[140:143], a[140:143], a[112:115], v[140:143]
    buffer_load_dwordx4 a[240:243], v4, s[20:23], s96 offen offset:1024 sc1
    v_mfma_f32_16x16x32_bf16 v[144:147], a[144:147], a[112:115], v[144:147]
    v_mfma_f32_16x16x32_bf16 v[148:151], a[128:131], a[116:119], v[148:151]
    buffer_load_dwordx4 a[244:247], v4, s[20:23], s96 offen offset:2048 sc1
    v_mfma_f32_16x16x32_bf16 v[152:155], a[132:135], a[116:119], v[152:155]
    v_mfma_f32_16x16x32_bf16 v[156:159], a[136:139], a[116:119], v[156:159]
    buffer_load_dwordx4 a[248:251], v4, s[20:23], s96 offen offset:3072 sc1
    v_mfma_f32_16x16x32_bf16 v[160:163], a[140:143], a[116:119], v[160:163]
    v_mfma_f32_16x16x32_bf16 v[164:167], a[144:147], a[116:119], v[164:167]
    buffer_load_dwordx4 a[252:255], v4, s[20:23], s97 offen offset:0 sc1
    v_mfma_f32_16x16x32_bf16 v[168:171], a[128:131], a[120:123], v[168:171]
    v_mfma_f32_16x16x32_bf16 v[172:175], a[132:135], a[120:123], v[172:175]
    buffer_load_dwordx4 a[220:223], v3, s[20:23], s24 offen sc1
    v_mfma_f32_16x16x32_bf16 v[176:179], a[136:139], a[120:123], v[176:179]
    v_mfma_f32_16x16x32_bf16 v[180:183], a[140:143], a[120:123], v[180:183]
    buffer_load_dwordx4 a[224:227], v3, s[20:23], s25 offen sc1
    v_mfma_f32_16x16x32_bf16 v[184:187], a[144:147], a[120:123], v[184:187]
    v_mfma_f32_16x16x32_bf16 v[188:191], a[128:131], a[124:127], v[188:191]
    buffer_load_dwordx4 a[228:231], v3, s[20:23], s26 offen sc1
    v_mfma_f32_16x16x32_bf16 v[192:195], a[132:135], a[124:127], v[192:195]
    v_mfma_f32_16x16x32_bf16 v[196:199], a[136:139], a[124:127], v[196:199]
    buffer_load_dwordx4 a[232:235], v3, s[20:23], s27 offen sc1
    v_mfma_f32_16x16x32_bf16 v[200:203], a[140:143], a[124:127], v[200:203]
    v_mfma_f32_16x16x32_bf16 v[204:207], a[144:147], a[124:127], v[204:207]
    s_waitcnt vmcnt(18)
    v_mfma_f32_16x16x32_bf16 v[128:131], a[164:167], a[148:151], v[128:131]
    v_mfma_f32_16x16x32_bf16 v[132:135], a[168:171], a[148:151], v[132:135]
    s_add_u32 m0, s29, 0
    s_nop 0
    buffer_load_dwordx4 v116, s[4:7], s28 offen lds
    v_mfma_f32_16x16x32_bf16 v[136:139], a[172:175], a[148:151], v[136:139]
    v_mfma_f32_16x16x32_bf16 v[140:143], a[176:179], a[148:151], v[140:143]
    s_add_u32 m0, s29, 1024
    s_nop 0
    buffer_load_dwordx4 v117, s[4:7], s28 offen lds
    v_mfma_f32_16x16x32_bf16 v[144:147], a[180:183], a[148:151], v[144:147]
    v_mfma_f32_16x16x32_bf16 v[148:151], a[164:167], a[152:155], v[148:151]
    s_add_u32 m0, s29, 2048
    s_nop 0
    buffer_load_dwordx4 v118, s[4:7], s28 offen lds
    v_mfma_f32_16x16x32_bf16 v[152:155], a[168:171], a[152:155], v[152:155]
    v_mfma_f32_16x16x32_bf16 v[156:159], a[172:175], a[152:155], v[156:159]
    v_mfma_f32_16x16x32_bf16 v[160:163], a[176:179], a[152:155], v[160:163]
    v_mfma_f32_16x16x32_bf16 v[164:167], a[180:183], a[152:155], v[164:167]
    v_mfma_f32_16x16x32_bf16 v[168:171], a[164:167], a[156:159], v[168:171]
    v_mfma_f32_16x16x32_bf16 v[172:175], a[168:171], a[156:159], v[172:175]
    v_mfma_f32_16x16x32_bf16 v[176:179], a[172:175], a[156:159], v[176:179]
    v_mfma_f32_16x16x32_bf16 v[180:183], a[176:179], a[156:159], v[180:183]
    v_mfma_f32_16x16x32_bf16 v[184:187], a[180:183], a[156:159], v[184:187]
    v_mfma_f32_16x16x32_bf16 v[188:191], a[164:167], a[160:163], v[188:191]
    v_mfma_f32_16x16x32_bf16 v[192:195], a[168:171], a[160:163], v[192:195]
    v_mfma_f32_16x16x32_bf16 v[196:199], a[172:175], a[160:163], v[196:199]
    v_mfma_f32_16x16x32_bf16 v[200:203], a[176:179], a[160:163], v[200:203]
    v_mfma_f32_16x16x32_bf16 v[204:207], a[180:183], a[160:163], v[204:207]
    s_waitcnt vmcnt(12)
    v_mfma_f32_16x16x32_bf16 v[128:131], a[200:203], a[184:187], v[128:131]
    v_mfma_f32_16x16x32_bf16 v[132:135], a[204:207], a[184:187], v[132:135]
    v_mfma_f32_16x16x32_bf16 v[136:139], a[208:211], a[184:187], v[136:139]
    v_mfma_f32_16x16x32_bf16 v[140:143], a[212:215], a[184:187], v[140:143]
    v_mfma_f32_16x16x32_bf16 v[144:147], a[216:219], a[184:187], v[144:147]
    v_mfma_f32_16x16x32_bf16 v[148:151], a[200:203], a[188:191], v[148:151]
    v_mfma_f32_16x16x32_bf16 v[152:155], a[204:207], a[188:191], v[152:155]
    v_mfma_f32_16x16x32_bf16 v[156:159], a[208:211], a[188:191], v[156:159]
    v_mfma_f32_16x16x32_bf16 v[160:163], a[212:215], a[188:191], v[160:163]
    v_mfma_f32_16x16x32_bf16 v[164:167], a[216:219], a[188:191], v[164:167]
    v_mfma_f32_16x16x32_bf16 v[168:171], a[200:203], a[192:195], v[168:171]
    v_mfma_f32_16x16x32_bf16 v[172:175], a[204:207], a[192:195], v[172:175]
    v_mfma_f32_16x16x32_bf16 v[176:179], a[208:211], a[192:195], v[176:179]
    v_mfma_f32_16x16x32_bf16 v[180:183], a[212:215], a[192:195], v[180:183]
    v_mfma_f32_16x16x32_bf16 v[184:187], a[216:219], a[192:195], v[184:187]
    v_mfma_f32_16x16x32_bf16 v[188:191], a[200:203], a[196:199], v[188:191]
    v_mfma_f32_16x16x32_bf16 v[192:195], a[204:207], a[196:199], v[192:195]
    v_mfma_f32_16x16x32_bf16 v[196:199], a[208:211], a[196:199], v[196:199]
    v_mfma_f32_16x16x32_bf16 v[200:203], a[212:215], a[196:199], v[200:203]
    v_mfma_f32_16x16x32_bf16 v[204:207], a[216:219], a[196:199], v[204:207]
    s_waitcnt vmcnt(3)
    v_mfma_f32_16x16x32_bf16 v[148:151], a[236:239], a[224:227], v[148:151]
    v_mfma_f32_16x16x32_bf16 v[152:155], a[240:243], a[224:227], v[152:155]
    v_mfma_f32_16x16x32_bf16 v[156:159], a[244:247], a[224:227], v[156:159]
    v_mfma_f32_16x16x32_bf16 v[160:163], a[248:251], a[224:227], v[160:163]
    v_mfma_f32_16x16x32_bf16 v[164:167], a[252:255], a[224:227], v[164:167]
    v_mfma_f32_16x16x32_bf16 v[168:171], a[236:239], a[228:231], v[168:171]
    v_mfma_f32_16x16x32_bf16 v[172:175], a[240:243], a[228:231], v[172:175]
    v_mfma_f32_16x16x32_bf16 v[176:179], a[244:247], a[228:231], v[176:179]
    s_nop 0
    ds_write_b128 v10, v[148:151] offset:0
    v_mfma_f32_16x16x32_bf16 v[180:183], a[248:251], a[228:231], v[180:183]
    ds_write_b128 v10, v[152:155] offset:1024
    v_mfma_f32_16x16x32_bf16 v[184:187], a[252:255], a[228:231], v[184:187]
    ds_write_b128 v10, v[156:159] offset:2048
    v_mfma_f32_16x16x32_bf16 v[188:191], a[236:239], a[232:235], v[188:191]
    ds_write_b128 v10, v[160:163] offset:3072
    v_mfma_f32_16x16x32_bf16 v[192:195], a[240:243], a[232:235], v[192:195]
    ds_write_b128 v10, v[164:167] offset:4096
    v_mfma_f32_16x16x32_bf16 v[196:199], a[244:247], a[232:235], v[196:199]
    ds_write_b128 v11, v[168:171] offset:0
    v_mfma_f32_16x16x32_bf16 v[200:203], a[248:251], a[232:235], v[200:203]
    ds_write_b128 v11, v[172:175] offset:1024
    v_mfma_f32_16x16x32_bf16 v[204:207], a[252:255], a[232:235], v[204:207]
    ds_write_b128 v11, v[176:179] offset:2048
    v_mfma_f32_16x16x32_bf16 v[128:131], a[236:239], a[220:223], v[128:131]
    ds_write_b128 v11, v[180:183] offset:3072
    v_mfma_f32_16x16x32_bf16 v[132:135], a[240:243], a[220:223], v[132:135]
    ds_write_b128 v11, v[184:187] offset:4096
    v_mfma_f32_16x16x32_bf16 v[136:139], a[244:247], a[220:223], v[136:139]
    ds_write_b128 v12, v[188:191] offset:0
    v_mfma_f32_16x16x32_bf16 v[140:143], a[248:251], a[220:223], v[140:143]
    ds_write_b128 v12, v[192:195] offset:1024
    v_mfma_f32_16x16x32_bf16 v[144:147], a[252:255], a[220:223], v[144:147]
    ds_write_b128 v12, v[196:199] offset:2048
    ds_write_b128 v12, v[200:203] offset:3072
    ds_write_b128 v12, v[204:207] offset:4096
    s_waitcnt lgkmcnt(0)
    s_barrier
    ds_read_b128 v[148:151], v13 offset:0
    ds_read_b128 v[168:171], v13 offset:5120
    ds_read_b128 v[188:191], v13 offset:10240
    ds_read_b128 v[152:155], v13 offset:1024
    ds_read_b128 v[172:175], v13 offset:6144
    ds_read_b128 v[192:195], v13 offset:11264
    ds_read_b128 v[156:159], v13 offset:2048
    ds_read_b128 v[176:179], v13 offset:7168
    ds_read_b128 v[196:199], v13 offset:12288
    ds_read_b128 v[160:163], v13 offset:3072
    ds_read_b128 v[180:183], v13 offset:8192
    ds_read_b128 v[200:203], v13 offset:13312
    ds_read_b128 v[164:167], v13 offset:4096
    ds_read_b128 v[184:187], v13 offset:9216
    ds_read_b128 v[204:207], v13 offset:14336
    s_waitcnt vmcnt(0)
    ds_read_b64 v[96:97], v8 offset:0
    ds_read_b64 v[98:99], v8 offset:32
    ds_read_b64 v[100:101], v8 offset:64
    ds_read_b64 v[102:103], v8 offset:96
    ds_read_b64 v[104:105], v8 offset:128
    s_waitcnt lgkmcnt(15)
    v_add_f32 v128, v128, v148
    v_add_f32 v129, v129, v149
    v_add_f32 v130, v130, v150
    v_add_f32 v131, v131, v151
    v_add_f32 v128, v128, v168
    v_add_f32 v129, v129, v169
    v_add_f32 v130, v130, v170
    v_add_f32 v131, v131, v171
    v_add_f32 v128, v128, v188
    v_add_f32 v129, v129, v189
    v_add_f32 v130, v130, v190
    v_add_f32 v131, v131, v191
    s_waitcnt lgkmcnt(4)
    v_lshlrev_b32 v112, 16, v96
    v_and_b32 v113, 0xffff0000, v96
    v_lshlrev_b32 v114, 16, v97
    v_and_b32 v115, 0xffff0000, v97
    v_add_f32 v128, v128, v112
    v_add_f32 v129, v129, v113
    v_add_f32 v130, v130, v114
    v_add_f32 v131, v131, v115
    v_cvt_pk_bf16_f32 v96, v128, v129
    v_cvt_pk_bf16_f32 v97, v130, v131
    ds_write_b64 v8, v[96:97] offset:0
    v_add_f32 v132, v132, v152
    v_add_f32 v133, v133, v153
    v_add_f32 v134, v134, v154
    v_add_f32 v135, v135, v155
    v_add_f32 v132, v132, v172
    v_add_f32 v133, v133, v173
    v_add_f32 v134, v134, v174
    v_add_f32 v135, v135, v175
    v_add_f32 v132, v132, v192
    v_add_f32 v133, v133, v193
    v_add_f32 v134, v134, v194
    v_add_f32 v135, v135, v195
    s_waitcnt lgkmcnt(4)
    v_lshlrev_b32 v112, 16, v98
    v_and_b32 v113, 0xffff0000, v98
    v_lshlrev_b32 v114, 16, v99
    v_and_b32 v115, 0xffff0000, v99
    v_add_f32 v132, v132, v112
    v_add_f32 v133, v133, v113
    v_add_f32 v134, v134, v114
    v_add_f32 v135, v135, v115
    v_cvt_pk_bf16_f32 v98, v132, v133
    v_cvt_pk_bf16_f32 v99, v134, v135
    ds_write_b64 v8, v[98:99] offset:32
    v_add_f32 v136, v136, v156
    v_add_f32 v137, v137, v157
    v_add_f32 v138, v138, v158
    v_add_f32 v139, v139, v159
    v_add_f32 v136, v136, v176
    v_add_f32 v137, v137, v177
    v_add_f32 v138, v138, v178
    v_add_f32 v139, v139, v179
    v_add_f32 v136, v136, v196
    v_add_f32 v137, v137, v197
    v_add_f32 v138, v138, v198
    v_add_f32 v139, v139, v199
    s_waitcnt lgkmcnt(4)
    v_lshlrev_b32 v112, 16, v100
    v_and_b32 v113, 0xffff0000, v100
    v_lshlrev_b32 v114, 16, v101
    v_and_b32 v115, 0xffff0000, v101
    v_add_f32 v136, v136, v112
    v_add_f32 v137, v137, v113
    v_add_f32 v138, v138, v114
    v_add_f32 v139, v139, v115
    v_cvt_pk_bf16_f32 v100, v136, v137
    v_cvt_pk_bf16_f32 v101, v138, v139
    ds_write_b64 v8, v[100:101] offset:64
    v_add_f32 v140, v140, v160
    v_add_f32 v141, v141, v161
    v_add_f32 v142, v142, v162
    v_add_f32 v143, v143, v163
    v_add_f32 v140, v140, v180
    v_add_f32 v141, v141, v181
    v_add_f32 v142, v142, v182
    v_add_f32 v143, v143, v183
    v_add_f32 v140, v140, v200
    v_add_f32 v141, v141, v201
    v_add_f32 v142, v142, v202
    v_add_f32 v143, v143, v203
    s_waitcnt lgkmcnt(4)
    v_lshlrev_b32 v112, 16, v102
    v_and_b32 v113, 0xffff0000, v102
    v_lshlrev_b32 v114, 16, v103
    v_and_b32 v115, 0xffff0000, v103
    v_add_f32 v140, v140, v112
    v_add_f32 v141, v141, v113
    v_add_f32 v142, v142, v114
    v_add_f32 v143, v143, v115
    v_cvt_pk_bf16_f32 v102, v140, v141
    v_cvt_pk_bf16_f32 v103, v142, v143
    ds_write_b64 v8, v[102:103] offset:96
    v_add_f32 v144, v144, v164
    v_add_f32 v145, v145, v165
    v_add_f32 v146, v146, v166
    v_add_f32 v147, v147, v167
    v_add_f32 v144, v144, v184
    v_add_f32 v145, v145, v185
    v_add_f32 v146, v146, v186
    v_add_f32 v147, v147, v187
    v_add_f32 v144, v144, v204
    v_add_f32 v145, v145, v205
    v_add_f32 v146, v146, v206
    v_add_f32 v147, v147, v207
    s_waitcnt lgkmcnt(4)
    v_lshlrev_b32 v112, 16, v104
    v_and_b32 v113, 0xffff0000, v104
    v_lshlrev_b32 v114, 16, v105
    v_and_b32 v115, 0xffff0000, v105
    v_add_f32 v144, v144, v112
    v_add_f32 v145, v145, v113
    v_add_f32 v146, v146, v114
    v_add_f32 v147, v147, v115
    v_cvt_pk_bf16_f32 v104, v144, v145
    v_cvt_pk_bf16_f32 v105, v146, v147
    ds_write_b64 v8, v[104:105] offset:128
    s_waitcnt lgkmcnt(0)
    ds_read_b128 v[148:151], v9 offset:0
    ds_read_b128 v[152:155], v9 offset:1024
    ds_read_b128 v[156:159], v9 offset:2048
    s_waitcnt lgkmcnt(2)
    buffer_store_dwordx4 v[148:151], v116, s[8:11], s28 offen
    s_waitcnt lgkmcnt(1)
    buffer_store_dwordx4 v[152:155], v117, s[8:11], s28 offen
    s_waitcnt lgkmcnt(0)
    buffer_store_dwordx4 v[156:159], v118, s[8:11], s28 offen
parallel_sum__linear_attn_block__dense_activation_relu__prompt_kernel_end:
parallel_sum__linear_attn_block__dense_activation_relu__prompt_kernel_exit:
    s_endpgm
.section .rodata,"a"
.p2align 6
.amdhsa_kernel parallel_sum__linear_attn_block__dense_activation_relu__prompt_kernel
  .amdhsa_next_free_vgpr 512
  .amdhsa_next_free_sgpr 102
  .amdhsa_accum_offset 256
  .amdhsa_group_segment_fixed_size 0
  .amdhsa_kernarg_size 72
  .amdhsa_user_sgpr_count 2
  .amdhsa_user_sgpr_kernarg_segment_ptr 1
  .amdhsa_system_sgpr_workgroup_id_x 1
  .amdhsa_float_denorm_mode_32 3
.end_amdhsa_kernel
```
